```python
import torch

def _softmax(x, axis=-1):
    return torch.softmax(x, dim=axis)
def _gelu(x):
    return torch.nn.functional.gelu(x, approximate="tanh")
def _silu(x):
    return torch.nn.functional.silu(x)
def _sigmoid(x):
    return torch.sigmoid(x)
def _layernorm(x, axis=-1, eps=1e-5):
    m = x.mean(dim=axis, keepdim=True)
    v = x.var(dim=axis, keepdim=True, unbiased=False)
    return (x - m) / torch.sqrt(v + eps)
def _scatter_add(tgt, idx, src, axis=0):
    return tgt.clone().index_add_(axis, idx, src)
def _segment_sum(src, seg, n):
    out = torch.zeros((n,) + src.shape[1:], dtype=src.dtype)
    return out.index_add_(0, seg, src)
def _pad(x, pw):
    flat = tuple(v for pair in reversed(pw) for v in pair)
    return torch.nn.functional.pad(x, flat)

kernel_name = 'interleave_layers__spectral_fnet__glu_gated_glu__prompt'

def setup_inputs():

    _w = (lambda a: (lambda t: t.to(torch.bfloat16) if t.is_floating_point() else t)(torch.as_tensor(a)))
    def _A_setup():
        B, S, D = 1, 2048, 640
        ns = torch.arange(S)[:, None] * torch.arange(S)[None, :]
        nd = torch.arange(D)[:, None] * torch.arange(D)[None, :]
        Ws_re = torch.cos(-2.0 * torch.pi * ns / S).to(float)
        Ws_im = torch.sin(-2.0 * torch.pi * ns / S).to(float)
        Wd_re = torch.cos(-2.0 * torch.pi * nd / D).to(float)
        Wd_im = torch.sin(-2.0 * torch.pi * nd / D).to(float)
        return {
            "x": _w((lambda *s: torch.randn(*s, dtype=torch.bfloat16) * 0.05)(B, S, D)),
            "dft_seq_re": _w(Ws_re),
            "dft_seq_im": _w(Ws_im),
            "dft_hid_re": _w(Wd_re),
            "dft_hid_im": _w(Wd_im),
        }
    _A_in = _A_setup()

    def _B_setup():
        B, S, D, F = 1, 2048, 640, 1728
        return {
            "x": _w((lambda *s: torch.randn(*s, dtype=torch.bfloat16) * 0.05)(B, S, D)),
            "w_gate": _w((lambda *s: torch.randn(*s, dtype=torch.bfloat16) * 1.6)(D, F)),
            "w_up": _w((lambda *s: torch.randn(*s, dtype=torch.bfloat16) * 0.8)(D, F)),
            "w_down": _w((lambda *s: torch.randn(*s, dtype=torch.bfloat16) * 0.8)(F, D)),
        }
    _B_in = _B_setup()

    return {
        "A_x": _A_in["x"],
        "A_dft_seq_re": _A_in["dft_seq_re"],
        "A_dft_seq_im": _A_in["dft_seq_im"],
        "A_dft_hid_re": _A_in["dft_hid_re"],
        "A_dft_hid_im": _A_in["dft_hid_im"],
        "B_x": _B_in["x"],
        "B_w_gate": _B_in["w_gate"],
        "B_w_up": _B_in["w_up"],
        "B_w_down": _B_in["w_down"],
    }

def reference(A_x, A_dft_seq_re, A_dft_seq_im, A_dft_hid_re, A_dft_hid_im, B_x, B_w_gate, B_w_up, B_w_down):
    def _A_ref(x, dft_seq_re, dft_seq_im, dft_hid_re, dft_hid_im):
        a = torch.einsum("bsd,ed->bse", x, dft_hid_re)
        b = torch.einsum("bsd,ed->bse", x, dft_hid_im)
        y = torch.einsum("ts,bse->bte", dft_seq_re, a) - torch.einsum("ts,bse->bte", dft_seq_im, b)
        return y

    def _B_ref(x, w_gate, w_up, w_down):
        g = torch.einsum("bsd,df->bsf", x, w_gate)
        u = torch.einsum("bsd,df->bsf", x, w_up)
        h = _sigmoid(g) * u
        return torch.einsum("bsf,fd->bsd", h, w_down)

    x = A_x
    x = x + _A_ref(_layernorm(x, axis=-1), A_dft_seq_re, A_dft_seq_im, A_dft_hid_re, A_dft_hid_im)
    x = x + _B_ref(_layernorm(x, axis=-1), B_w_gate, B_w_up, B_w_down)
    x = x + _A_ref(_layernorm(x, axis=-1), A_dft_seq_re, A_dft_seq_im, A_dft_hid_re, A_dft_hid_im)
    x = x + _B_ref(_layernorm(x, axis=-1), B_w_gate, B_w_up, B_w_down)
    return x
```

```asm
; @launch grid=(256,1,1) block=(256,1,1) lds=163840
.amdgcn_target "amdgcn-amd-amdhsa--gfx950"
.text
.globl interleave_layers__spectral_fnet__glu_gated_glu__prompt_kernel
.p2align 8
.type interleave_layers__spectral_fnet__glu_gated_glu__prompt_kernel,@function
interleave_layers__spectral_fnet__glu_gated_glu__prompt_kernel:
    s_cmp_ge_u32 s2, 256
    s_cbranch_scc1 L_exit
    s_getpc_b64 s[30:31]
L_pfpc:
    v_lshlrev_b32 v1, 7, v0
    s_mov_b32 s37, L_exit-L_pfpc
    v_mov_b32 v5, s31
    v_mov_b32 v3, s31
    v_add_u32 v2, 0x8000, v1
    v_min_u32 v1, s37, v1
    v_min_u32 v2, s37, v2
    v_add_co_u32 v4, vcc, s30, v1
    s_nop 1
    v_addc_co_u32 v5, vcc, 0, v5, vcc
    global_load_dword v234, v[4:5], off
    v_add_co_u32 v2, vcc, s30, v2
    s_nop 1
    v_addc_co_u32 v3, vcc, 0, v3, vcc
    global_load_dword v235, v[2:3], off
    s_load_dwordx2 s[8:9], s[0:1], 0
    s_load_dwordx2 s[12:13], s[0:1], 24
    s_load_dwordx2 s[16:17], s[0:1], 32
    s_load_dwordx2 s[4:5], s[0:1], 88
    s_load_dwordx2 s[76:77], s[0:1], 48
    s_load_dwordx2 s[80:81], s[0:1], 56
    s_load_dwordx2 s[84:85], s[0:1], 64
    s_load_dwordx2 s[88:89], s[0:1], 80
    s_load_dwordx2 s[92:93], s[0:1], 72
    v_lshrrev_b32 v1, 6, v0
    v_and_b32 v0, 63, v0
    v_readfirstlane_b32 s20, v1
    s_mov_b32 s21, s2
    s_mov_b32 s10, 2621440
    s_mov_b32 s11, 0x20000
    s_mov_b32 s14, 819200
    s_mov_b32 s15, 0x20000
    s_mov_b32 s18, 819200
    s_mov_b32 s19, 0x20000
    s_mov_b32 s6, 34443264
    s_mov_b32 s7, 0x20000
    s_mov_b32 s78, 2211840
    s_mov_b32 s79, 0x20000
    s_mov_b32 s82, 2211840
    s_mov_b32 s83, 0x20000
    s_mov_b32 s86, 2211840
    s_mov_b32 s87, 0x20000
    s_mov_b32 s90, 256
    s_mov_b32 s91, 0x20000
    s_mov_b32 s94, 2621440
    s_mov_b32 s95, 0x20000
    s_and_b32 s25, s21, 7
    s_lshr_b32 s26, s21, 3
    s_and_b32 s70, s25, 3
    s_lshl_b32 s70, s70, 2
    s_lshr_b32 s27, s26, 3
    s_add_u32 s70, s70, s27
    s_lshr_b32 s71, s26, 2
    s_and_b32 s71, s71, 1
    s_lshr_b32 s72, s25, 2
    s_lshl_b32 s72, s72, 2
    s_and_b32 s27, s26, 3
    s_add_u32 s72, s72, s27
    s_and_b32 s73, s25, 1
    s_lshl_b32 s73, s73, 3
    s_lshr_b32 s27, s26, 2
    s_add_u32 s73, s73, s27
    s_lshr_b32 s74, s25, 1
    s_lshl_b32 s74, s74, 2
    s_and_b32 s27, s26, 3
    s_add_u32 s74, s74, s27
    s_mul_i32 s75, s74, 7
    s_min_u32 s75, s75, 101
    s_mov_b32 s38, 819200
    s_mov_b32 s39, 0x20000
    v_lshrrev_b32 v14, 4, v0
    v_and_b32 v15, 15, v0
    v_add_u32 v3, 0, v14
    v_xor_b32 v3, v15, v3
    v_mul_u32_u24 v4, 163840, v14
    v_lshl_add_u32 v16, v3, 4, v4
    v_add_u32 v3, 4, v14
    v_xor_b32 v3, v15, v3
    v_mul_u32_u24 v4, 163840, v14
    v_lshl_add_u32 v17, v3, 4, v4
    v_add_u32 v3, 8, v14
    v_xor_b32 v3, v15, v3
    v_mul_u32_u24 v4, 163840, v14
    v_lshl_add_u32 v18, v3, 4, v4
    v_add_u32 v3, 12, v14
    v_xor_b32 v3, v15, v3
    v_mul_u32_u24 v4, 163840, v14
    v_lshl_add_u32 v19, v3, 4, v4
    s_lshl_b32 s28, s20, 2
    v_add_u32 v3, s28, v14
    v_xor_b32 v3, v15, v3
    v_mul_u32_u24 v4, 1280, v14
    v_lshl_add_u32 v28, v3, 4, v4
    s_or_b32 s29, s72, s20
    s_cmp_eq_u32 s29, 0
    s_cselect_b32 s29, 409600, 0
    v_cmp_eq_u32 vcc, 0, v14
    v_mov_b32 v5, s29
    s_nop 0
    v_cndmask_b32 v5, 0, v5, vcc
    v_add_u32 v29, v28, v5
    s_mul_i32 s30, s72, 40
    s_and_b32 s31, s20, 1
    s_lshl_b32 s31, s31, 2
    s_add_u32 s30, s30, s31
    s_mul_i32 s30, s30, 1280
    s_lshl_b32 s32, s20, 10
    s_add_u32 s32, s32, 81920
    s_lshl_b32 s29, s71, 2
    s_add_u32 s29, s29, s20
    s_lshl_b32 s29, s29, 4
    s_add_u32 s29, s29, s70
    s_mul_i32 s29, s29, 1280
    s_lshl_b32 s31, s20, 12
    s_waitcnt lgkmcnt(0)
    s_lshl_b32 s61, s21, 8
    s_add_u32 s61, s61, 34377728
    s_cmp_lg_u32 s20, 0
    s_cbranch_scc1 L1_ol
    s_mov_b64 exec, 1
    v_mov_b32 v254, 0
    v_mov_b32 v255, 0
    buffer_store_dword v254, v255, s[4:7], s61 offen sc1
    s_mov_b64 exec, -1
L1_ol:
    s_cmp_lt_u32 s20, 2
    s_cselect_b32 s36, s12, s16
    s_cselect_b32 s37, s13, s17
    s_add_u32 m0, s31, 0
    s_add_u32 s33, s29, 0
    buffer_load_dwordx4 v16, s[8:11], s33 offen lds
    s_add_u32 m0, s31, 1024
    s_add_u32 s33, s29, 655360
    buffer_load_dwordx4 v17, s[8:11], s33 offen lds
    s_add_u32 m0, s31, 2048
    s_add_u32 s33, s29, 1310720
    buffer_load_dwordx4 v18, s[8:11], s33 offen lds
    s_add_u32 m0, s31, 3072
    s_add_u32 s33, s29, 1966080
    buffer_load_dwordx4 v19, s[8:11], s33 offen lds
    s_add_u32 m0, s32, 0
    s_add_u32 s33, s30, 0
    buffer_load_dwordx4 v29, s[36:39], s33 offen lds
    s_add_u32 m0, s32, 4096
    s_add_u32 s33, s30, 10240
    buffer_load_dwordx4 v28, s[36:39], s33 offen lds
    s_add_u32 m0, s32, 8192
    s_add_u32 s33, s30, 20480
    buffer_load_dwordx4 v28, s[36:39], s33 offen lds
    s_add_u32 m0, s32, 12288
    s_add_u32 s33, s30, 30720
    buffer_load_dwordx4 v28, s[36:39], s33 offen lds
    s_add_u32 m0, s32, 16384
    s_add_u32 s33, s30, 40960
    buffer_load_dwordx4 v28, s[36:39], s33 offen lds
    s_add_u32 m0, s31, 16384
    s_add_u32 s33, s29, 256
    buffer_load_dwordx4 v16, s[8:11], s33 offen lds
    s_add_u32 m0, s31, 17408
    s_add_u32 s33, s29, 655616
    buffer_load_dwordx4 v17, s[8:11], s33 offen lds
    s_add_u32 m0, s31, 18432
    s_add_u32 s33, s29, 1310976
    buffer_load_dwordx4 v18, s[8:11], s33 offen lds
    s_add_u32 m0, s31, 19456
    s_add_u32 s33, s29, 1966336
    buffer_load_dwordx4 v19, s[8:11], s33 offen lds
    s_add_u32 m0, s32, 20480
    s_add_u32 s33, s30, 256
    buffer_load_dwordx4 v29, s[36:39], s33 offen lds
    s_add_u32 m0, s32, 24576
    s_add_u32 s33, s30, 10496
    buffer_load_dwordx4 v28, s[36:39], s33 offen lds
    s_add_u32 m0, s32, 28672
    s_add_u32 s33, s30, 20736
    buffer_load_dwordx4 v28, s[36:39], s33 offen lds
    s_add_u32 m0, s32, 32768
    s_add_u32 s33, s30, 30976
    buffer_load_dwordx4 v28, s[36:39], s33 offen lds
    s_add_u32 m0, s32, 36864
    s_add_u32 s33, s30, 41216
    buffer_load_dwordx4 v28, s[36:39], s33 offen lds
    s_and_b32 s61, s21, 1
    s_lshl_b32 s61, s61, 7
    s_bfe_u32 s62, s21, 0x20001
    s_lshl_b32 s62, s62, 4
    s_add_u32 s61, s61, s62
    v_add_u32 v3, 0, v14
    v_xor_b32 v3, v15, v3
    v_lshlrev_b32 v3, 4, v3
    v_lshl_add_u32 v3, v15, 8, v3
    v_add_u32 v20, s31, v3
    v_add_u32 v24, 0x10000, v20
    v_add_u32 v30, 81920, v3
    v_add_u32 v3, 4, v14
    v_xor_b32 v3, v15, v3
    v_lshlrev_b32 v3, 4, v3
    v_lshl_add_u32 v3, v15, 8, v3
    v_add_u32 v21, s31, v3
    v_add_u32 v25, 0x10000, v21
    v_add_u32 v31, 81920, v3
    v_add_u32 v3, 8, v14
    v_xor_b32 v3, v15, v3
    v_lshlrev_b32 v3, 4, v3
    v_lshl_add_u32 v3, v15, 8, v3
    v_add_u32 v22, s31, v3
    v_add_u32 v26, 0x10000, v22
    v_add_u32 v32, 81920, v3
    v_add_u32 v3, 12, v14
    v_xor_b32 v3, v15, v3
    v_lshlrev_b32 v3, 4, v3
    v_lshl_add_u32 v3, v15, 8, v3
    v_add_u32 v23, s31, v3
    v_add_u32 v27, 0x10000, v23
    v_add_u32 v33, 81920, v3
    s_cmp_lg_u32 s20, 0
    s_cbranch_scc1 L2_ol
    s_mov_b64 exec, 1
    s_waitcnt vmcnt(18)
    v_mov_b32 v254, 1
    v_mov_b32 v255, 0
    buffer_atomic_add v254, v255, s[88:91], s61 offen sc1
    s_mov_b64 exec, -1
L2_ol:
    v_mov_b32 v60, 0x3f803f80
    v_mov_b32 v61, 0x3f803f80
    v_mov_b32 v62, 0x3f803f80
    v_mov_b32 v63, 0x3f803f80
    s_waitcnt vmcnt(9)
    s_barrier
    ds_read_b128 v[92:95], v20 offset:0
    ds_read_b128 v[100:103], v30 offset:0
    ds_read_b128 v[104:107], v30 offset:4096
    ds_read_b128 v[108:111], v30 offset:8192
    ds_read_b128 v[112:115], v30 offset:12288
    ds_read_b128 v[116:119], v30 offset:16384
    s_waitcnt lgkmcnt(4)
    v_mfma_f32_16x16x32_bf16 v[64:67], v[92:95], v[100:103], 0
    ds_read_b128 v[96:99], v21 offset:0
    s_add_u32 m0, s31, 32768
    s_add_u32 s33, s29, 512
    buffer_load_dwordx4 v16, s[8:11], s33 offen lds
    v_mov_b32 v45, 1.0
    v_mov_b32 v6, -1.0
    s_waitcnt lgkmcnt(4)
    v_mfma_f32_16x16x32_bf16 v[68:71], v[92:95], v[104:107], 0
    ds_read_b128 v[120:123], v31 offset:0
    s_add_u32 m0, s31, 33792
    s_add_u32 s33, s29, 655872
    buffer_load_dwordx4 v17, s[8:11], s33 offen lds
    v_cmp_gt_u32 vcc, 8, v15
    s_nop 1
    v_cndmask_b32 v45, v6, v45, vcc
    s_waitcnt lgkmcnt(4)
    v_mfma_f32_16x16x32_bf16 v[72:75], v[92:95], v[108:111], 0
    ds_read_b128 v[124:127], v31 offset:4096
    s_add_u32 m0, s31, 34816
    s_add_u32 s33, s29, 1311232
    buffer_load_dwordx4 v18, s[8:11], s33 offen lds
    v_and_b32 v3, 7, v15
    v_lshrrev_b32 v4, 3, v15
    s_waitcnt lgkmcnt(4)
    v_mfma_f32_16x16x32_bf16 v[76:79], v[92:95], v[112:115], 0
    ds_read_b128 v[128:131], v31 offset:8192
    s_add_u32 m0, s31, 35840
    s_add_u32 s33, s29, 1966592
    buffer_load_dwordx4 v19, s[8:11], s33 offen lds
    v_lshlrev_b32 v3, 4, v3
    v_lshl_add_u32 v3, v4, 3, v3
    s_waitcnt lgkmcnt(4)
    v_mfma_f32_16x16x32_bf16 v[80:83], v[92:95], v[116:119], 0
    ds_read_b128 v[132:135], v31 offset:12288
    s_add_u32 m0, s32, 40960
    s_add_u32 s33, s30, 512
    buffer_load_dwordx4 v29, s[36:39], s33 offen lds
    v_mul_u32_u24 v4, 2560, v14
    v_add_u32 v3, v3, v4
    v_mfma_f32_16x16x32_bf16 v[84:87], v[92:95], v[92:95], 0
    ds_read_b128 v[136:139], v31 offset:16384
    s_lshl_b32 s53, s20, 1
    v_add_u32 v3, s53, v3
    v_add_u32 v44, 143360, v3
    v_mfma_f32_16x16x32_bf16 v[88:91], v[92:95], v[60:63], 0
    s_lshl_b32 s53, s20, 6
    v_add_u32 v7, s53, v0
    s_lshl_b32 s54, s70, 1
    s_waitcnt lgkmcnt(4)
    v_mfma_f32_16x16x32_bf16 v[64:67], v[96:99], v[120:123], v[64:67]
    ds_read_b128 v[92:95], v22 offset:0
    s_add_u32 m0, s32, 45056
    s_add_u32 s33, s30, 10752
    buffer_load_dwordx4 v28, s[36:39], s33 offen lds
    s_add_u32 s54, s54, s71
    s_mul_i32 s54, s54, 320
    s_waitcnt lgkmcnt(4)
    v_mfma_f32_16x16x32_bf16 v[68:71], v[96:99], v[124:127], v[68:71]
    ds_read_b128 v[100:103], v32 offset:0
    s_add_u32 m0, s32, 49152
    s_add_u32 s33, s30, 20992
    buffer_load_dwordx4 v28, s[36:39], s33 offen lds
    s_mul_i32 s53, s72, 40
    s_add_u32 s54, s54, s53
    s_waitcnt lgkmcnt(4)
    v_mfma_f32_16x16x32_bf16 v[72:75], v[96:99], v[128:131], v[72:75]
    ds_read_b128 v[104:107], v32 offset:4096
    s_add_u32 m0, s32, 53248
    s_add_u32 s33, s30, 31232
    buffer_load_dwordx4 v28, s[36:39], s33 offen lds
    s_lshl_b32 s54, s54, 4
    s_add_u32 s54, s54, 6721536
    s_waitcnt lgkmcnt(4)
    v_mfma_f32_16x16x32_bf16 v[76:79], v[96:99], v[132:135], v[76:79]
    ds_read_b128 v[108:111], v32 offset:8192
    s_add_u32 m0, s32, 57344
    s_add_u32 s33, s30, 41472
    buffer_load_dwordx4 v28, s[36:39], s33 offen lds
    v_add_u32 v8, 0, v7
    v_mul_u32_u24 v9, 205, v8
    s_waitcnt lgkmcnt(4)
    v_mfma_f32_16x16x32_bf16 v[80:83], v[96:99], v[136:139], v[80:83]
    ds_read_b128 v[112:115], v32 offset:12288
    s_add_u32 m0, s31, 49152
    s_add_u32 s33, s29, 768
    buffer_load_dwordx4 v16, s[8:11], s33 offen lds
    v_lshrrev_b32 v9, 13, v9
    v_mul_u32_u24 v6, 40, v9
    v_mfma_f32_16x16x32_bf16 v[84:87], v[96:99], v[96:99], v[84:87]
    ds_read_b128 v[116:119], v32 offset:16384
    v_sub_u32 v6, v8, v6
    v_mul_u32_u24 v9, 163840, v9
    v_lshl_add_u32 v38, v6, 4, v9
    v_mfma_f32_16x16x32_bf16 v[88:91], v[96:99], v[60:63], v[88:91]
    v_lshlrev_b32 v8, 4, v8
    v_add_u32 v41, 143360, v8
    v_add_u32 v8, 256, v7
    s_waitcnt lgkmcnt(4)
    v_mfma_f32_16x16x32_bf16 v[64:67], v[92:95], v[100:103], v[64:67]
    ds_read_b128 v[96:99], v23 offset:0
    s_add_u32 m0, s31, 50176
    s_add_u32 s33, s29, 656128
    buffer_load_dwordx4 v17, s[8:11], s33 offen lds
    v_mul_u32_u24 v9, 205, v8
    v_lshrrev_b32 v9, 13, v9
    s_waitcnt lgkmcnt(4)
    v_mfma_f32_16x16x32_bf16 v[68:71], v[92:95], v[104:107], v[68:71]
    ds_read_b128 v[120:123], v33 offset:0
    s_add_u32 m0, s31, 51200
    s_add_u32 s33, s29, 1311488
    buffer_load_dwordx4 v18, s[8:11], s33 offen lds
    v_mul_u32_u24 v6, 40, v9
    v_sub_u32 v6, v8, v6
    s_waitcnt lgkmcnt(4)
    v_mfma_f32_16x16x32_bf16 v[72:75], v[92:95], v[108:111], v[72:75]
    ds_read_b128 v[124:127], v33 offset:4096
    s_add_u32 m0, s31, 52224
    s_add_u32 s33, s29, 1966848
    buffer_load_dwordx4 v19, s[8:11], s33 offen lds
    v_mul_u32_u24 v9, 163840, v9
    v_lshl_add_u32 v39, v6, 4, v9
    s_waitcnt lgkmcnt(4)
    v_mfma_f32_16x16x32_bf16 v[76:79], v[92:95], v[112:115], v[76:79]
    ds_read_b128 v[128:131], v33 offset:8192
    s_add_u32 m0, s31, 65536
    s_add_u32 s33, s29, 1024
    buffer_load_dwordx4 v16, s[8:11], s33 offen lds
    v_lshlrev_b32 v8, 4, v8
    v_add_u32 v42, 143360, v8
    s_waitcnt lgkmcnt(4)
    v_mfma_f32_16x16x32_bf16 v[80:83], v[92:95], v[116:119], v[80:83]
    ds_read_b128 v[132:135], v33 offset:12288
    s_add_u32 m0, s31, 66560
    s_add_u32 s33, s29, 656384
    buffer_load_dwordx4 v17, s[8:11], s33 offen lds
    v_add_u32 v8, 512, v7
    v_mul_u32_u24 v9, 205, v8
    v_mfma_f32_16x16x32_bf16 v[84:87], v[92:95], v[92:95], v[84:87]
    ds_read_b128 v[136:139], v33 offset:16384
    v_lshrrev_b32 v9, 13, v9
    v_mul_u32_u24 v6, 40, v9
    v_sub_u32 v6, v8, v6
    v_mfma_f32_16x16x32_bf16 v[88:91], v[92:95], v[60:63], v[88:91]
    v_mul_u32_u24 v9, 163840, v9
    v_lshl_add_u32 v40, v6, 4, v9
    v_lshlrev_b32 v8, 4, v8
    s_add_u32 m0, s31, 67584
    s_add_u32 s33, s29, 1311744
    buffer_load_dwordx4 v18, s[8:11], s33 offen lds
    s_add_u32 m0, s31, 68608
    s_add_u32 s33, s29, 1967104
    buffer_load_dwordx4 v19, s[8:11], s33 offen lds
    s_waitcnt lgkmcnt(0)
    s_waitcnt vmcnt(17)
    s_barrier
    v_mfma_f32_16x16x32_bf16 v[64:67], v[96:99], v[120:123], v[64:67]
    ds_read_b128 v[92:95], v20 offset:16384
    s_add_u32 m0, s32, 0
    s_add_u32 s33, s30, 768
    buffer_load_dwordx4 v29, s[36:39], s33 offen lds
    v_add_u32 v43, 143360, v8
    v_and_b32 v48, 15, v0
    v_mfma_f32_16x16x32_bf16 v[68:71], v[96:99], v[124:127], v[68:71]
    ds_read_b128 v[100:103], v30 offset:20480
    s_add_u32 m0, s32, 4096
    s_add_u32 s33, s30, 11008
    buffer_load_dwordx4 v28, s[36:39], s33 offen lds
    v_lshrrev_b32 v49, 4, v0
    v_lshlrev_b32 v49, 2, v49
    v_mfma_f32_16x16x32_bf16 v[72:75], v[96:99], v[128:131], v[72:75]
    ds_read_b128 v[104:107], v30 offset:24576
    s_add_u32 m0, s32, 8192
    s_add_u32 s33, s30, 21248
    buffer_load_dwordx4 v28, s[36:39], s33 offen lds
    v_add_u32 v50, 0, v49
    v_mul_u32_u24 v50, v48, v50
    v_mfma_f32_16x16x32_bf16 v[76:79], v[96:99], v[132:135], v[76:79]
    ds_read_b128 v[108:111], v30 offset:28672
    s_add_u32 m0, s32, 12288
    s_add_u32 s33, s30, 31488
    buffer_load_dwordx4 v28, s[36:39], s33 offen lds
    v_and_b32 v50, 15, v50
    v_cvt_f32_u32 v50, v50
    v_mfma_f32_16x16x32_bf16 v[80:83], v[96:99], v[136:139], v[80:83]
    ds_read_b128 v[112:115], v30 offset:32768
    s_add_u32 m0, s32, 16384
    s_add_u32 s33, s30, 41728
    buffer_load_dwordx4 v28, s[36:39], s33 offen lds
    v_mul_f32 v50, 0x3d800000, v50
    v_cos_f32 v51, v50
    v_mfma_f32_16x16x32_bf16 v[84:87], v[96:99], v[96:99], v[84:87]
    ds_read_b128 v[116:119], v30 offset:36864
    v_sin_f32 v55, v50
    v_add_u32 v50, 1, v49
    v_mul_u32_u24 v50, v48, v50
    v_mfma_f32_16x16x32_bf16 v[88:91], v[96:99], v[60:63], v[88:91]
    v_and_b32 v50, 15, v50
    v_cvt_f32_u32 v50, v50
    v_mul_f32 v50, 0x3d800000, v50
    s_waitcnt lgkmcnt(4)
    v_mfma_f32_16x16x32_bf16 v[64:67], v[92:95], v[100:103], v[64:67]
    ds_read_b128 v[96:99], v21 offset:16384
    v_cos_f32 v52, v50
    v_sin_f32 v56, v50
    s_waitcnt lgkmcnt(4)
    v_mfma_f32_16x16x32_bf16 v[68:71], v[92:95], v[104:107], v[68:71]
    ds_read_b128 v[120:123], v31 offset:20480
    v_add_u32 v50, 2, v49
    v_mul_u32_u24 v50, v48, v50
    s_waitcnt lgkmcnt(4)
    v_mfma_f32_16x16x32_bf16 v[72:75], v[92:95], v[108:111], v[72:75]
    ds_read_b128 v[124:127], v31 offset:24576
    v_and_b32 v50, 15, v50
    v_cvt_f32_u32 v50, v50
    s_waitcnt lgkmcnt(4)
    v_mfma_f32_16x16x32_bf16 v[76:79], v[92:95], v[112:115], v[76:79]
    ds_read_b128 v[128:131], v31 offset:28672
    v_mul_f32 v50, 0x3d800000, v50
    v_cos_f32 v53, v50
    s_waitcnt lgkmcnt(4)
    v_mfma_f32_16x16x32_bf16 v[80:83], v[92:95], v[116:119], v[80:83]
    ds_read_b128 v[132:135], v31 offset:32768
    v_sin_f32 v57, v50
    v_add_u32 v50, 3, v49
    v_mfma_f32_16x16x32_bf16 v[84:87], v[92:95], v[92:95], v[84:87]
    ds_read_b128 v[136:139], v31 offset:36864
    v_mul_u32_u24 v50, v48, v50
    v_and_b32 v50, 15, v50
    v_cvt_f32_u32 v50, v50
    v_mfma_f32_16x16x32_bf16 v[88:91], v[92:95], v[60:63], v[88:91]
    v_mul_f32 v50, 0x3d800000, v50
    v_cos_f32 v54, v50
    v_sin_f32 v58, v50
    s_waitcnt lgkmcnt(4)
    v_mfma_f32_16x16x32_bf16 v[64:67], v[96:99], v[120:123], v[64:67]
    ds_read_b128 v[92:95], v22 offset:16384
    v_cvt_pk_bf16_f32 v250, v51, v52
    v_cvt_pk_bf16_f32 v252, v55, v56
    s_waitcnt lgkmcnt(4)
    v_mfma_f32_16x16x32_bf16 v[68:71], v[96:99], v[124:127], v[68:71]
    ds_read_b128 v[100:103], v32 offset:20480
    v_cvt_pk_bf16_f32 v251, v53, v54
    v_cvt_pk_bf16_f32 v253, v57, v58
    s_waitcnt lgkmcnt(4)
    v_mfma_f32_16x16x32_bf16 v[72:75], v[96:99], v[128:131], v[72:75]
    ds_read_b128 v[104:107], v32 offset:24576
    s_waitcnt lgkmcnt(4)
    v_mfma_f32_16x16x32_bf16 v[76:79], v[96:99], v[132:135], v[76:79]
    ds_read_b128 v[108:111], v32 offset:28672
    s_waitcnt lgkmcnt(4)
    v_mfma_f32_16x16x32_bf16 v[80:83], v[96:99], v[136:139], v[80:83]
    ds_read_b128 v[112:115], v32 offset:32768
    v_mfma_f32_16x16x32_bf16 v[84:87], v[96:99], v[96:99], v[84:87]
    ds_read_b128 v[116:119], v32 offset:36864
    v_mfma_f32_16x16x32_bf16 v[88:91], v[96:99], v[60:63], v[88:91]
    s_waitcnt lgkmcnt(4)
    v_mfma_f32_16x16x32_bf16 v[64:67], v[92:95], v[100:103], v[64:67]
    ds_read_b128 v[96:99], v23 offset:16384
    s_waitcnt lgkmcnt(4)
    v_mfma_f32_16x16x32_bf16 v[68:71], v[92:95], v[104:107], v[68:71]
    ds_read_b128 v[120:123], v33 offset:20480
    s_waitcnt lgkmcnt(4)
    v_mfma_f32_16x16x32_bf16 v[72:75], v[92:95], v[108:111], v[72:75]
    ds_read_b128 v[124:127], v33 offset:24576
    s_waitcnt lgkmcnt(4)
    v_mfma_f32_16x16x32_bf16 v[76:79], v[92:95], v[112:115], v[76:79]
    ds_read_b128 v[128:131], v33 offset:28672
    s_waitcnt lgkmcnt(4)
    v_mfma_f32_16x16x32_bf16 v[80:83], v[92:95], v[116:119], v[80:83]
    ds_read_b128 v[132:135], v33 offset:32768
    v_mfma_f32_16x16x32_bf16 v[84:87], v[92:95], v[92:95], v[84:87]
    ds_read_b128 v[136:139], v33 offset:36864
    v_mfma_f32_16x16x32_bf16 v[88:91], v[92:95], v[60:63], v[88:91]
    s_waitcnt lgkmcnt(0)
    s_waitcnt vmcnt(13)
    s_barrier
    v_mfma_f32_16x16x32_bf16 v[64:67], v[96:99], v[120:123], v[64:67]
    ds_read_b128 v[92:95], v20 offset:32768
    s_add_u32 m0, s32, 20480
    s_add_u32 s33, s30, 1024
    buffer_load_dwordx4 v29, s[36:39], s33 offen lds
    v_mfma_f32_16x16x32_bf16 v[68:71], v[96:99], v[124:127], v[68:71]
    ds_read_b128 v[100:103], v30 offset:40960
    s_add_u32 m0, s32, 24576
    s_add_u32 s33, s30, 11264
    buffer_load_dwordx4 v28, s[36:39], s33 offen lds
    v_mfma_f32_16x16x32_bf16 v[72:75], v[96:99], v[128:131], v[72:75]
    ds_read_b128 v[104:107], v30 offset:45056
    s_add_u32 m0, s32, 28672
    s_add_u32 s33, s30, 21504
    buffer_load_dwordx4 v28, s[36:39], s33 offen lds
    v_mfma_f32_16x16x32_bf16 v[76:79], v[96:99], v[132:135], v[76:79]
    ds_read_b128 v[108:111], v30 offset:49152
    s_add_u32 m0, s32, 32768
    s_add_u32 s33, s30, 31744
    buffer_load_dwordx4 v28, s[36:39], s33 offen lds
    v_mfma_f32_16x16x32_bf16 v[80:83], v[96:99], v[136:139], v[80:83]
    ds_read_b128 v[112:115], v30 offset:53248
    s_add_u32 m0, s32, 36864
    s_add_u32 s33, s30, 41984
    buffer_load_dwordx4 v28, s[36:39], s33 offen lds
    v_mfma_f32_16x16x32_bf16 v[84:87], v[96:99], v[96:99], v[84:87]
    ds_read_b128 v[116:119], v30 offset:57344
    v_mfma_f32_16x16x32_bf16 v[88:91], v[96:99], v[60:63], v[88:91]
    s_waitcnt lgkmcnt(4)
    v_mfma_f32_16x16x32_bf16 v[64:67], v[92:95], v[100:103], v[64:67]
    ds_read_b128 v[96:99], v21 offset:32768
    s_waitcnt lgkmcnt(4)
    v_mfma_f32_16x16x32_bf16 v[68:71], v[92:95], v[104:107], v[68:71]
    ds_read_b128 v[120:123], v31 offset:40960
    s_waitcnt lgkmcnt(4)
    v_mfma_f32_16x16x32_bf16 v[72:75], v[92:95], v[108:111], v[72:75]
    ds_read_b128 v[124:127], v31 offset:45056
    s_waitcnt lgkmcnt(4)
    v_mfma_f32_16x16x32_bf16 v[76:79], v[92:95], v[112:115], v[76:79]
    ds_read_b128 v[128:131], v31 offset:49152
    s_waitcnt lgkmcnt(4)
    v_mfma_f32_16x16x32_bf16 v[80:83], v[92:95], v[116:119], v[80:83]
    ds_read_b128 v[132:135], v31 offset:53248
    v_mfma_f32_16x16x32_bf16 v[84:87], v[92:95], v[92:95], v[84:87]
    ds_read_b128 v[136:139], v31 offset:57344
    v_mfma_f32_16x16x32_bf16 v[88:91], v[92:95], v[60:63], v[88:91]
    s_waitcnt lgkmcnt(4)
    v_mfma_f32_16x16x32_bf16 v[64:67], v[96:99], v[120:123], v[64:67]
    ds_read_b128 v[92:95], v22 offset:32768
    s_waitcnt lgkmcnt(4)
    v_mfma_f32_16x16x32_bf16 v[68:71], v[96:99], v[124:127], v[68:71]
    ds_read_b128 v[100:103], v32 offset:40960
    s_waitcnt lgkmcnt(4)
    v_mfma_f32_16x16x32_bf16 v[72:75], v[96:99], v[128:131], v[72:75]
    ds_read_b128 v[104:107], v32 offset:45056
    s_waitcnt lgkmcnt(4)
    v_mfma_f32_16x16x32_bf16 v[76:79], v[96:99], v[132:135], v[76:79]
    ds_read_b128 v[108:111], v32 offset:49152
    s_waitcnt lgkmcnt(4)
    v_mfma_f32_16x16x32_bf16 v[80:83], v[96:99], v[136:139], v[80:83]
    ds_read_b128 v[112:115], v32 offset:53248
    v_mfma_f32_16x16x32_bf16 v[84:87], v[96:99], v[96:99], v[84:87]
    ds_read_b128 v[116:119], v32 offset:57344
    v_mfma_f32_16x16x32_bf16 v[88:91], v[96:99], v[60:63], v[88:91]
    s_waitcnt lgkmcnt(4)
    v_mfma_f32_16x16x32_bf16 v[64:67], v[92:95], v[100:103], v[64:67]
    ds_read_b128 v[96:99], v23 offset:32768
    s_waitcnt lgkmcnt(4)
    v_mfma_f32_16x16x32_bf16 v[68:71], v[92:95], v[104:107], v[68:71]
    ds_read_b128 v[120:123], v33 offset:40960
    s_waitcnt lgkmcnt(4)
    v_mfma_f32_16x16x32_bf16 v[72:75], v[92:95], v[108:111], v[72:75]
    ds_read_b128 v[124:127], v33 offset:45056
    s_waitcnt lgkmcnt(4)
    v_mfma_f32_16x16x32_bf16 v[76:79], v[92:95], v[112:115], v[76:79]
    ds_read_b128 v[128:131], v33 offset:49152
    s_waitcnt lgkmcnt(4)
    v_mfma_f32_16x16x32_bf16 v[80:83], v[92:95], v[116:119], v[80:83]
    ds_read_b128 v[132:135], v33 offset:53248
    v_mfma_f32_16x16x32_bf16 v[84:87], v[92:95], v[92:95], v[84:87]
    ds_read_b128 v[136:139], v33 offset:57344
    v_mfma_f32_16x16x32_bf16 v[88:91], v[92:95], v[60:63], v[88:91]
    s_waitcnt lgkmcnt(0)
    s_waitcnt vmcnt(5)
    s_barrier
    v_mfma_f32_16x16x32_bf16 v[64:67], v[96:99], v[120:123], v[64:67]
    ds_read_b128 v[92:95], v20 offset:49152
    v_mfma_f32_16x16x32_bf16 v[68:71], v[96:99], v[124:127], v[68:71]
    ds_read_b128 v[100:103], v30 offset:0
    v_mfma_f32_16x16x32_bf16 v[72:75], v[96:99], v[128:131], v[72:75]
    ds_read_b128 v[104:107], v30 offset:4096
    v_mfma_f32_16x16x32_bf16 v[76:79], v[96:99], v[132:135], v[76:79]
    ds_read_b128 v[108:111], v30 offset:8192
    v_mfma_f32_16x16x32_bf16 v[80:83], v[96:99], v[136:139], v[80:83]
    ds_read_b128 v[112:115], v30 offset:12288
    v_mfma_f32_16x16x32_bf16 v[84:87], v[96:99], v[96:99], v[84:87]
    ds_read_b128 v[116:119], v30 offset:16384
    v_mfma_f32_16x16x32_bf16 v[88:91], v[96:99], v[60:63], v[88:91]
    s_waitcnt lgkmcnt(4)
    v_mfma_f32_16x16x32_bf16 v[64:67], v[92:95], v[100:103], v[64:67]
    ds_read_b128 v[96:99], v21 offset:49152
    s_waitcnt lgkmcnt(4)
    v_mfma_f32_16x16x32_bf16 v[68:71], v[92:95], v[104:107], v[68:71]
    ds_read_b128 v[120:123], v31 offset:0
    s_waitcnt lgkmcnt(4)
    v_mfma_f32_16x16x32_bf16 v[72:75], v[92:95], v[108:111], v[72:75]
    ds_read_b128 v[124:127], v31 offset:4096
    s_waitcnt lgkmcnt(4)
    v_mfma_f32_16x16x32_bf16 v[76:79], v[92:95], v[112:115], v[76:79]
    ds_read_b128 v[128:131], v31 offset:8192
    s_waitcnt lgkmcnt(4)
    v_mfma_f32_16x16x32_bf16 v[80:83], v[92:95], v[116:119], v[80:83]
    ds_read_b128 v[132:135], v31 offset:12288
    v_mfma_f32_16x16x32_bf16 v[84:87], v[92:95], v[92:95], v[84:87]
    ds_read_b128 v[136:139], v31 offset:16384
    v_mfma_f32_16x16x32_bf16 v[88:91], v[92:95], v[60:63], v[88:91]
    s_waitcnt lgkmcnt(4)
    v_mfma_f32_16x16x32_bf16 v[64:67], v[96:99], v[120:123], v[64:67]
    ds_read_b128 v[92:95], v22 offset:49152
    s_waitcnt lgkmcnt(4)
    v_mfma_f32_16x16x32_bf16 v[68:71], v[96:99], v[124:127], v[68:71]
    ds_read_b128 v[100:103], v32 offset:0
    s_waitcnt lgkmcnt(4)
    v_mfma_f32_16x16x32_bf16 v[72:75], v[96:99], v[128:131], v[72:75]
    ds_read_b128 v[104:107], v32 offset:4096
    s_waitcnt lgkmcnt(4)
    v_mfma_f32_16x16x32_bf16 v[76:79], v[96:99], v[132:135], v[76:79]
    ds_read_b128 v[108:111], v32 offset:8192
    s_waitcnt lgkmcnt(4)
    v_mfma_f32_16x16x32_bf16 v[80:83], v[96:99], v[136:139], v[80:83]
    ds_read_b128 v[112:115], v32 offset:12288
    v_mfma_f32_16x16x32_bf16 v[84:87], v[96:99], v[96:99], v[84:87]
    ds_read_b128 v[116:119], v32 offset:16384
    v_mfma_f32_16x16x32_bf16 v[88:91], v[96:99], v[60:63], v[88:91]
    s_waitcnt lgkmcnt(4)
    v_mfma_f32_16x16x32_bf16 v[64:67], v[92:95], v[100:103], v[64:67]
    ds_read_b128 v[96:99], v23 offset:49152
    s_waitcnt lgkmcnt(4)
    v_mfma_f32_16x16x32_bf16 v[68:71], v[92:95], v[104:107], v[68:71]
    ds_read_b128 v[120:123], v33 offset:0
    s_waitcnt lgkmcnt(4)
    v_mfma_f32_16x16x32_bf16 v[72:75], v[92:95], v[108:111], v[72:75]
    ds_read_b128 v[124:127], v33 offset:4096
    s_waitcnt lgkmcnt(4)
    v_mfma_f32_16x16x32_bf16 v[76:79], v[92:95], v[112:115], v[76:79]
    ds_read_b128 v[128:131], v33 offset:8192
    s_waitcnt lgkmcnt(4)
    v_mfma_f32_16x16x32_bf16 v[80:83], v[92:95], v[116:119], v[80:83]
    ds_read_b128 v[132:135], v33 offset:12288
    v_mfma_f32_16x16x32_bf16 v[84:87], v[92:95], v[92:95], v[84:87]
    ds_read_b128 v[136:139], v33 offset:16384
    v_mfma_f32_16x16x32_bf16 v[88:91], v[92:95], v[60:63], v[88:91]
    s_waitcnt lgkmcnt(0)
    s_waitcnt vmcnt(0)
    s_barrier
    v_mfma_f32_16x16x32_bf16 v[64:67], v[96:99], v[120:123], v[64:67]
    ds_read_b128 v[92:95], v24
    v_mfma_f32_16x16x32_bf16 v[68:71], v[96:99], v[124:127], v[68:71]
    ds_read_b128 v[100:103], v30 offset:20480
    v_mfma_f32_16x16x32_bf16 v[72:75], v[96:99], v[128:131], v[72:75]
    ds_read_b128 v[104:107], v30 offset:24576
    v_mfma_f32_16x16x32_bf16 v[76:79], v[96:99], v[132:135], v[76:79]
    ds_read_b128 v[108:111], v30 offset:28672
    v_mfma_f32_16x16x32_bf16 v[80:83], v[96:99], v[136:139], v[80:83]
    ds_read_b128 v[112:115], v30 offset:32768
    v_mfma_f32_16x16x32_bf16 v[84:87], v[96:99], v[96:99], v[84:87]
    ds_read_b128 v[116:119], v30 offset:36864
    v_mfma_f32_16x16x32_bf16 v[88:91], v[96:99], v[60:63], v[88:91]
    s_waitcnt lgkmcnt(4)
    v_mfma_f32_16x16x32_bf16 v[64:67], v[92:95], v[100:103], v[64:67]
    ds_read_b128 v[96:99], v25
    s_waitcnt lgkmcnt(4)
    v_mfma_f32_16x16x32_bf16 v[68:71], v[92:95], v[104:107], v[68:71]
    ds_read_b128 v[120:123], v31 offset:20480
    s_waitcnt lgkmcnt(4)
    v_mfma_f32_16x16x32_bf16 v[72:75], v[92:95], v[108:111], v[72:75]
    ds_read_b128 v[124:127], v31 offset:24576
    s_waitcnt lgkmcnt(4)
    v_mfma_f32_16x16x32_bf16 v[76:79], v[92:95], v[112:115], v[76:79]
    ds_read_b128 v[128:131], v31 offset:28672
    s_waitcnt lgkmcnt(4)
    v_mfma_f32_16x16x32_bf16 v[80:83], v[92:95], v[116:119], v[80:83]
    ds_read_b128 v[132:135], v31 offset:32768
    v_mfma_f32_16x16x32_bf16 v[84:87], v[92:95], v[92:95], v[84:87]
    ds_read_b128 v[136:139], v31 offset:36864
    v_mfma_f32_16x16x32_bf16 v[88:91], v[92:95], v[60:63], v[88:91]
    s_waitcnt lgkmcnt(4)
    v_mfma_f32_16x16x32_bf16 v[64:67], v[96:99], v[120:123], v[64:67]
    ds_read_b128 v[92:95], v26
    s_waitcnt lgkmcnt(4)
    v_mfma_f32_16x16x32_bf16 v[68:71], v[96:99], v[124:127], v[68:71]
    ds_read_b128 v[100:103], v32 offset:20480
    s_waitcnt lgkmcnt(4)
    v_mfma_f32_16x16x32_bf16 v[72:75], v[96:99], v[128:131], v[72:75]
    ds_read_b128 v[104:107], v32 offset:24576
    s_waitcnt lgkmcnt(4)
    v_mfma_f32_16x16x32_bf16 v[76:79], v[96:99], v[132:135], v[76:79]
    ds_read_b128 v[108:111], v32 offset:28672
    s_waitcnt lgkmcnt(4)
    v_mfma_f32_16x16x32_bf16 v[80:83], v[96:99], v[136:139], v[80:83]
    ds_read_b128 v[112:115], v32 offset:32768
    v_mfma_f32_16x16x32_bf16 v[84:87], v[96:99], v[96:99], v[84:87]
    ds_read_b128 v[116:119], v32 offset:36864
    v_mfma_f32_16x16x32_bf16 v[88:91], v[96:99], v[60:63], v[88:91]
    s_waitcnt lgkmcnt(4)
    v_mfma_f32_16x16x32_bf16 v[64:67], v[92:95], v[100:103], v[64:67]
    ds_read_b128 v[96:99], v27
    s_waitcnt lgkmcnt(4)
    v_mfma_f32_16x16x32_bf16 v[68:71], v[92:95], v[104:107], v[68:71]
    ds_read_b128 v[120:123], v33 offset:20480
    s_waitcnt lgkmcnt(4)
    v_mfma_f32_16x16x32_bf16 v[72:75], v[92:95], v[108:111], v[72:75]
    ds_read_b128 v[124:127], v33 offset:24576
    s_waitcnt lgkmcnt(4)
    v_mfma_f32_16x16x32_bf16 v[76:79], v[92:95], v[112:115], v[76:79]
    ds_read_b128 v[128:131], v33 offset:28672
    s_waitcnt lgkmcnt(4)
    v_mfma_f32_16x16x32_bf16 v[80:83], v[92:95], v[116:119], v[80:83]
    ds_read_b128 v[132:135], v33 offset:32768
    v_mfma_f32_16x16x32_bf16 v[84:87], v[92:95], v[92:95], v[84:87]
    ds_read_b128 v[136:139], v33 offset:36864
    v_mfma_f32_16x16x32_bf16 v[88:91], v[92:95], v[60:63], v[88:91]
    s_waitcnt lgkmcnt(4)
    v_mfma_f32_16x16x32_bf16 v[64:67], v[96:99], v[120:123], v[64:67]
    s_waitcnt lgkmcnt(3)
    v_mfma_f32_16x16x32_bf16 v[68:71], v[96:99], v[124:127], v[68:71]
    s_waitcnt lgkmcnt(2)
    v_mfma_f32_16x16x32_bf16 v[72:75], v[96:99], v[128:131], v[72:75]
    s_waitcnt lgkmcnt(1)
    v_mfma_f32_16x16x32_bf16 v[76:79], v[96:99], v[132:135], v[76:79]
    s_waitcnt lgkmcnt(0)
    v_mfma_f32_16x16x32_bf16 v[80:83], v[96:99], v[136:139], v[80:83]
    v_mfma_f32_16x16x32_bf16 v[84:87], v[96:99], v[96:99], v[84:87]
    v_mfma_f32_16x16x32_bf16 v[88:91], v[96:99], v[60:63], v[88:91]
    v_and_b32 v236, 1, v0
    v_lshlrev_b32 v236, 7, v236
    v_bfe_u32 v3, v0, 1, 2
    v_lshl_add_u32 v236, v3, 4, v236
    buffer_load_dword v237, v236, s[88:91], 0 offen sc1
    s_mul_i32 s50, s72, 160
    v_lshl_add_u32 v3, v14, 3, s50
    v_lshrrev_b32 v4, 8, v3
    v_bfe_u32 v5, v3, 4, 4
    v_xor_b32 v5, v5, v15
    v_lshlrev_b32 v4, 14, v4
    v_lshl_add_u32 v4, v5, 4, v4
    v_and_b32 v5, 8, v3
    v_add_u32 v4, v4, v5
    v_lshl_add_u32 v4, v15, 8, v4
    v_add_u32 v4, s31, v4
    ds_read_b64 v[240:241], v4
    v_add_u32 v3, 32, v3
    v_lshrrev_b32 v4, 8, v3
    v_bfe_u32 v5, v3, 4, 4
    v_xor_b32 v5, v5, v15
    v_lshlrev_b32 v4, 14, v4
    v_lshl_add_u32 v4, v5, 4, v4
    v_and_b32 v5, 8, v3
    v_add_u32 v4, v4, v5
    v_lshl_add_u32 v4, v15, 8, v4
    v_add_u32 v4, s31, v4
    ds_read_b64 v[242:243], v4
    v_add_u32 v3, 32, v3
    v_lshrrev_b32 v4, 8, v3
    v_bfe_u32 v5, v3, 4, 4
    v_xor_b32 v5, v5, v15
    v_lshlrev_b32 v4, 14, v4
    v_lshl_add_u32 v4, v5, 4, v4
    v_and_b32 v5, 8, v3
    v_add_u32 v4, v4, v5
    v_lshl_add_u32 v4, v15, 8, v4
    v_add_u32 v4, s31, v4
    ds_read_b64 v[244:245], v4
    v_add_u32 v3, 32, v3
    v_lshrrev_b32 v4, 8, v3
    v_bfe_u32 v5, v3, 4, 4
    v_xor_b32 v5, v5, v15
    v_lshlrev_b32 v4, 14, v4
    v_lshl_add_u32 v4, v5, 4, v4
    v_and_b32 v5, 8, v3
    v_add_u32 v4, v4, v5
    v_lshl_add_u32 v4, v15, 8, v4
    v_add_u32 v4, s31, v4
    ds_read_b64 v[246:247], v4
    v_add_u32 v3, 32, v3
    v_lshrrev_b32 v4, 8, v3
    v_bfe_u32 v5, v3, 4, 4
    v_xor_b32 v5, v5, v15
    v_lshlrev_b32 v4, 14, v4
    v_lshl_add_u32 v4, v5, 4, v4
    v_and_b32 v5, 8, v3
    v_add_u32 v4, v4, v5
    v_lshl_add_u32 v4, v15, 8, v4
    v_add_u32 v4, s31, v4
    ds_read_b64 v[248:249], v4
    v_mul_u32_u24 v3, 80, v14
    v_add_u32 v4, 0, v3
    ds_bpermute_b32 v52, v4, v84
    v_add_u32 v4, 4, v3
    ds_bpermute_b32 v53, v4, v85
    v_add_u32 v4, 8, v3
    ds_bpermute_b32 v54, v4, v86
    v_add_u32 v4, 12, v3
    ds_bpermute_b32 v55, v4, v87
    v_mul_f32 v88, 0x3acccccd, v88
    s_waitcnt lgkmcnt(3)
    v_mul_f32 v52, 0x3acccccd, v52
    v_fma_f32 v52, -v88, v88, v52
    v_add_f32 v52, 0x3727c5ac, v52
    v_rsq_f32 v48, v52
    v_mul_f32 v89, 0x3acccccd, v89
    s_waitcnt lgkmcnt(2)
    v_mul_f32 v53, 0x3acccccd, v53
    v_fma_f32 v53, -v89, v89, v53
    v_add_f32 v53, 0x3727c5ac, v53
    v_rsq_f32 v49, v53
    v_mul_f32 v90, 0x3acccccd, v90
    s_waitcnt lgkmcnt(1)
    v_mul_f32 v54, 0x3acccccd, v54
    v_fma_f32 v54, -v90, v90, v54
    v_add_f32 v54, 0x3727c5ac, v54
    v_rsq_f32 v50, v54
    v_mul_f32 v91, 0x3acccccd, v91
    s_waitcnt lgkmcnt(0)
    v_mul_f32 v55, 0x3acccccd, v55
    v_fma_f32 v55, -v91, v91, v55
    v_add_f32 v55, 0x3727c5ac, v55
    v_rsq_f32 v51, v55
    v_mul_f32 v64, v64, v48
    v_mul_f32 v65, v65, v49
    v_mul_f32 v66, v66, v50
    v_mul_f32 v67, v67, v51
    v_cvt_pk_bf16_f32 v140, v64, v65
    v_cvt_pk_bf16_f32 v141, v66, v67
    v_mul_f32 v68, v68, v48
    v_mul_f32 v69, v69, v49
    v_mul_f32 v70, v70, v50
    v_mul_f32 v71, v71, v51
    v_cvt_pk_bf16_f32 v142, v68, v69
    v_cvt_pk_bf16_f32 v143, v70, v71
    v_mul_f32 v72, v72, v48
    v_mul_f32 v73, v73, v49
    v_mul_f32 v74, v74, v50
    v_mul_f32 v75, v75, v51
    v_cvt_pk_bf16_f32 v144, v72, v73
    v_cvt_pk_bf16_f32 v145, v74, v75
    v_mul_f32 v76, v76, v48
    v_mul_f32 v77, v77, v49
    v_mul_f32 v78, v78, v50
    v_mul_f32 v79, v79, v51
    v_cvt_pk_bf16_f32 v146, v76, v77
    v_cvt_pk_bf16_f32 v147, v78, v79
    v_mul_f32 v80, v80, v48
    v_mul_f32 v81, v81, v49
    v_mul_f32 v82, v82, v50
    v_mul_f32 v83, v83, v51
    v_cvt_pk_bf16_f32 v148, v80, v81
    v_cvt_pk_bf16_f32 v149, v82, v83
    v_mfma_f32_16x16x16_bf16 v[96:99], v[250:251], v[140:141], 0
    v_mfma_f32_16x16x16_bf16 v[116:119], v[252:253], v[140:141], 0
    v_mfma_f32_16x16x16_bf16 v[100:103], v[250:251], v[142:143], 0
    v_mfma_f32_16x16x16_bf16 v[120:123], v[252:253], v[142:143], 0
    v_mfma_f32_16x16x16_bf16 v[104:107], v[250:251], v[144:145], 0
    v_mfma_f32_16x16x16_bf16 v[124:127], v[252:253], v[144:145], 0
    v_mfma_f32_16x16x16_bf16 v[108:111], v[250:251], v[146:147], 0
    v_mfma_f32_16x16x16_bf16 v[128:131], v[252:253], v[146:147], 0
    v_mfma_f32_16x16x16_bf16 v[112:115], v[250:251], v[148:149], 0
    v_mfma_f32_16x16x16_bf16 v[132:135], v[252:253], v[148:149], 0
    v_fmac_f32_dpp v96, v116, v45 row_ror:8 row_mask:0xf bank_mask:0xf
    v_fmac_f32_dpp v97, v117, v45 row_ror:8 row_mask:0xf bank_mask:0xf
    v_fmac_f32_dpp v98, v118, v45 row_ror:8 row_mask:0xf bank_mask:0xf
    v_fmac_f32_dpp v99, v119, v45 row_ror:8 row_mask:0xf bank_mask:0xf
    v_cvt_pk_bf16_f32 v64, v96, v97
    ds_write_b16 v44, v64 offset:0
    ds_write_b16_d16_hi v44, v64 offset:640
    v_cvt_pk_bf16_f32 v65, v98, v99
    ds_write_b16 v44, v65 offset:1280
    ds_write_b16_d16_hi v44, v65 offset:1920
    v_fmac_f32_dpp v100, v120, v45 row_ror:8 row_mask:0xf bank_mask:0xf
    v_fmac_f32_dpp v101, v121, v45 row_ror:8 row_mask:0xf bank_mask:0xf
    v_fmac_f32_dpp v102, v122, v45 row_ror:8 row_mask:0xf bank_mask:0xf
    v_fmac_f32_dpp v103, v123, v45 row_ror:8 row_mask:0xf bank_mask:0xf
    v_cvt_pk_bf16_f32 v66, v100, v101
    ds_write_b16 v44, v66 offset:128
    ds_write_b16_d16_hi v44, v66 offset:768
    v_cvt_pk_bf16_f32 v67, v102, v103
    ds_write_b16 v44, v67 offset:1408
    ds_write_b16_d16_hi v44, v67 offset:2048
    v_fmac_f32_dpp v104, v124, v45 row_ror:8 row_mask:0xf bank_mask:0xf
    v_fmac_f32_dpp v105, v125, v45 row_ror:8 row_mask:0xf bank_mask:0xf
    v_fmac_f32_dpp v106, v126, v45 row_ror:8 row_mask:0xf bank_mask:0xf
    v_fmac_f32_dpp v107, v127, v45 row_ror:8 row_mask:0xf bank_mask:0xf
    v_cvt_pk_bf16_f32 v68, v104, v105
    ds_write_b16 v44, v68 offset:256
    ds_write_b16_d16_hi v44, v68 offset:896
    v_cvt_pk_bf16_f32 v69, v106, v107
    ds_write_b16 v44, v69 offset:1536
    ds_write_b16_d16_hi v44, v69 offset:2176
    v_fmac_f32_dpp v108, v128, v45 row_ror:8 row_mask:0xf bank_mask:0xf
    v_fmac_f32_dpp v109, v129, v45 row_ror:8 row_mask:0xf bank_mask:0xf
    v_fmac_f32_dpp v110, v130, v45 row_ror:8 row_mask:0xf bank_mask:0xf
    v_fmac_f32_dpp v111, v131, v45 row_ror:8 row_mask:0xf bank_mask:0xf
    v_cvt_pk_bf16_f32 v70, v108, v109
    ds_write_b16 v44, v70 offset:384
    ds_write_b16_d16_hi v44, v70 offset:1024
    v_cvt_pk_bf16_f32 v71, v110, v111
    ds_write_b16 v44, v71 offset:1664
    ds_write_b16_d16_hi v44, v71 offset:2304
    v_fmac_f32_dpp v112, v132, v45 row_ror:8 row_mask:0xf bank_mask:0xf
    v_fmac_f32_dpp v113, v133, v45 row_ror:8 row_mask:0xf bank_mask:0xf
    v_fmac_f32_dpp v114, v134, v45 row_ror:8 row_mask:0xf bank_mask:0xf
    v_fmac_f32_dpp v115, v135, v45 row_ror:8 row_mask:0xf bank_mask:0xf
    v_cvt_pk_bf16_f32 v72, v112, v113
    ds_write_b16 v44, v72 offset:512
    ds_write_b16_d16_hi v44, v72 offset:1152
    v_cvt_pk_bf16_f32 v73, v114, v115
    ds_write_b16 v44, v73 offset:1792
    ds_write_b16_d16_hi v44, v73 offset:2432
    s_waitcnt lgkmcnt(0)
    s_barrier
    ds_read_b128 v[74:77], v41
    ds_read_b128 v[78:81], v42
    ds_read_b128 v[82:85], v43
    s_waitcnt lgkmcnt(2)
    buffer_store_dwordx4 v[74:77], v38, s[4:7], s54 offen sc1
    s_waitcnt lgkmcnt(1)
    buffer_store_dwordx4 v[78:81], v39, s[4:7], s54 offen sc1
    s_waitcnt lgkmcnt(0)
    s_cmp_ge_u32 s20, 2
    s_cbranch_scc1 L3_zs
    buffer_store_dwordx4 v[82:85], v40, s[4:7], s54 offen sc1
L3_zs:
    s_mov_b32 s62, 0
    s_waitcnt vmcnt(2)
    v_cmp_gt_u32 vcc, 32, v237
    s_nop 1
    s_cmp_eq_u64 vcc, 0
    s_cbranch_scc1 L5_icd
L4_ic:
    buffer_load_dword v237, v236, s[88:91], 0 offen sc1
    s_waitcnt vmcnt(0)
    v_cmp_gt_u32 vcc, 32, v237
    s_add_u32 s62, s62, 1
    s_nop 1
    s_cmp_eq_u64 vcc, 0
    s_cbranch_scc1 L5_icd
    s_cmp_lt_u32 s62, 65536
    s_cbranch_scc1 L4_ic
L5_icd:
    s_waitcnt vmcnt(0)
    s_waitcnt vmcnt(0)
    s_barrier
    s_mul_i32 s61, s72, 256
    s_add_u32 s63, s61, 34410496
    s_add_u32 s61, s61, 34408448
    s_cmp_lg_u32 s20, 0
    s_cbranch_scc1 L7_ol
    s_mov_b64 exec, 1
    v_mov_b32 v254, 1
    v_mov_b32 v255, 0
    buffer_atomic_add v254, v255, s[4:7], s61 offen sc0 sc1
    s_mov_b64 exec, -1
L7_ol:
    s_cmp_ge_u32 s21, 135
    s_cbranch_scc1 L8_pwd
    s_mul_i32 s40, s21, 205
    s_lshr_b32 s40, s40, 10
    s_mul_i32 s41, s40, 5
    s_sub_u32 s41, s21, s41
    v_lshrrev_b32 v1, 3, v0
    v_and_b32 v2, 7, v0
    v_and_b32 v3, 2, v1
    v_xor_b32 v4, v2, v3
    v_xor_b32 v5, 4, v4
    v_mul_u32_u24 v6, 3456, v1
    v_lshl_add_u32 v4, v4, 4, v6
    v_lshl_add_u32 v5, v5, 4, v6
    s_lshl_b32 s42, s41, 7
    s_lshl_b32 s43, s20, 5
    s_add_u32 s42, s42, s43
    s_mul_i32 s42, s42, 3456
    s_lshl_b32 s43, s40, 7
    s_add_u32 s42, s42, s43
    s_lshl_b32 s47, s20, 12
    s_add_u32 s47, s47, 81920
    s_add_u32 m0, s47, 0
    s_add_u32 s45, s42, 0
    buffer_load_dwordx4 v4, s[76:79], s45 offen lds
    s_add_u32 m0, s47, 16384
    s_nop 0
    buffer_load_dwordx4 v5, s[80:83], s45 offen lds
    s_add_u32 m0, s47, 1024
    s_add_u32 s45, s42, 27648
    buffer_load_dwordx4 v4, s[76:79], s45 offen lds
    s_add_u32 m0, s47, 17408
    s_nop 0
    buffer_load_dwordx4 v5, s[80:83], s45 offen lds
    s_add_u32 m0, s47, 2048
    s_add_u32 s45, s42, 55296
    buffer_load_dwordx4 v4, s[76:79], s45 offen lds
    s_add_u32 m0, s47, 18432
    s_nop 0
    buffer_load_dwordx4 v5, s[80:83], s45 offen lds
    s_add_u32 m0, s47, 3072
    s_add_u32 s45, s42, 82944
    buffer_load_dwordx4 v4, s[76:79], s45 offen lds
    s_add_u32 m0, s47, 19456
    s_nop 0
    buffer_load_dwordx4 v5, s[80:83], s45 offen lds
    s_branch L9_pe1
L8_pwd:
    s_sub_u32 s40, s21, 135
    s_sub_u32 s43, s40, 108
    s_cmp_ge_u32 s40, 108
    s_cselect_b32 s40, s43, s40
    s_mul_i32 s42, s40, 20480
    s_mul_i32 s43, s20, 5
    s_add_u32 s43, s43, 0
    s_lshl_b32 s47, s43, 6
    v_add_u32 v1, s47, v0
    v_mul_u32_u24 v2, 1639, v1
    v_lshrrev_b32 v2, 17, v2
    v_mul_u32_u24 v3, 80, v2
    v_sub_u32 v3, v1, v3
    v_and_b32 v4, 3, v2
    v_bfe_u32 v5, v2, 3, 1
    v_lshl_or_b32 v4, v5, 2, v4
    v_lshlrev_b32 v4, 1, v4
    v_xor_b32 v3, v3, v4
    v_mul_u32_u24 v2, 1280, v2
    v_lshl_add_u32 v6, v3, 4, v2
    s_lshl_b32 s47, s43, 10
    s_add_u32 m0, s47, 81920
    s_nop 0
    buffer_load_dwordx4 v6, s[84:87], s42 offen lds
    s_mul_i32 s43, s20, 5
    s_add_u32 s43, s43, 1
    s_lshl_b32 s47, s43, 6
    v_add_u32 v1, s47, v0
    v_mul_u32_u24 v2, 1639, v1
    v_lshrrev_b32 v2, 17, v2
    v_mul_u32_u24 v3, 80, v2
    v_sub_u32 v3, v1, v3
    v_and_b32 v4, 3, v2
    v_bfe_u32 v5, v2, 3, 1
    v_lshl_or_b32 v4, v5, 2, v4
    v_lshlrev_b32 v4, 1, v4
    v_xor_b32 v3, v3, v4
    v_mul_u32_u24 v2, 1280, v2
    v_lshl_add_u32 v6, v3, 4, v2
    s_lshl_b32 s47, s43, 10
    s_add_u32 m0, s47, 81920
    s_nop 0
    buffer_load_dwordx4 v6, s[84:87], s42 offen lds
    s_mul_i32 s43, s20, 5
    s_add_u32 s43, s43, 2
    s_lshl_b32 s47, s43, 6
    v_add_u32 v1, s47, v0
    v_mul_u32_u24 v2, 1639, v1
    v_lshrrev_b32 v2, 17, v2
    v_mul_u32_u24 v3, 80, v2
    v_sub_u32 v3, v1, v3
    v_and_b32 v4, 3, v2
    v_bfe_u32 v5, v2, 3, 1
    v_lshl_or_b32 v4, v5, 2, v4
    v_lshlrev_b32 v4, 1, v4
    v_xor_b32 v3, v3, v4
    v_mul_u32_u24 v2, 1280, v2
    v_lshl_add_u32 v6, v3, 4, v2
    s_lshl_b32 s47, s43, 10
    s_add_u32 m0, s47, 81920
    s_nop 0
    buffer_load_dwordx4 v6, s[84:87], s42 offen lds
    s_mul_i32 s43, s20, 5
    s_add_u32 s43, s43, 3
    s_lshl_b32 s47, s43, 6
    v_add_u32 v1, s47, v0
    v_mul_u32_u24 v2, 1639, v1
    v_lshrrev_b32 v2, 17, v2
    v_mul_u32_u24 v3, 80, v2
    v_sub_u32 v3, v1, v3
    v_and_b32 v4, 3, v2
    v_bfe_u32 v5, v2, 3, 1
    v_lshl_or_b32 v4, v5, 2, v4
    v_lshlrev_b32 v4, 1, v4
    v_xor_b32 v3, v3, v4
    v_mul_u32_u24 v2, 1280, v2
    v_lshl_add_u32 v6, v3, 4, v2
    s_lshl_b32 s47, s43, 10
    s_add_u32 m0, s47, 81920
    s_nop 0
    buffer_load_dwordx4 v6, s[84:87], s42 offen lds
    s_mul_i32 s43, s20, 5
    s_add_u32 s43, s43, 4
    s_lshl_b32 s47, s43, 6
    v_add_u32 v1, s47, v0
    v_mul_u32_u24 v2, 1639, v1
    v_lshrrev_b32 v2, 17, v2
    v_mul_u32_u24 v3, 80, v2
    v_sub_u32 v3, v1, v3
    v_and_b32 v4, 3, v2
    v_bfe_u32 v5, v2, 3, 1
    v_lshl_or_b32 v4, v5, 2, v4
    v_lshlrev_b32 v4, 1, v4
    v_xor_b32 v3, v3, v4
    v_mul_u32_u24 v2, 1280, v2
    v_lshl_add_u32 v6, v3, 4, v2
    s_lshl_b32 s47, s43, 10
    s_add_u32 m0, s47, 81920
    s_nop 0
    buffer_load_dwordx4 v6, s[84:87], s42 offen lds
    buffer_load_dwordx4 v6, s[84:87], s42 offen lds
    buffer_load_dwordx4 v6, s[84:87], s42 offen lds
    buffer_load_dwordx4 v6, s[84:87], s42 offen lds
L9_pe1:
    s_mov_b32 s22, s70
    s_mov_b32 s23, s71
    s_mov_b32 s24, s72
    v_and_b32 v1, 15, v0
    v_lshrrev_b32 v2, 4, v0
    v_lshlrev_b32 v12, 4, v0
    s_sub_u32 s28, 16, s22
    s_and_b32 s28, s28, 15
    s_cmp_lt_u32 s24, 4
    s_cselect_b32 s28, s22, s28
    s_mul_i32 s29, s24, 80
    s_sub_u32 s30, 640, s29
    s_cmp_lt_u32 s24, 4
    s_cselect_b32 s29, s29, s30
    s_cselect_b32 s32, 16, -16
    s_lshl_b32 s31, s32, 4
    v_mul_lo_u32 v3, s32, v1
    v_mul_u32_u24 v4, 5120, v2
    v_add_u32 v3, v3, v4
    s_lshl_b32 s33, s29, 4
    v_add_u32 v10, s33, v3
    s_cmp_eq_u32 s24, 4
    s_cselect_b32 s33, 5120, 0
    v_cmp_eq_u32 vcc, 0, v1
    v_mov_b32 v5, s33
    s_nop 0
    v_cndmask_b32 v5, 0, v5, vcc
    v_sub_u32 v11, v10, v5
    s_mul_i32 s34, s28, 163840
    s_mul_i32 s35, s20, 40960
    s_add_u32 s34, s34, s35
    s_mul_i32 s35, s20, 10240
    s_lshl_b32 s38, s23, 2
    s_add_u32 s38, s38, s20
    s_cmp_lg_u32 s20, 0
    s_cbranch_scc1 L10_ol
    s_mov_b64 exec, 1
    s_waitcnt vmcnt(8)
    v_readfirstlane_b32 s62, v254
    s_nop 3
    s_cmp_lg_u32 s62, 31
    s_cbranch_scc1 L6_rel
    v_mov_b32 v254, 1
    v_mov_b32 v255, 0
    buffer_store_dword v254, v255, s[4:7], s63 offen sc1
L6_rel:
    s_mov_b64 exec, -1
L10_ol:
    v_and_b32 v48, 15, v0
    v_lshrrev_b32 v49, 4, v0
    s_lshl_b32 s55, s71, 2
    s_add_u32 s55, s55, s20
    s_lshl_b32 s55, s55, 4
    s_add_u32 s55, s55, s70
    v_lshl_add_u32 v48, v48, 7, s55
    v_lshrrev_b32 v50, 1, v49
    v_and_b32 v49, 1, v49
    v_lshl_add_u32 v49, v49, 6, v50
    s_cmp_lt_u32 s72, 4
    s_mov_b32 s56, 0x3a000000
    s_cselect_b32 s56, s56, 0xba000000
    v_cvt_f32_u32 v48, v48
    v_cvt_f32_u32 v49, v49
    v_mul_f32 v48, s56, v48
    v_mul_f32 v49, v48, v49
    v_add_f32 v50, v48, v48
    v_mul_f32 v48, 0x41800000, v48
    v_fract_f32 v51, v49
    v_add_f32 v52, v49, v48
    v_add_f32 v53, v52, v48
    v_add_f32 v54, v53, v48
    v_fract_f32 v52, v52
    v_fract_f32 v53, v53
    v_fract_f32 v54, v54
    v_add_f32 v49, v49, v50
    v_cos_f32 v55, v51
    v_cos_f32 v56, v52
    v_cos_f32 v57, v53
    v_cos_f32 v58, v54
    v_sin_f32 v51, v51
    v_sin_f32 v52, v52
    v_sin_f32 v53, v53
    v_sin_f32 v54, v54
    v_cvt_pk_bf16_f32 v55, v55, v56
    v_cvt_pk_bf16_f32 v56, v57, v58
    v_cvt_pk_bf16_f32 v51, v51, v52
    v_cvt_pk_bf16_f32 v52, v53, v54
    v_accvgpr_write_b32 a128, v55
    v_accvgpr_write_b32 a129, v56
    v_accvgpr_write_b32 a130, v51
    v_accvgpr_write_b32 a131, v52
    v_fract_f32 v51, v49
    v_add_f32 v52, v49, v48
    v_add_f32 v53, v52, v48
    v_add_f32 v54, v53, v48
    v_fract_f32 v52, v52
    v_fract_f32 v53, v53
    v_fract_f32 v54, v54
    v_add_f32 v49, v49, v50
    v_cos_f32 v55, v51
    v_cos_f32 v56, v52
    v_cos_f32 v57, v53
    v_cos_f32 v58, v54
    v_sin_f32 v51, v51
    v_sin_f32 v52, v52
    v_sin_f32 v53, v53
    v_sin_f32 v54, v54
    v_cvt_pk_bf16_f32 v55, v55, v56
    v_cvt_pk_bf16_f32 v56, v57, v58
    v_cvt_pk_bf16_f32 v51, v51, v52
    v_cvt_pk_bf16_f32 v52, v53, v54
    v_accvgpr_write_b32 a132, v55
    v_accvgpr_write_b32 a133, v56
    v_accvgpr_write_b32 a134, v51
    v_accvgpr_write_b32 a135, v52
    v_fract_f32 v51, v49
    v_add_f32 v52, v49, v48
    v_add_f32 v53, v52, v48
    v_add_f32 v54, v53, v48
    v_fract_f32 v52, v52
    v_fract_f32 v53, v53
    v_fract_f32 v54, v54
    v_add_f32 v49, v49, v50
    v_cos_f32 v55, v51
    v_cos_f32 v56, v52
    v_cos_f32 v57, v53
    v_cos_f32 v58, v54
    v_sin_f32 v51, v51
    v_sin_f32 v52, v52
    v_sin_f32 v53, v53
    v_sin_f32 v54, v54
    v_cvt_pk_bf16_f32 v55, v55, v56
    v_cvt_pk_bf16_f32 v56, v57, v58
    v_cvt_pk_bf16_f32 v51, v51, v52
    v_cvt_pk_bf16_f32 v52, v53, v54
    v_accvgpr_write_b32 a136, v55
    v_accvgpr_write_b32 a137, v56
    v_accvgpr_write_b32 a138, v51
    v_accvgpr_write_b32 a139, v52
    v_fract_f32 v51, v49
    v_add_f32 v52, v49, v48
    v_add_f32 v53, v52, v48
    v_add_f32 v54, v53, v48
    v_fract_f32 v52, v52
    v_fract_f32 v53, v53
    v_fract_f32 v54, v54
    v_add_f32 v49, v49, v50
    v_cos_f32 v55, v51
    v_cos_f32 v56, v52
    v_cos_f32 v57, v53
    v_cos_f32 v58, v54
    v_sin_f32 v51, v51
    v_sin_f32 v52, v52
    v_sin_f32 v53, v53
    v_sin_f32 v54, v54
    v_cvt_pk_bf16_f32 v55, v55, v56
    v_cvt_pk_bf16_f32 v56, v57, v58
    v_cvt_pk_bf16_f32 v51, v51, v52
    v_cvt_pk_bf16_f32 v52, v53, v54
    v_accvgpr_write_b32 a140, v55
    v_accvgpr_write_b32 a141, v56
    v_accvgpr_write_b32 a142, v51
    v_accvgpr_write_b32 a143, v52
    v_fract_f32 v51, v49
    v_add_f32 v52, v49, v48
    v_add_f32 v53, v52, v48
    v_add_f32 v54, v53, v48
    v_fract_f32 v52, v52
    v_fract_f32 v53, v53
    v_fract_f32 v54, v54
    v_add_f32 v49, v49, v50
    v_cos_f32 v55, v51
    v_cos_f32 v56, v52
    v_cos_f32 v57, v53
    v_cos_f32 v58, v54
    v_sin_f32 v51, v51
    v_sin_f32 v52, v52
    v_sin_f32 v53, v53
    v_sin_f32 v54, v54
    v_cvt_pk_bf16_f32 v55, v55, v56
    v_cvt_pk_bf16_f32 v56, v57, v58
    v_cvt_pk_bf16_f32 v51, v51, v52
    v_cvt_pk_bf16_f32 v52, v53, v54
    v_accvgpr_write_b32 a144, v55
    v_accvgpr_write_b32 a145, v56
    v_accvgpr_write_b32 a146, v51
    v_accvgpr_write_b32 a147, v52
    v_fract_f32 v51, v49
    v_add_f32 v52, v49, v48
    v_add_f32 v53, v52, v48
    v_add_f32 v54, v53, v48
    v_fract_f32 v52, v52
    v_fract_f32 v53, v53
    v_fract_f32 v54, v54
    v_add_f32 v49, v49, v50
    v_cos_f32 v55, v51
    v_cos_f32 v56, v52
    v_cos_f32 v57, v53
    v_cos_f32 v58, v54
    v_sin_f32 v51, v51
    v_sin_f32 v52, v52
    v_sin_f32 v53, v53
    v_sin_f32 v54, v54
    v_cvt_pk_bf16_f32 v55, v55, v56
    v_cvt_pk_bf16_f32 v56, v57, v58
    v_cvt_pk_bf16_f32 v51, v51, v52
    v_cvt_pk_bf16_f32 v52, v53, v54
    v_accvgpr_write_b32 a148, v55
    v_accvgpr_write_b32 a149, v56
    v_accvgpr_write_b32 a150, v51
    v_accvgpr_write_b32 a151, v52
    v_fract_f32 v51, v49
    v_add_f32 v52, v49, v48
    v_add_f32 v53, v52, v48
    v_add_f32 v54, v53, v48
    v_fract_f32 v52, v52
    v_fract_f32 v53, v53
    v_fract_f32 v54, v54
    v_add_f32 v49, v49, v50
    v_cos_f32 v55, v51
    v_cos_f32 v56, v52
    v_cos_f32 v57, v53
    v_cos_f32 v58, v54
    v_sin_f32 v51, v51
    v_sin_f32 v52, v52
    v_sin_f32 v53, v53
    v_sin_f32 v54, v54
    v_cvt_pk_bf16_f32 v55, v55, v56
    v_cvt_pk_bf16_f32 v56, v57, v58
    v_cvt_pk_bf16_f32 v51, v51, v52
    v_cvt_pk_bf16_f32 v52, v53, v54
    v_accvgpr_write_b32 a152, v55
    v_accvgpr_write_b32 a153, v56
    v_accvgpr_write_b32 a154, v51
    v_accvgpr_write_b32 a155, v52
    v_fract_f32 v51, v49
    v_add_f32 v52, v49, v48
    v_add_f32 v53, v52, v48
    v_add_f32 v54, v53, v48
    v_fract_f32 v52, v52
    v_fract_f32 v53, v53
    v_fract_f32 v54, v54
    v_cos_f32 v55, v51
    v_cos_f32 v56, v52
    v_cos_f32 v57, v53
    v_cos_f32 v58, v54
    v_sin_f32 v51, v51
    v_sin_f32 v52, v52
    v_sin_f32 v53, v53
    v_sin_f32 v54, v54
    v_cvt_pk_bf16_f32 v55, v55, v56
    v_cvt_pk_bf16_f32 v56, v57, v58
    v_cvt_pk_bf16_f32 v51, v51, v52
    v_cvt_pk_bf16_f32 v52, v53, v54
    v_accvgpr_write_b32 a156, v55
    v_accvgpr_write_b32 a157, v56
    v_accvgpr_write_b32 a158, v51
    v_accvgpr_write_b32 a159, v52
    s_lshl_b32 s50, s72, 1
    s_sub_u32 s51, 14, s50
    s_cmp_lt_u32 s72, 4
    s_cselect_b32 s52, s50, s51
    s_add_u32 s53, s52, 1
    s_add_u32 s54, s52, 2
    s_and_b32 s54, s54, 7
    s_cmp_lt_u32 s72, 4
    s_cselect_b32 s54, s52, s54
    s_cmp_eq_u32 s20, 0
    s_cbranch_scc1 L11_ct
    s_getpc_b64 s[58:59]
L12_cp:
    s_sub_u32 s60, s20, 1
    s_lshl_b32 s60, s60, 13
    v_lshlrev_b32 v222, 7, v0
    v_add_u32 v222, s60, v222
    s_mov_b32 s60, L_exit-L12_cp
    v_min_u32 v222, s60, v222
    v_mov_b32 v223, s59
    v_add_co_u32 v222, vcc, s58, v222
    s_nop 1
    v_addc_co_u32 v223, vcc, 0, v223, vcc
    global_load_dword v220, v[222:223], off
L11_ct:
    s_mov_b32 s61, 34410496
    s_cmp_lg_u32 s20, 0
    s_cbranch_scc1 L15_ws
    v_mov_b32 v255, s52
    v_mov_b32 v254, s53
    v_cmp_eq_u32 vcc, 1, v0
    s_nop 1
    v_cndmask_b32 v255, v255, v254, vcc
    v_mov_b32 v254, s54
    v_cmp_eq_u32 vcc, 2, v0
    s_nop 1
    v_cndmask_b32 v255, v255, v254, vcc
    v_mul_u32_u24 v255, 256, v255
    s_mov_b32 s62, 0
L13_w:
    buffer_load_dword v254, v255, s[4:7], s61 offen sc1
    s_waitcnt vmcnt(0)
    v_cmp_gt_u32 vcc, 1, v254
    s_add_u32 s62, s62, 1
    s_nop 1
    s_cmp_eq_u64 vcc, 0
    s_cbranch_scc1 L14_wd
    s_cmp_lt_u32 s62, 65536
    s_cbranch_scc1 L13_w
L14_wd:
L15_ws:
    s_barrier
    s_add_u32 s34, s34, 6721536
    s_mul_i32 s36, s31, 0
    s_add_u32 s36, s36, s34
    s_add_u32 m0, s35, 0
    s_nop 0
    buffer_load_dwordx4 v11, s[4:7], s36 offen sc1 lds
    s_mul_i32 s36, s31, 1
    s_add_u32 s36, s36, s34
    s_add_u32 m0, s35, 1024
    s_nop 0
    buffer_load_dwordx4 v10, s[4:7], s36 offen sc1 lds
    s_mul_i32 s36, s31, 2
    s_add_u32 s36, s36, s34
    s_add_u32 m0, s35, 2048
    s_nop 0
    buffer_load_dwordx4 v10, s[4:7], s36 offen sc1 lds
    s_mul_i32 s36, s31, 3
    s_add_u32 s36, s36, s34
    s_add_u32 m0, s35, 3072
    s_nop 0
    buffer_load_dwordx4 v10, s[4:7], s36 offen sc1 lds
    s_mul_i32 s36, s31, 4
    s_add_u32 s36, s36, s34
    s_add_u32 m0, s35, 4096
    s_nop 0
    buffer_load_dwordx4 v10, s[4:7], s36 offen sc1 lds
    s_mul_i32 s36, s31, 0
    s_add_u32 s36, s36, s34
    s_add_u32 s36, s36, 20480
    s_add_u32 m0, s35, 5120
    s_nop 0
    buffer_load_dwordx4 v11, s[4:7], s36 offen sc1 lds
    s_mul_i32 s36, s31, 1
    s_add_u32 s36, s36, s34
    s_add_u32 s36, s36, 20480
    s_add_u32 m0, s35, 6144
    s_nop 0
    buffer_load_dwordx4 v10, s[4:7], s36 offen sc1 lds
    s_mul_i32 s36, s31, 2
    s_add_u32 s36, s36, s34
    s_add_u32 s36, s36, 20480
    s_add_u32 m0, s35, 7168
    s_nop 0
    buffer_load_dwordx4 v10, s[4:7], s36 offen sc1 lds
    s_mul_i32 s36, s31, 3
    s_add_u32 s36, s36, s34
    s_add_u32 s36, s36, 20480
    s_add_u32 m0, s35, 8192
    s_nop 0
    buffer_load_dwordx4 v10, s[4:7], s36 offen sc1 lds
    s_mul_i32 s36, s31, 4
    s_add_u32 s36, s36, s34
    s_add_u32 s36, s36, 20480
    s_add_u32 m0, s35, 9216
    s_nop 0
    buffer_load_dwordx4 v10, s[4:7], s36 offen sc1 lds
    s_waitcnt vmcnt(10)
    s_barrier
    s_cmp_ge_u32 s21, 135
    s_cbranch_scc1 L16_pmwd
    v_lshrrev_b32 v1, 4, v0
    v_and_b32 v2, 1, v1
    v_lshrrev_b32 v3, 1, v1
    v_bfe_u32 v6, v0, 2, 2
    v_and_b32 v7, 3, v0
    v_lshl_add_u32 v8, v3, 3, v6
    v_lshlrev_b32 v8, 7, v8
    v_lshl_add_u32 v8, v2, 14, v8
    v_and_b32 v9, 1, v7
    s_lshl_b32 s46, s20, 1
    v_add_u32 v9, s46, v9
    v_and_b32 v10, 2, v6
    v_lshl_or_b32 v10, v2, 2, v10
    v_xor_b32 v9, v9, v10
    v_lshl_add_u32 v8, v9, 4, v8
    v_lshrrev_b32 v7, 1, v7
    v_lshl_add_u32 v8, v7, 3, v8
    v_add_u32 v8, 81920, v8
    s_lshl_b32 s46, s40, 2
    s_add_u32 s46, s46, s20
    s_mul_i32 s47, s46, 40
    s_lshl_b32 s48, s41, 3
    s_add_u32 s47, s47, s48
    s_lshl_b32 s47, s47, 10
    s_add_u32 s47, s47, 0
    v_lshlrev_b32 v11, 4, v0
    v_mov_b32 v12, 0
    s_mov_b32 s49, 0x3f803f80
    ds_read_b64_tr_b16 v[64:65], v8 offset:0
    ds_read_b64_tr_b16 v[66:67], v8 offset:512
    ds_read_b64_tr_b16 v[68:69], v8 offset:2048
    ds_read_b64_tr_b16 v[70:71], v8 offset:2560
    ds_read_b64_tr_b16 v[72:73], v8 offset:4096
    ds_read_b64_tr_b16 v[74:75], v8 offset:4608
    ds_read_b64_tr_b16 v[76:77], v8 offset:6144
    ds_read_b64_tr_b16 v[78:79], v8 offset:6656
    s_waitcnt lgkmcnt(4)
    ds_read_b64_tr_b16 v[80:81], v8 offset:8192
    ds_read_b64_tr_b16 v[82:83], v8 offset:8704
    ds_read_b64_tr_b16 v[84:85], v8 offset:10240
    ds_read_b64_tr_b16 v[86:87], v8 offset:10752
    ds_read_b64_tr_b16 v[88:89], v8 offset:12288
    ds_read_b64_tr_b16 v[90:91], v8 offset:12800
    ds_read_b64_tr_b16 v[92:93], v8 offset:14336
    ds_read_b64_tr_b16 v[94:95], v8 offset:14848
    s_add_u32 s48, s47, 0
    s_waitcnt lgkmcnt(8)
    buffer_store_dwordx4 v[64:67], v11, s[4:7], s48 offen sc1
    v_dot2c_f32_bf16 v12, s49, v64
    v_dot2c_f32_bf16 v12, s49, v65
    v_dot2c_f32_bf16 v12, s49, v66
    v_dot2c_f32_bf16 v12, s49, v67
    s_add_u32 s48, s47, 1024
    buffer_store_dwordx4 v[68:71], v11, s[4:7], s48 offen sc1
    v_dot2c_f32_bf16 v12, s49, v68
    v_dot2c_f32_bf16 v12, s49, v69
    v_dot2c_f32_bf16 v12, s49, v70
    v_dot2c_f32_bf16 v12, s49, v71
    s_add_u32 s48, s47, 2048
    buffer_store_dwordx4 v[72:75], v11, s[4:7], s48 offen sc1
    v_dot2c_f32_bf16 v12, s49, v72
    v_dot2c_f32_bf16 v12, s49, v73
    v_dot2c_f32_bf16 v12, s49, v74
    v_dot2c_f32_bf16 v12, s49, v75
    s_add_u32 s48, s47, 3072
    buffer_store_dwordx4 v[76:79], v11, s[4:7], s48 offen sc1
    v_dot2c_f32_bf16 v12, s49, v76
    v_dot2c_f32_bf16 v12, s49, v77
    v_dot2c_f32_bf16 v12, s49, v78
    v_dot2c_f32_bf16 v12, s49, v79
    s_add_u32 s48, s47, 4096
    s_waitcnt lgkmcnt(0)
    buffer_store_dwordx4 v[80:83], v11, s[4:7], s48 offen sc1
    v_dot2c_f32_bf16 v12, s49, v80
    v_dot2c_f32_bf16 v12, s49, v81
    v_dot2c_f32_bf16 v12, s49, v82
    v_dot2c_f32_bf16 v12, s49, v83
    s_add_u32 s48, s47, 5120
    buffer_store_dwordx4 v[84:87], v11, s[4:7], s48 offen sc1
    v_dot2c_f32_bf16 v12, s49, v84
    v_dot2c_f32_bf16 v12, s49, v85
    v_dot2c_f32_bf16 v12, s49, v86
    v_dot2c_f32_bf16 v12, s49, v87
    s_add_u32 s48, s47, 6144
    buffer_store_dwordx4 v[88:91], v11, s[4:7], s48 offen sc1
    v_dot2c_f32_bf16 v12, s49, v88
    v_dot2c_f32_bf16 v12, s49, v89
    v_dot2c_f32_bf16 v12, s49, v90
    v_dot2c_f32_bf16 v12, s49, v91
    s_add_u32 s48, s47, 7168
    buffer_store_dwordx4 v[92:95], v11, s[4:7], s48 offen sc1
    v_dot2c_f32_bf16 v12, s49, v92
    v_dot2c_f32_bf16 v12, s49, v93
    v_dot2c_f32_bf16 v12, s49, v94
    v_dot2c_f32_bf16 v12, s49, v95
    s_nop 2
    v_mov_b32 v13, v12
    s_nop 1
    v_permlane32_swap_b32 v12, v13
    v_add_f32 v12, v12, v13
    s_mul_i32 s47, s41, 108
    s_add_u32 s47, s47, s46
    s_lshl_b32 s47, s47, 7
    s_add_u32 s47, s47, 6635520
    v_and_b32 v13, 31, v0
    v_lshlrev_b32 v13, 2, v13
    buffer_store_dword v12, v13, s[4:7], s47 offen sc1
    s_branch L17_pmdone
L16_pmwd:
    v_lshrrev_b32 v1, 4, v0
    v_lshrrev_b32 v2, 1, v1
    v_and_b32 v3, 1, v1
    v_bfe_u32 v6, v0, 2, 2
    v_and_b32 v7, 3, v0
    v_lshl_add_u32 v8, v3, 3, v6
    v_lshl_or_b32 v10, v3, 2, v6
    v_lshlrev_b32 v10, 1, v10
    v_mul_u32_u24 v8, 1280, v8
    v_add_u32 v8, 81920, v8
    s_mul_i32 s46, s40, 147
    s_lshr_b32 s46, s46, 10
    s_mul_i32 s47, s46, 7
    s_sub_u32 s47, s40, s47
    s_lshl_b32 s48, s46, 2
    s_add_u32 s48, s48, s47
    s_lshl_b32 s49, s46, 1
    s_add_u32 s49, s49, s47
    s_add_u32 s50, s49, 52
    s_add_u32 s51, s49, 58
    s_cmp_ge_u32 s49, 30
    s_cselect_b32 s49, s51, s50
    s_cmp_lt_u32 s47, 4
    s_cselect_b32 s48, s48, s49
    s_add_u32 s50, s46, 82
    s_add_u32 s51, s46, 84
    s_cmp_ge_u32 s46, 6
    s_cselect_b32 s49, s51, s50
    s_cmp_eq_u32 s47, 6
    s_cselect_b32 s48, s49, s48
    s_cmp_ge_u32 s40, 98
    s_cselect_b32 s48, s40, s48
    s_and_b32 s46, s48, 1
    s_lshr_b32 s47, s48, 1
    v_and_b32 v11, 31, v0
    s_lshl_b32 s48, s46, 5
    v_add_u32 v11, s48, v11
    v_lshlrev_b32 v11, 4, v11
    s_mul_i32 s48, s20, 10
    s_add_u32 s48, s48, 0
    v_add_u32 v1, s48, v2
    v_lshrrev_b32 v3, 1, v7
    v_lshl_add_u32 v3, v1, 1, v3
    v_xor_b32 v3, v3, v10
    v_lshl_add_u32 v3, v3, 4, v8
    v_and_b32 v4, 1, v7
    v_lshl_add_u32 v3, v4, 3, v3
    ds_read_b64_tr_b16 v[64:65], v3
    ds_read_b64_tr_b16 v[66:67], v3 offset:5120
    v_mul_u32_u24 v4, 13, v1
    v_lshrrev_b32 v4, 6, v4
    v_mul_u32_u24 v5, 5, v4
    v_sub_u32 v5, v1, v5
    v_mul_u32_u24 v4, 270, v4
    v_add_u32 v4, v4, v5
    s_mul_i32 s48, s47, 5
    v_add_u32 v4, s48, v4
    v_lshl_add_u32 v90, v4, 10, v11
    s_mul_i32 s48, s20, 10
    s_add_u32 s48, s48, 2
    v_add_u32 v1, s48, v2
    v_lshrrev_b32 v3, 1, v7
    v_lshl_add_u32 v3, v1, 1, v3
    v_xor_b32 v3, v3, v10
    v_lshl_add_u32 v3, v3, 4, v8
    v_and_b32 v4, 1, v7
    v_lshl_add_u32 v3, v4, 3, v3
    ds_read_b64_tr_b16 v[68:69], v3
    ds_read_b64_tr_b16 v[70:71], v3 offset:5120
    v_mul_u32_u24 v4, 13, v1
    v_lshrrev_b32 v4, 6, v4
    v_mul_u32_u24 v5, 5, v4
    v_sub_u32 v5, v1, v5
    v_mul_u32_u24 v4, 270, v4
    v_add_u32 v4, v4, v5
    s_mul_i32 s48, s47, 5
    v_add_u32 v4, s48, v4
    v_lshl_add_u32 v91, v4, 10, v11
    s_mul_i32 s48, s20, 10
    s_add_u32 s48, s48, 4
    v_add_u32 v1, s48, v2
    v_lshrrev_b32 v3, 1, v7
    v_lshl_add_u32 v3, v1, 1, v3
    v_xor_b32 v3, v3, v10
    v_lshl_add_u32 v3, v3, 4, v8
    v_and_b32 v4, 1, v7
    v_lshl_add_u32 v3, v4, 3, v3
    ds_read_b64_tr_b16 v[72:73], v3
    ds_read_b64_tr_b16 v[74:75], v3 offset:5120
    v_mul_u32_u24 v4, 13, v1
    v_lshrrev_b32 v4, 6, v4
    v_mul_u32_u24 v5, 5, v4
    v_sub_u32 v5, v1, v5
    v_mul_u32_u24 v4, 270, v4
    v_add_u32 v4, v4, v5
    s_mul_i32 s48, s47, 5
    v_add_u32 v4, s48, v4
    v_lshl_add_u32 v92, v4, 10, v11
    s_mul_i32 s48, s20, 10
    s_add_u32 s48, s48, 6
    v_add_u32 v1, s48, v2
    v_lshrrev_b32 v3, 1, v7
    v_lshl_add_u32 v3, v1, 1, v3
    v_xor_b32 v3, v3, v10
    v_lshl_add_u32 v3, v3, 4, v8
    v_and_b32 v4, 1, v7
    v_lshl_add_u32 v3, v4, 3, v3
    ds_read_b64_tr_b16 v[76:77], v3
    ds_read_b64_tr_b16 v[78:79], v3 offset:5120
    v_mul_u32_u24 v4, 13, v1
    v_lshrrev_b32 v4, 6, v4
    v_mul_u32_u24 v5, 5, v4
    v_sub_u32 v5, v1, v5
    v_mul_u32_u24 v4, 270, v4
    v_add_u32 v4, v4, v5
    s_mul_i32 s48, s47, 5
    v_add_u32 v4, s48, v4
    v_lshl_add_u32 v93, v4, 10, v11
    s_mul_i32 s48, s20, 10
    s_add_u32 s48, s48, 8
    v_add_u32 v1, s48, v2
    v_lshrrev_b32 v3, 1, v7
    v_lshl_add_u32 v3, v1, 1, v3
    v_xor_b32 v3, v3, v10
    v_lshl_add_u32 v3, v3, 4, v8
    v_and_b32 v4, 1, v7
    v_lshl_add_u32 v3, v4, 3, v3
    ds_read_b64_tr_b16 v[80:81], v3
    ds_read_b64_tr_b16 v[82:83], v3 offset:5120
    v_mul_u32_u24 v4, 13, v1
    v_lshrrev_b32 v4, 6, v4
    v_mul_u32_u24 v5, 5, v4
    v_sub_u32 v5, v1, v5
    v_mul_u32_u24 v4, 270, v4
    v_add_u32 v4, v4, v5
    s_mul_i32 s48, s47, 5
    v_add_u32 v4, s48, v4
    v_lshl_add_u32 v94, v4, 10, v11
    s_waitcnt lgkmcnt(0)
    s_mov_b32 s48, 4423680
    buffer_store_dwordx4 v[64:67], v90, s[4:7], s48 offen sc1
    buffer_store_dwordx4 v[68:71], v91, s[4:7], s48 offen sc1
    buffer_store_dwordx4 v[72:75], v92, s[4:7], s48 offen sc1
    buffer_store_dwordx4 v[76:79], v93, s[4:7], s48 offen sc1
    buffer_store_dwordx4 v[80:83], v94, s[4:7], s48 offen sc1
    buffer_store_dwordx4 v[80:83], v94, s[4:7], s48 offen sc1
    buffer_store_dwordx4 v[80:83], v94, s[4:7], s48 offen sc1
    buffer_store_dwordx4 v[80:83], v94, s[4:7], s48 offen sc1
    buffer_store_dwordx4 v[80:83], v94, s[4:7], s48 offen sc1
L17_pmdone:
    v_and_b32 v1, 15, v0
    v_lshrrev_b32 v2, 4, v0
    v_lshlrev_b32 v12, 4, v0
    s_waitcnt vmcnt(9)
    s_barrier
    ds_read_b128 v[96:99], v12 offset:0
    ds_read_b128 v[100:103], v12 offset:1024
    ds_read_b128 v[104:107], v12 offset:2048
    ds_read_b128 v[108:111], v12 offset:3072
    ds_read_b128 v[112:115], v12 offset:4096
    s_waitcnt lgkmcnt(4)
    v_mfma_f32_16x16x32_bf16 v[64:67], v[96:99], a[128:131], 0
    ds_read_b128 v[116:119], v12 offset:5120
    s_waitcnt lgkmcnt(4)
    v_mfma_f32_16x16x32_bf16 v[68:71], v[100:103], a[128:131], 0
    ds_read_b128 v[120:123], v12 offset:6144
    s_waitcnt lgkmcnt(4)
    v_mfma_f32_16x16x32_bf16 v[72:75], v[104:107], a[128:131], 0
    ds_read_b128 v[124:127], v12 offset:7168
    s_waitcnt lgkmcnt(4)
    v_mfma_f32_16x16x32_bf16 v[76:79], v[108:111], a[128:131], 0
    ds_read_b128 v[128:131], v12 offset:8192
    s_waitcnt lgkmcnt(4)
    v_mfma_f32_16x16x32_bf16 v[80:83], v[112:115], a[128:131], 0
    ds_read_b128 v[132:135], v12 offset:9216
    s_waitcnt lgkmcnt(4)
    v_mfma_f32_16x16x32_bf16 v[64:67], v[116:119], a[132:135], v[64:67]
    ds_read_b128 v[96:99], v12 offset:10240
    s_waitcnt lgkmcnt(4)
    v_mfma_f32_16x16x32_bf16 v[68:71], v[120:123], a[132:135], v[68:71]
    ds_read_b128 v[100:103], v12 offset:11264
    s_waitcnt lgkmcnt(4)
    v_mfma_f32_16x16x32_bf16 v[72:75], v[124:127], a[132:135], v[72:75]
    ds_read_b128 v[104:107], v12 offset:12288
    s_waitcnt lgkmcnt(4)
    v_mfma_f32_16x16x32_bf16 v[76:79], v[128:131], a[132:135], v[76:79]
    ds_read_b128 v[108:111], v12 offset:13312
    s_waitcnt lgkmcnt(4)
    v_mfma_f32_16x16x32_bf16 v[80:83], v[132:135], a[132:135], v[80:83]
    ds_read_b128 v[112:115], v12 offset:14336
    s_waitcnt lgkmcnt(4)
    v_mfma_f32_16x16x32_bf16 v[64:67], v[96:99], a[136:139], v[64:67]
    ds_read_b128 v[116:119], v12 offset:15360
    s_waitcnt lgkmcnt(4)
    v_mfma_f32_16x16x32_bf16 v[68:71], v[100:103], a[136:139], v[68:71]
    ds_read_b128 v[120:123], v12 offset:16384
    s_waitcnt lgkmcnt(4)
    v_mfma_f32_16x16x32_bf16 v[72:75], v[104:107], a[136:139], v[72:75]
    ds_read_b128 v[124:127], v12 offset:17408
    s_waitcnt lgkmcnt(4)
    v_mfma_f32_16x16x32_bf16 v[76:79], v[108:111], a[136:139], v[76:79]
    ds_read_b128 v[128:131], v12 offset:18432
    s_waitcnt lgkmcnt(4)
    v_mfma_f32_16x16x32_bf16 v[80:83], v[112:115], a[136:139], v[80:83]
    ds_read_b128 v[132:135], v12 offset:19456
    s_waitcnt lgkmcnt(4)
    v_mfma_f32_16x16x32_bf16 v[64:67], v[116:119], a[140:143], v[64:67]
    ds_read_b128 v[96:99], v12 offset:20480
    s_waitcnt lgkmcnt(4)
    v_mfma_f32_16x16x32_bf16 v[68:71], v[120:123], a[140:143], v[68:71]
    ds_read_b128 v[100:103], v12 offset:21504
    s_waitcnt lgkmcnt(4)
    v_mfma_f32_16x16x32_bf16 v[72:75], v[124:127], a[140:143], v[72:75]
    ds_read_b128 v[104:107], v12 offset:22528
    s_waitcnt lgkmcnt(4)
    v_mfma_f32_16x16x32_bf16 v[76:79], v[128:131], a[140:143], v[76:79]
    ds_read_b128 v[108:111], v12 offset:23552
    s_waitcnt lgkmcnt(4)
    v_mfma_f32_16x16x32_bf16 v[80:83], v[132:135], a[140:143], v[80:83]
    ds_read_b128 v[112:115], v12 offset:24576
    s_waitcnt lgkmcnt(4)
    v_mfma_f32_16x16x32_bf16 v[64:67], v[96:99], a[144:147], v[64:67]
    ds_read_b128 v[116:119], v12 offset:25600
    s_waitcnt lgkmcnt(4)
    v_mfma_f32_16x16x32_bf16 v[68:71], v[100:103], a[144:147], v[68:71]
    ds_read_b128 v[120:123], v12 offset:26624
    s_waitcnt lgkmcnt(4)
    v_mfma_f32_16x16x32_bf16 v[72:75], v[104:107], a[144:147], v[72:75]
    ds_read_b128 v[124:127], v12 offset:27648
    s_waitcnt lgkmcnt(4)
    v_mfma_f32_16x16x32_bf16 v[76:79], v[108:111], a[144:147], v[76:79]
    ds_read_b128 v[128:131], v12 offset:28672
    s_waitcnt lgkmcnt(4)
    v_mfma_f32_16x16x32_bf16 v[80:83], v[112:115], a[144:147], v[80:83]
    ds_read_b128 v[132:135], v12 offset:29696
    s_waitcnt lgkmcnt(4)
    v_mfma_f32_16x16x32_bf16 v[64:67], v[116:119], a[148:151], v[64:67]
    ds_read_b128 v[96:99], v12 offset:30720
    s_waitcnt lgkmcnt(4)
    v_mfma_f32_16x16x32_bf16 v[68:71], v[120:123], a[148:151], v[68:71]
    ds_read_b128 v[100:103], v12 offset:31744
    s_waitcnt lgkmcnt(4)
    v_mfma_f32_16x16x32_bf16 v[72:75], v[124:127], a[148:151], v[72:75]
    ds_read_b128 v[104:107], v12 offset:32768
    s_waitcnt lgkmcnt(4)
    v_mfma_f32_16x16x32_bf16 v[76:79], v[128:131], a[148:151], v[76:79]
    ds_read_b128 v[108:111], v12 offset:33792
    s_waitcnt lgkmcnt(4)
    v_mfma_f32_16x16x32_bf16 v[80:83], v[132:135], a[148:151], v[80:83]
    ds_read_b128 v[112:115], v12 offset:34816
    s_waitcnt lgkmcnt(4)
    v_mfma_f32_16x16x32_bf16 v[64:67], v[96:99], a[152:155], v[64:67]
    ds_read_b128 v[116:119], v12 offset:35840
    s_waitcnt lgkmcnt(4)
    v_mfma_f32_16x16x32_bf16 v[68:71], v[100:103], a[152:155], v[68:71]
    ds_read_b128 v[120:123], v12 offset:36864
    s_waitcnt lgkmcnt(4)
    v_mfma_f32_16x16x32_bf16 v[72:75], v[104:107], a[152:155], v[72:75]
    ds_read_b128 v[124:127], v12 offset:37888
    s_waitcnt lgkmcnt(4)
    v_mfma_f32_16x16x32_bf16 v[76:79], v[108:111], a[152:155], v[76:79]
    ds_read_b128 v[128:131], v12 offset:38912
    s_waitcnt lgkmcnt(4)
    v_mfma_f32_16x16x32_bf16 v[80:83], v[112:115], a[152:155], v[80:83]
    ds_read_b128 v[132:135], v12 offset:39936
    s_waitcnt lgkmcnt(4)
    v_mfma_f32_16x16x32_bf16 v[64:67], v[116:119], a[156:159], v[64:67]
    s_waitcnt lgkmcnt(3)
    v_mfma_f32_16x16x32_bf16 v[68:71], v[120:123], a[156:159], v[68:71]
    s_waitcnt lgkmcnt(2)
    v_mfma_f32_16x16x32_bf16 v[72:75], v[124:127], a[156:159], v[72:75]
    s_waitcnt lgkmcnt(1)
    v_mfma_f32_16x16x32_bf16 v[76:79], v[128:131], a[156:159], v[76:79]
    s_waitcnt lgkmcnt(0)
    v_mfma_f32_16x16x32_bf16 v[80:83], v[132:135], a[156:159], v[80:83]
    s_waitcnt vmcnt(0)
    s_barrier
    s_mul_i32 s61, s21, 205
    s_lshr_b32 s61, s61, 10
    s_add_u32 s61, s61, 168
    s_and_b32 s62, s21, 7
    s_add_u32 s62, s62, 112
    s_cmp_lt_u32 s21, 135
    s_cselect_b32 s61, s61, s62
    s_lshl_b32 s61, s61, 8
    s_add_u32 s61, s61, 34377728
    s_cmp_eq_u32 s21, 255
    s_cselect_b32 s62, 0, 1
    s_cmp_lg_u32 s20, 0
    s_cbranch_scc1 L18_ol
    s_mov_b64 exec, 1
    v_mov_b32 v254, s62
    v_mov_b32 v255, 0
    buffer_atomic_add v254, v255, s[4:7], s61 offen sc1
    s_mov_b64 exec, -1
L18_ol:
    s_cmp_eq_u32 s72, 0
    s_cselect_b32 s40, 0, 1
    v_mov_b32 v6, 0
    v_or_b32 v5, s40, v2
    v_cmp_eq_u32 vcc, 0, v5
    s_nop 1
    v_cndmask_b32 v64, v64, v6, vcc
    v_lshrrev_b32 v3, 1, v2
    v_and_b32 v4, 1, v2
    v_lshlrev_b32 v5, 4, v1
    v_lshl_add_u32 v5, v3, 8, v5
    v_lshl_add_u32 v13, v4, 3, v5
    s_lshl_b32 s38, s71, 2
    s_add_u32 s38, s38, s20
    s_mul_i32 s36, s70, 163840
    s_mul_i32 s37, s38, 20480
    s_add_u32 s36, s36, s37
    s_mul_i32 s37, s72, 2560
    s_add_u32 s36, s36, s37
    s_add_u32 s36, s36, 11964416
    v_lshlrev_b32 v14, 16, v240
    v_and_b32 v15, 0xffff0000, v240
    v_lshlrev_b32 v6, 16, v241
    v_and_b32 v7, 0xffff0000, v241
    v_pk_add_f32 v[64:65], v[64:65], v[14:15]
    v_pk_add_f32 v[66:67], v[66:67], v[6:7]
    v_cvt_pk_bf16_f32 v240, v64, v65
    v_cvt_pk_bf16_f32 v241, v66, v67
    buffer_store_dwordx2 v[240:241], v13, s[4:7], s36 offen offset:0 sc1
    v_lshlrev_b32 v14, 16, v242
    v_and_b32 v15, 0xffff0000, v242
    v_lshlrev_b32 v6, 16, v243
    v_and_b32 v7, 0xffff0000, v243
    v_pk_add_f32 v[68:69], v[68:69], v[14:15]
    v_pk_add_f32 v[70:71], v[70:71], v[6:7]
    v_cvt_pk_bf16_f32 v242, v68, v69
    v_cvt_pk_bf16_f32 v243, v70, v71
    buffer_store_dwordx2 v[242:243], v13, s[4:7], s36 offen offset:512 sc1
    v_lshlrev_b32 v14, 16, v244
    v_and_b32 v15, 0xffff0000, v244
    v_lshlrev_b32 v6, 16, v245
    v_and_b32 v7, 0xffff0000, v245
    v_pk_add_f32 v[72:73], v[72:73], v[14:15]
    v_pk_add_f32 v[74:75], v[74:75], v[6:7]
    v_cvt_pk_bf16_f32 v244, v72, v73
    v_cvt_pk_bf16_f32 v245, v74, v75
    buffer_store_dwordx2 v[244:245], v13, s[4:7], s36 offen offset:1024 sc1
    v_lshlrev_b32 v14, 16, v246
    v_and_b32 v15, 0xffff0000, v246
    v_lshlrev_b32 v6, 16, v247
    v_and_b32 v7, 0xffff0000, v247
    v_pk_add_f32 v[76:77], v[76:77], v[14:15]
    v_pk_add_f32 v[78:79], v[78:79], v[6:7]
    v_cvt_pk_bf16_f32 v246, v76, v77
    v_cvt_pk_bf16_f32 v247, v78, v79
    buffer_store_dwordx2 v[246:247], v13, s[4:7], s36 offen offset:1536 sc1
    v_lshlrev_b32 v14, 16, v248
    v_and_b32 v15, 0xffff0000, v248
    v_lshlrev_b32 v6, 16, v249
    v_and_b32 v7, 0xffff0000, v249
    v_pk_add_f32 v[80:81], v[80:81], v[14:15]
    v_pk_add_f32 v[82:83], v[82:83], v[6:7]
    v_cvt_pk_bf16_f32 v248, v80, v81
    v_cvt_pk_bf16_f32 v249, v82, v83
    buffer_store_dwordx2 v[248:249], v13, s[4:7], s36 offen offset:2048 sc1
    v_pk_mul_f32 v[52:53], v[64:65], v[64:65]
    v_pk_add_f32 v[50:51], v[64:65], v[66:67]
    v_pk_fma_f32 v[52:53], v[66:67], v[66:67], v[52:53]
    v_pk_fma_f32 v[52:53], v[68:69], v[68:69], v[52:53]
    v_pk_add_f32 v[50:51], v[50:51], v[68:69]
    v_pk_fma_f32 v[52:53], v[70:71], v[70:71], v[52:53]
    v_pk_add_f32 v[50:51], v[50:51], v[70:71]
    v_pk_fma_f32 v[52:53], v[72:73], v[72:73], v[52:53]
    v_pk_add_f32 v[50:51], v[50:51], v[72:73]
    v_pk_fma_f32 v[52:53], v[74:75], v[74:75], v[52:53]
    v_pk_add_f32 v[50:51], v[50:51], v[74:75]
    v_pk_fma_f32 v[52:53], v[76:77], v[76:77], v[52:53]
    v_pk_add_f32 v[50:51], v[50:51], v[76:77]
    v_pk_fma_f32 v[52:53], v[78:79], v[78:79], v[52:53]
    v_pk_add_f32 v[50:51], v[50:51], v[78:79]
    v_pk_fma_f32 v[52:53], v[80:81], v[80:81], v[52:53]
    v_pk_add_f32 v[50:51], v[50:51], v[80:81]
    v_pk_fma_f32 v[52:53], v[82:83], v[82:83], v[52:53]
    v_pk_add_f32 v[50:51], v[50:51], v[82:83]
    v_add_f32 v48, v50, v51
    v_add_f32 v49, v52, v53
    v_mov_b32 v3, v48
    s_nop 1
    v_permlane16_swap_b32 v48, v3
    v_add_f32 v48, v48, v3
    v_mov_b32 v3, v48
    s_nop 1
    v_permlane32_swap_b32 v48, v3
    v_add_f32 v48, v48, v3
    v_mov_b32 v3, v49
    s_nop 1
    v_permlane16_swap_b32 v49, v3
    v_add_f32 v49, v49, v3
    v_mov_b32 v3, v49
    s_nop 1
    v_permlane32_swap_b32 v49, v3
    v_add_f32 v49, v49, v3
    s_lshl_b32 s36, s70, 13
    s_lshr_b32 s37, s72, 1
    s_lshl_b32 s37, s37, 11
    s_add_u32 s36, s36, s37
    s_lshl_b32 s37, s38, 8
    s_add_u32 s36, s36, s37
    s_and_b32 s37, s72, 1
    s_lshl_b32 s37, s37, 3
    s_add_u32 s36, s36, s37
    s_add_u32 s36, s36, 17207296
    v_lshlrev_b32 v5, 4, v1
    buffer_store_dwordx2 v[48:49], v5, s[4:7], s36 offen sc1
    s_mul_i32 s44, s20, 7
    s_mul_i32 s46, s20, 3
    s_add_u32 s46, s46, 21
    s_lshl_b32 s101, s20, 2
    s_add_u32 s101, s101, 30
    s_cmp_eq_u32 s20, 3
    s_cselect_b32 s45, 1, 0
    s_sub_u32 s101, s101, s45
    s_mul_i32 s45, s72, 54
    s_add_u32 s44, s44, s45
    s_mul_i32 s44, s44, 5120
    s_add_u32 s44, s44, 4423680
    s_add_u32 s46, s46, s45
    s_mul_i32 s46, s46, 5120
    s_add_u32 s46, s46, 4423680
    s_add_u32 s101, s101, s45
    s_mul_i32 s101, s101, 5120
    s_add_u32 s101, s101, 4423680
    s_mul_i32 s100, s20, 22528
    s_add_u32 s100, s100, 71680
    s_mov_b32 s22, s73
    s_mov_b32 s23, s74
    s_mov_b32 s24, s75
    v_lshlrev_b32 v11, 4, v0
    s_mul_i32 s30, s24, 40960
    s_lshl_b32 s29, s20, 10
    s_add_u32 s30, s30, s29
    s_add_u32 s30, s30, 0
    s_mul_i32 s33, s20, 1024
    s_mul_i32 s34, s20, 2048
    s_mul_i32 s35, s20, 3072
    s_mul_i32 s36, s20, 4096
    v_and_b32 v1, 31, v0
    v_lshrrev_b32 v2, 5, v0
    v_lshrrev_b32 v3, 4, v1
    v_and_b32 v4, 15, v0
    v_lshlrev_b32 v5, 4, v4
    v_lshl_add_u32 v5, v2, 8, v5
    v_mul_u32_u24 v6, 20480, v3
    v_add_u32 v10, v6, v5
    v_lshl_add_u32 v12, v3, 10, v5
    v_lshlrev_b32 v13, 4, v2
    v_add_u32 v13, 65536, v13
    v_add_u32 v14, 0x10000, v11
    s_mul_i32 s28, s22, 163840
    s_mul_i32 s29, s20, 40960
    s_add_u32 s28, s28, s29
    s_add_u32 s28, s28, 11964416
    s_mul_i32 s31, s22, 442368
    s_lshr_b32 s29, s20, 1
    s_mul_i32 s29, s29, 221184
    s_add_u32 s31, s31, s29
    s_and_b32 s29, s20, 1
    s_lshl_b32 s29, s29, 11
    s_add_u32 s31, s31, s29
    s_add_u32 s31, s31, 17469440
    s_lshl_b32 s40, s23, 2
    s_add_u32 s40, s40, 0
    s_add_u32 s41, s24, 0
    s_cmp_ge_u32 s41, 98
    s_cselect_b32 s40, s41, s40
    s_lshr_b32 s41, s40, 1
    s_lshl_b32 s41, s41, 12
    s_and_b32 s40, s40, 1
    s_lshl_b32 s40, s40, 9
    s_add_u32 s40, s40, s41
    s_add_u32 s47, s40, s31
    s_lshl_b32 s40, s23, 2
    s_add_u32 s40, s40, 1
    s_add_u32 s41, s24, 1
    s_cmp_ge_u32 s41, 98
    s_cselect_b32 s40, s41, s40
    s_lshr_b32 s41, s40, 1
    s_lshl_b32 s41, s41, 12
    s_and_b32 s40, s40, 1
    s_lshl_b32 s40, s40, 9
    s_add_u32 s40, s40, s41
    s_add_u32 s48, s40, s31
    s_lshl_b32 s40, s23, 2
    s_add_u32 s40, s40, 2
    s_add_u32 s41, s24, 2
    s_cmp_ge_u32 s41, 98
    s_cselect_b32 s40, s41, s40
    s_lshr_b32 s41, s40, 1
    s_lshl_b32 s41, s41, 12
    s_and_b32 s40, s40, 1
    s_lshl_b32 s40, s40, 9
    s_add_u32 s40, s40, s41
    s_add_u32 s49, s40, s31
    s_lshl_b32 s40, s23, 2
    s_add_u32 s40, s40, 3
    s_add_u32 s41, s24, 3
    s_cmp_ge_u32 s41, 98
    s_cselect_b32 s40, s41, s40
    s_lshr_b32 s41, s40, 1
    s_lshl_b32 s41, s41, 12
    s_and_b32 s40, s40, 1
    s_lshl_b32 s40, s40, 9
    s_add_u32 s40, s40, s41
    s_add_u32 s66, s40, s31
    s_lshl_b32 s41, s23, 1
    s_add_u32 s40, s41, 56
    s_add_u32 s50, s41, 62
    s_cmp_ge_u32 s23, 13
    s_cselect_b32 s40, s50, s40
    s_add_u32 s41, s24, 4
    s_cmp_ge_u32 s41, 98
    s_cselect_b32 s40, s41, s40
    s_lshr_b32 s41, s40, 1
    s_lshl_b32 s41, s41, 12
    s_and_b32 s40, s40, 1
    s_lshl_b32 s40, s40, 9
    s_add_u32 s40, s40, s41
    s_add_u32 s67, s40, s31
    s_lshl_b32 s41, s23, 1
    s_add_u32 s40, s41, 57
    s_add_u32 s50, s41, 63
    s_cmp_ge_u32 s23, 13
    s_cselect_b32 s40, s50, s40
    s_add_u32 s41, s24, 5
    s_cmp_ge_u32 s41, 98
    s_cselect_b32 s40, s41, s40
    s_lshr_b32 s41, s40, 1
    s_lshl_b32 s41, s41, 12
    s_and_b32 s40, s40, 1
    s_lshl_b32 s40, s40, 9
    s_add_u32 s40, s40, s41
    s_add_u32 s68, s40, s31
    s_add_u32 s40, s23, 82
    s_add_u32 s50, s23, 84
    s_cmp_ge_u32 s23, 6
    s_cselect_b32 s40, s50, s40
    s_add_u32 s41, s24, 6
    s_cmp_ge_u32 s41, 98
    s_cselect_b32 s40, s41, s40
    s_lshr_b32 s41, s40, 1
    s_lshl_b32 s41, s41, 12
    s_and_b32 s40, s40, 1
    s_lshl_b32 s40, s40, 9
    s_add_u32 s40, s40, s41
    s_add_u32 s69, s40, s31
    v_lshlrev_b32 v7, 4, v1
    v_lshl_add_u32 v7, v2, 12, v7
    s_lshl_b32 s42, s22, 13
    s_lshl_b32 s37, s20, 9
    s_add_u32 s42, s42, s37
    s_add_u32 s42, s42, 17207296
    s_lshl_b32 s37, s20, 8
    v_lshlrev_b32 v8, 2, v0
    v_add_u32 v8, s37, v8
    s_lshl_b32 s43, s24, 7
    s_add_u32 s43, s43, 6635520
    s_lshr_b32 s57, s75, 2
    s_add_u32 s62, s75, 6
    s_lshr_b32 s62, s62, 2
    v_add_u32 v236, s57, v0
    v_min_u32 v236, s62, v236
    v_lshlrev_b32 v236, 8, v236
    s_mov_b32 s57, 34420736
    buffer_load_dword v237, v236, s[4:7], s57 offen sc1
    s_waitcnt vmcnt(0)
    s_waitcnt vmcnt(0)
    s_barrier
    s_lshl_b32 s61, s70, 8
    s_add_u32 s61, s61, 34377728
    s_cmp_lg_u32 s20, 0
    s_cbranch_scc1 L19_ol
    s_mov_b64 exec, 1
    v_mov_b32 v254, 1
    v_mov_b32 v255, 0
    buffer_atomic_add v254, v255, s[4:7], s61 offen sc1
    s_mov_b64 exec, -1
L19_ol:
    s_mov_b32 s62, 0
    v_cmp_gt_u32 vcc, 5, v237
    s_nop 1
    s_cmp_eq_u64 vcc, 0
    s_cbranch_scc1 L21_qd
L20_qp:
    buffer_load_dword v237, v236, s[4:7], s57 offen sc1
    s_waitcnt vmcnt(0)
    v_cmp_gt_u32 vcc, 5, v237
    s_add_u32 s62, s62, 1
    s_nop 1
    s_cmp_eq_u64 vcc, 0
    s_cbranch_scc1 L21_qd
    s_cmp_lt_u32 s62, 65536
    s_cbranch_scc1 L20_qp
L21_qd:
    s_cmp_eq_u32 s20, 0
    s_cbranch_scc1 L22_ct
    s_getpc_b64 s[58:59]
L23_cp:
    s_sub_u32 s60, s20, 1
    s_lshl_b32 s60, s60, 13
    v_lshlrev_b32 v222, 7, v0
    v_add_u32 v222, s60, v222
    s_mov_b32 s60, L_exit-L23_cp
    v_min_u32 v222, s60, v222
    v_mov_b32 v223, s59
    v_add_co_u32 v222, vcc, s58, v222
    s_nop 1
    v_addc_co_u32 v223, vcc, 0, v223, vcc
    global_load_dword v220, v[222:223], off
L22_ct:
    s_cmp_eq_u32 s20, 0
    s_cbranch_scc1 L27_pb
    s_add_u32 m0, s36, 0
    s_add_u32 s38, s30, 0
    buffer_load_dwordx4 v11, s[4:7], s38 offen sc1 lds
    s_add_u32 m0, s36, 1024
    s_add_u32 s38, s30, 40960
    buffer_load_dwordx4 v11, s[4:7], s38 offen sc1 lds
    s_add_u32 m0, s36, 2048
    s_add_u32 s38, s30, 81920
    buffer_load_dwordx4 v11, s[4:7], s38 offen sc1 lds
    s_add_u32 m0, s36, 3072
    s_add_u32 s38, s30, 122880
    buffer_load_dwordx4 v11, s[4:7], s38 offen sc1 lds
    s_add_u32 m0, s36, 16384
    s_add_u32 s38, s30, 4096
    buffer_load_dwordx4 v11, s[4:7], s38 offen sc1 lds
    s_add_u32 m0, s36, 17408
    s_add_u32 s38, s30, 45056
    buffer_load_dwordx4 v11, s[4:7], s38 offen sc1 lds
    s_add_u32 m0, s36, 18432
    s_add_u32 s38, s30, 86016
    buffer_load_dwordx4 v11, s[4:7], s38 offen sc1 lds
    s_add_u32 m0, s36, 19456
    s_add_u32 s38, s30, 126976
    buffer_load_dwordx4 v11, s[4:7], s38 offen sc1 lds
L27_pb:
    s_lshl_b32 s61, s73, 8
    s_add_u32 s61, s61, 34377728
    s_cmp_lg_u32 s20, 0
    s_cbranch_scc1 L26_ws
    v_mov_b32 v255, 0
    s_mov_b32 s62, 0
L24_w:
    buffer_load_dword v254, v255, s[4:7], s61 offen sc1
    s_waitcnt vmcnt(0)
    v_cmp_gt_u32 vcc, 16, v254
    s_add_u32 s62, s62, 1
    s_nop 1
    s_cmp_eq_u64 vcc, 0
    s_cbranch_scc1 L25_wd
    s_cmp_lt_u32 s62, 65536
    s_cbranch_scc1 L24_w
L25_wd:
L26_ws:
    s_barrier
    s_cmp_lg_u32 s20, 0
    s_cbranch_scc1 L28_pb
    s_add_u32 m0, s36, 0
    s_add_u32 s38, s30, 0
    s_nop 0
    buffer_load_dwordx4 v11, s[4:7], s38 offen sc1 lds
    s_add_u32 m0, s36, 1024
    s_add_u32 s38, s30, 40960
    s_nop 0
    buffer_load_dwordx4 v11, s[4:7], s38 offen sc1 lds
    s_add_u32 m0, s36, 2048
    s_add_u32 s38, s30, 81920
    s_nop 0
    buffer_load_dwordx4 v11, s[4:7], s38 offen sc1 lds
    s_add_u32 m0, s36, 3072
    s_add_u32 s38, s30, 122880
    s_nop 0
    buffer_load_dwordx4 v11, s[4:7], s38 offen sc1 lds
    s_add_u32 m0, s36, 16384
    s_add_u32 s38, s30, 4096
    s_nop 0
    buffer_load_dwordx4 v11, s[4:7], s38 offen sc1 lds
    s_add_u32 m0, s36, 17408
    s_add_u32 s38, s30, 45056
    s_nop 0
    buffer_load_dwordx4 v11, s[4:7], s38 offen sc1 lds
    s_add_u32 m0, s36, 18432
    s_add_u32 s38, s30, 86016
    s_nop 0
    buffer_load_dwordx4 v11, s[4:7], s38 offen sc1 lds
    s_add_u32 m0, s36, 19456
    s_add_u32 s38, s30, 126976
    s_nop 0
    buffer_load_dwordx4 v11, s[4:7], s38 offen sc1 lds
L28_pb:
    s_add_u32 s39, s28, 0
    buffer_load_dwordx4 a[0:3], v10, s[4:7], s39 offen offset:0 sc1
    s_add_u32 s39, s28, 0
    buffer_load_dwordx4 a[4:7], v10, s[4:7], s39 offen offset:512 sc1
    s_add_u32 s39, s28, 0
    buffer_load_dwordx4 a[8:11], v10, s[4:7], s39 offen offset:1024 sc1
    s_add_u32 s39, s28, 0
    buffer_load_dwordx4 a[12:15], v10, s[4:7], s39 offen offset:1536 sc1
    buffer_load_dwordx4 v[48:51], v7, s[4:7], s42 offen sc1
    buffer_load_dwordx4 v[52:55], v7, s[4:7], s42 offen offset:2048 sc1
    s_add_u32 s39, s28, 0
    buffer_load_dwordx4 a[16:19], v10, s[4:7], s39 offen offset:2048 sc1
    s_add_u32 s39, s28, 0
    buffer_load_dwordx4 a[20:23], v10, s[4:7], s39 offen offset:2560 sc1
    s_add_u32 s39, s28, 0
    buffer_load_dwordx4 a[24:27], v10, s[4:7], s39 offen offset:3072 sc1
    s_add_u32 s39, s28, 0
    buffer_load_dwordx4 a[28:31], v10, s[4:7], s39 offen offset:3584 sc1
    buffer_load_dword v59, v8, s[4:7], s43 offen sc1
    s_add_u32 s43, s43, 13824
    buffer_load_dword v60, v8, s[4:7], s43 offen sc1
    s_add_u32 s43, s43, 13824
    buffer_load_dword v61, v8, s[4:7], s43 offen sc1
    s_add_u32 s43, s43, 13824
    buffer_load_dword v62, v8, s[4:7], s43 offen sc1
    s_add_u32 s43, s43, 13824
    buffer_load_dword v63, v8, s[4:7], s43 offen sc1
    s_waitcnt vmcnt(19)
    s_barrier
    ds_read_b128 v[32:35], v11 offset:0
    ds_read_b128 v[36:39], v11 offset:1024
    ds_read_b128 v[40:43], v11 offset:2048
    s_waitcnt vmcnt(14) lgkmcnt(2)
    v_mfma_f32_32x32x16_bf16 v[64:79], v[32:35], a[0:3], 0
    ds_read_b128 v[44:47], v11 offset:3072
    s_add_u32 m0, s36, 32768
    s_add_u32 s38, s30, 8192
    buffer_load_dwordx4 v11, s[4:7], s38 offen sc1 lds
    s_waitcnt lgkmcnt(2)
    v_mfma_f32_32x32x16_bf16 v[80:95], v[36:39], a[0:3], 0
    ds_read_b128 v[32:35], v11 offset:4096
    s_waitcnt lgkmcnt(2)
    v_mfma_f32_32x32x16_bf16 v[96:111], v[40:43], a[0:3], 0
    ds_read_b128 v[36:39], v11 offset:5120
    s_add_u32 m0, s36, 33792
    s_add_u32 s38, s30, 49152
    buffer_load_dwordx4 v11, s[4:7], s38 offen sc1 lds
    s_waitcnt lgkmcnt(2)
    v_mfma_f32_32x32x16_bf16 v[112:127], v[44:47], a[0:3], 0
    ds_read_b128 v[40:43], v11 offset:6144
    s_waitcnt vmcnt(15) lgkmcnt(2)
    v_mfma_f32_32x32x16_bf16 v[64:79], v[32:35], a[4:7], v[64:79]
    ds_read_b128 v[44:47], v11 offset:7168
    s_add_u32 m0, s36, 34816
    s_add_u32 s38, s30, 90112
    buffer_load_dwordx4 v11, s[4:7], s38 offen sc1 lds
    s_waitcnt lgkmcnt(2)
    v_mfma_f32_32x32x16_bf16 v[80:95], v[36:39], a[4:7], v[80:95]
    ds_read_b128 v[32:35], v11 offset:8192
    s_waitcnt lgkmcnt(2)
    v_mfma_f32_32x32x16_bf16 v[96:111], v[40:43], a[4:7], v[96:111]
    ds_read_b128 v[36:39], v11 offset:9216
    s_add_u32 m0, s36, 35840
    s_add_u32 s38, s30, 131072
    buffer_load_dwordx4 v11, s[4:7], s38 offen sc1 lds
    s_waitcnt lgkmcnt(2)
    v_mfma_f32_32x32x16_bf16 v[112:127], v[44:47], a[4:7], v[112:127]
    ds_read_b128 v[40:43], v11 offset:10240
    s_waitcnt vmcnt(16) lgkmcnt(2)
    v_mfma_f32_32x32x16_bf16 v[64:79], v[32:35], a[8:11], v[64:79]
    ds_read_b128 v[44:47], v11 offset:11264
    s_add_u32 s39, s28, 4096
    buffer_load_dwordx4 a[32:35], v10, s[4:7], s39 offen offset:0 sc1
    s_waitcnt lgkmcnt(2)
    v_mfma_f32_32x32x16_bf16 v[80:95], v[36:39], a[8:11], v[80:95]
    ds_read_b128 v[32:35], v11 offset:12288
    s_waitcnt lgkmcnt(2)
    v_mfma_f32_32x32x16_bf16 v[96:111], v[40:43], a[8:11], v[96:111]
    ds_read_b128 v[36:39], v11 offset:13312
    s_add_u32 s39, s28, 4096
    buffer_load_dwordx4 a[36:39], v10, s[4:7], s39 offen offset:512 sc1
    s_waitcnt lgkmcnt(2)
    v_mfma_f32_32x32x16_bf16 v[112:127], v[44:47], a[8:11], v[112:127]
    ds_read_b128 v[40:43], v11 offset:14336
    s_waitcnt vmcnt(17) lgkmcnt(2)
    v_mfma_f32_32x32x16_bf16 v[64:79], v[32:35], a[12:15], v[64:79]
    ds_read_b128 v[44:47], v11 offset:15360
    s_add_u32 s39, s28, 4096
    buffer_load_dwordx4 a[40:43], v10, s[4:7], s39 offen offset:1024 sc1
    s_waitcnt lgkmcnt(2)
    v_mfma_f32_32x32x16_bf16 v[80:95], v[36:39], a[12:15], v[80:95]
    s_waitcnt vmcnt(10)
    v_add_f32 v59, v59, v60
    s_waitcnt vmcnt(8)
    v_add_f32 v61, v61, v62
    s_waitcnt vmcnt(7)
    v_add_f32 v59, v59, v63
    v_add_f32 v59, v59, v61
    v_add_u32 v8, 65536, v8
    ds_write_b32 v8, v59
    s_waitcnt lgkmcnt(0)
    s_barrier
    ds_read_b128 v[32:35], v11 offset:16384
    v_mfma_f32_32x32x16_bf16 v[96:111], v[40:43], a[12:15], v[96:111]
    ds_read_b128 v[36:39], v11 offset:17408
    s_add_u32 s39, s28, 4096
    buffer_load_dwordx4 a[44:47], v10, s[4:7], s39 offen offset:1536 sc1
    v_mfma_f32_32x32x16_bf16 v[112:127], v[44:47], a[12:15], v[112:127]
    ds_read_b128 v[40:43], v11 offset:18432
    s_waitcnt lgkmcnt(2)
    v_mfma_f32_32x32x16_bf16 v[64:79], v[32:35], a[16:19], v[64:79]
    ds_read_b128 v[44:47], v11 offset:19456
    s_add_u32 m0, s36, 49152
    s_add_u32 s38, s30, 12288
    buffer_load_dwordx4 v11, s[4:7], s38 offen sc1 lds
    v_add_f32 v48, v48, v50
    v_add_f32 v49, v49, v51
    v_add_f32 v52, v52, v54
    s_waitcnt lgkmcnt(2)
    v_mfma_f32_32x32x16_bf16 v[80:95], v[36:39], a[16:19], v[80:95]
    ds_read_b128 v[32:35], v11 offset:20480
    v_add_f32 v53, v53, v55
    v_add_f32 v48, v48, v52
    v_add_f32 v49, v49, v53
    v_mov_b32 v50, v48
    v_mov_b32 v51, v49
    s_waitcnt lgkmcnt(2)
    v_mfma_f32_32x32x16_bf16 v[96:111], v[40:43], a[16:19], v[96:111]
    ds_read_b128 v[36:39], v11 offset:21504
    s_add_u32 m0, s36, 50176
    s_add_u32 s38, s30, 53248
    buffer_load_dwordx4 v11, s[4:7], s38 offen sc1 lds
    v_permlane32_swap_b32 v48, v50
    v_permlane32_swap_b32 v49, v51
    v_add_f32 v48, v48, v50
    s_waitcnt lgkmcnt(2)
    v_mfma_f32_32x32x16_bf16 v[112:127], v[44:47], a[16:19], v[112:127]
    ds_read_b128 v[40:43], v11 offset:22528
    v_add_f32 v49, v49, v51
    v_mul_f32 v48, 0x3acccccd, v48
    v_mul_f32 v49, 0x3acccccd, v49
    v_fma_f32 v49, -v48, v48, v49
    v_add_f32 v49, 0x3727c5ac, v49
    s_waitcnt lgkmcnt(2)
    v_mfma_f32_32x32x16_bf16 v[64:79], v[32:35], a[20:23], v[64:79]
    ds_read_b128 v[44:47], v11 offset:23552
    v_sqrt_f32 v57, v49
    v_sub_f32 v56, 0, v48
    v_rcp_f32 v58, v57
    s_waitcnt lgkmcnt(2)
    v_mfma_f32_32x32x16_bf16 v[80:95], v[36:39], a[20:23], v[80:95]
    ds_read_b128 v[32:35], v11 offset:24576
    s_add_u32 m0, s36, 51200
    s_add_u32 s38, s30, 94208
    buffer_load_dwordx4 v11, s[4:7], s38 offen sc1 lds
    v_mul_f32 v58, 0xbfb8aa3b, v58
    s_waitcnt lgkmcnt(2)
    v_mfma_f32_32x32x16_bf16 v[96:111], v[40:43], a[20:23], v[96:111]
    ds_read_b128 v[36:39], v11 offset:25600
    s_waitcnt lgkmcnt(2)
    v_mfma_f32_32x32x16_bf16 v[112:127], v[44:47], a[20:23], v[112:127]
    ds_read_b128 v[40:43], v11 offset:26624
    s_add_u32 m0, s36, 52224
    s_add_u32 s38, s30, 135168
    buffer_load_dwordx4 v11, s[4:7], s38 offen sc1 lds
    s_waitcnt lgkmcnt(2)
    v_mfma_f32_32x32x16_bf16 v[64:79], v[32:35], a[24:27], v[64:79]
    ds_read_b128 v[44:47], v11 offset:27648
    s_waitcnt lgkmcnt(2)
    v_mfma_f32_32x32x16_bf16 v[80:95], v[36:39], a[24:27], v[80:95]
    ds_read_b128 v[32:35], v11 offset:28672
    s_add_u32 s39, s28, 4096
    buffer_load_dwordx4 a[48:51], v10, s[4:7], s39 offen offset:2048 sc1
    s_waitcnt lgkmcnt(2)
    v_mfma_f32_32x32x16_bf16 v[96:111], v[40:43], a[24:27], v[96:111]
    ds_read_b128 v[36:39], v11 offset:29696
    s_waitcnt lgkmcnt(2)
    v_mfma_f32_32x32x16_bf16 v[112:127], v[44:47], a[24:27], v[112:127]
    ds_read_b128 v[40:43], v11 offset:30720
    s_add_u32 s39, s28, 4096
    buffer_load_dwordx4 a[52:55], v10, s[4:7], s39 offen offset:2560 sc1
    s_waitcnt lgkmcnt(2)
    v_mfma_f32_32x32x16_bf16 v[64:79], v[32:35], a[28:31], v[64:79]
    ds_read_b128 v[44:47], v11 offset:31744
    s_waitcnt lgkmcnt(2)
    v_mfma_f32_32x32x16_bf16 v[80:95], v[36:39], a[28:31], v[80:95]
    s_waitcnt vmcnt(10)
    s_barrier
    ds_read_b128 v[32:35], v11 offset:32768
    s_add_u32 s39, s28, 4096
    buffer_load_dwordx4 a[56:59], v10, s[4:7], s39 offen offset:3072 sc1
    s_waitcnt lgkmcnt(2)
    v_mfma_f32_32x32x16_bf16 v[96:111], v[40:43], a[28:31], v[96:111]
    ds_read_b128 v[36:39], v11 offset:33792
    s_waitcnt lgkmcnt(2)
    v_mfma_f32_32x32x16_bf16 v[112:127], v[44:47], a[28:31], v[112:127]
    ds_read_b128 v[40:43], v11 offset:34816
    s_add_u32 s39, s28, 4096
    buffer_load_dwordx4 a[60:63], v10, s[4:7], s39 offen offset:3584 sc1
    s_waitcnt vmcnt(11) lgkmcnt(2)
    v_mfma_f32_32x32x16_bf16 v[64:79], v[32:35], a[32:35], v[64:79]
    ds_read_b128 v[44:47], v11 offset:35840
    s_waitcnt lgkmcnt(2)
    v_mfma_f32_32x32x16_bf16 v[80:95], v[36:39], a[32:35], v[80:95]
    ds_read_b128 v[32:35], v11 offset:36864
    s_add_u32 m0, s36, 0
    s_add_u32 s38, s30, 16384
    buffer_load_dwordx4 v11, s[4:7], s38 offen sc1 lds
    s_waitcnt lgkmcnt(2)
    v_mfma_f32_32x32x16_bf16 v[96:111], v[40:43], a[32:35], v[96:111]
    ds_read_b128 v[36:39], v11 offset:37888
    s_waitcnt lgkmcnt(2)
    v_mfma_f32_32x32x16_bf16 v[112:127], v[44:47], a[32:35], v[112:127]
    ds_read_b128 v[40:43], v11 offset:38912
    s_add_u32 m0, s36, 1024
    s_add_u32 s38, s30, 57344
    buffer_load_dwordx4 v11, s[4:7], s38 offen sc1 lds
    s_waitcnt vmcnt(12) lgkmcnt(2)
    v_mfma_f32_32x32x16_bf16 v[64:79], v[32:35], a[36:39], v[64:79]
    ds_read_b128 v[44:47], v11 offset:39936
    s_waitcnt lgkmcnt(2)
    v_mfma_f32_32x32x16_bf16 v[80:95], v[36:39], a[36:39], v[80:95]
    ds_read_b128 v[32:35], v11 offset:40960
    s_add_u32 m0, s36, 2048
    s_add_u32 s38, s30, 98304
    buffer_load_dwordx4 v11, s[4:7], s38 offen sc1 lds
    s_waitcnt lgkmcnt(2)
    v_mfma_f32_32x32x16_bf16 v[96:111], v[40:43], a[36:39], v[96:111]
    ds_read_b128 v[36:39], v11 offset:41984
    s_waitcnt lgkmcnt(2)
    v_mfma_f32_32x32x16_bf16 v[112:127], v[44:47], a[36:39], v[112:127]
    ds_read_b128 v[40:43], v11 offset:43008
    s_add_u32 m0, s36, 3072
    s_add_u32 s38, s30, 139264
    buffer_load_dwordx4 v11, s[4:7], s38 offen sc1 lds
    s_waitcnt vmcnt(13) lgkmcnt(2)
    v_mfma_f32_32x32x16_bf16 v[64:79], v[32:35], a[40:43], v[64:79]
    ds_read_b128 v[44:47], v11 offset:44032
    s_waitcnt lgkmcnt(2)
    v_mfma_f32_32x32x16_bf16 v[80:95], v[36:39], a[40:43], v[80:95]
    ds_read_b128 v[32:35], v11 offset:45056
    s_waitcnt lgkmcnt(2)
    v_mfma_f32_32x32x16_bf16 v[96:111], v[40:43], a[40:43], v[96:111]
    ds_read_b128 v[36:39], v11 offset:46080
    s_add_u32 s39, s28, 8192
    buffer_load_dwordx4 a[64:67], v10, s[4:7], s39 offen offset:0 sc1
    s_waitcnt lgkmcnt(2)
    v_mfma_f32_32x32x16_bf16 v[112:127], v[44:47], a[40:43], v[112:127]
    ds_read_b128 v[40:43], v11 offset:47104
    s_waitcnt vmcnt(13) lgkmcnt(2)
    v_mfma_f32_32x32x16_bf16 v[64:79], v[32:35], a[44:47], v[64:79]
    ds_read_b128 v[44:47], v11 offset:48128
    s_add_u32 s39, s28, 8192
    buffer_load_dwordx4 a[68:71], v10, s[4:7], s39 offen offset:512 sc1
    s_waitcnt lgkmcnt(2)
    v_mfma_f32_32x32x16_bf16 v[80:95], v[36:39], a[44:47], v[80:95]
    s_waitcnt vmcnt(10)
    s_barrier
    ds_read_b128 v[32:35], v11 offset:49152
    s_waitcnt lgkmcnt(2)
    v_mfma_f32_32x32x16_bf16 v[96:111], v[40:43], a[44:47], v[96:111]
    ds_read_b128 v[36:39], v11 offset:50176
    s_add_u32 s39, s28, 8192
    buffer_load_dwordx4 a[72:75], v10, s[4:7], s39 offen offset:1024 sc1
    s_waitcnt lgkmcnt(2)
    v_mfma_f32_32x32x16_bf16 v[112:127], v[44:47], a[44:47], v[112:127]
    ds_read_b128 v[40:43], v11 offset:51200
    s_waitcnt vmcnt(10) lgkmcnt(2)
    v_mfma_f32_32x32x16_bf16 v[64:79], v[32:35], a[48:51], v[64:79]
    ds_read_b128 v[44:47], v11 offset:52224
    s_add_u32 s39, s28, 8192
    buffer_load_dwordx4 a[76:79], v10, s[4:7], s39 offen offset:1536 sc1
    s_waitcnt lgkmcnt(2)
    v_mfma_f32_32x32x16_bf16 v[80:95], v[36:39], a[48:51], v[80:95]
    ds_read_b128 v[32:35], v11 offset:53248
    s_waitcnt lgkmcnt(2)
    v_mfma_f32_32x32x16_bf16 v[96:111], v[40:43], a[48:51], v[96:111]
    ds_read_b128 v[36:39], v11 offset:54272
    s_add_u32 m0, s36, 16384
    s_add_u32 s38, s30, 20480
    buffer_load_dwordx4 v11, s[4:7], s38 offen sc1 lds
    s_waitcnt lgkmcnt(2)
    v_mfma_f32_32x32x16_bf16 v[112:127], v[44:47], a[48:51], v[112:127]
    ds_read_b128 v[40:43], v11 offset:55296
    s_waitcnt vmcnt(11) lgkmcnt(2)
    v_mfma_f32_32x32x16_bf16 v[64:79], v[32:35], a[52:55], v[64:79]
    ds_read_b128 v[44:47], v11 offset:56320
    s_add_u32 m0, s36, 17408
    s_add_u32 s38, s30, 61440
    buffer_load_dwordx4 v11, s[4:7], s38 offen sc1 lds
    s_waitcnt lgkmcnt(2)
    v_mfma_f32_32x32x16_bf16 v[80:95], v[36:39], a[52:55], v[80:95]
    ds_read_b128 v[32:35], v11 offset:57344
    s_waitcnt lgkmcnt(2)
    v_mfma_f32_32x32x16_bf16 v[96:111], v[40:43], a[52:55], v[96:111]
    ds_read_b128 v[36:39], v11 offset:58368
    s_add_u32 m0, s36, 18432
    s_add_u32 s38, s30, 102400
    buffer_load_dwordx4 v11, s[4:7], s38 offen sc1 lds
    s_waitcnt lgkmcnt(2)
    v_mfma_f32_32x32x16_bf16 v[112:127], v[44:47], a[52:55], v[112:127]
    ds_read_b128 v[40:43], v11 offset:59392
    s_waitcnt vmcnt(12) lgkmcnt(2)
    v_mfma_f32_32x32x16_bf16 v[64:79], v[32:35], a[56:59], v[64:79]
    ds_read_b128 v[44:47], v11 offset:60416
    s_add_u32 m0, s36, 19456
    s_add_u32 s38, s30, 143360
    buffer_load_dwordx4 v11, s[4:7], s38 offen sc1 lds
    s_waitcnt lgkmcnt(2)
    v_mfma_f32_32x32x16_bf16 v[80:95], v[36:39], a[56:59], v[80:95]
    ds_read_b128 v[32:35], v11 offset:61440
    s_waitcnt lgkmcnt(2)
    v_mfma_f32_32x32x16_bf16 v[96:111], v[40:43], a[56:59], v[96:111]
    ds_read_b128 v[36:39], v11 offset:62464
    s_add_u32 s39, s28, 8192
    buffer_load_dwordx4 a[80:83], v10, s[4:7], s39 offen offset:2048 sc1
    s_waitcnt lgkmcnt(2)
    v_mfma_f32_32x32x16_bf16 v[112:127], v[44:47], a[56:59], v[112:127]
    ds_read_b128 v[40:43], v11 offset:63488
    s_waitcnt vmcnt(13) lgkmcnt(2)
    v_mfma_f32_32x32x16_bf16 v[64:79], v[32:35], a[60:63], v[64:79]
    ds_read_b128 v[44:47], v11 offset:64512
    s_add_u32 s39, s28, 8192
    buffer_load_dwordx4 a[84:87], v10, s[4:7], s39 offen offset:2560 sc1
    s_waitcnt lgkmcnt(2)
    v_mfma_f32_32x32x16_bf16 v[80:95], v[36:39], a[60:63], v[80:95]
    s_waitcnt vmcnt(10)
    s_barrier
    ds_read_b128 v[32:35], v11 offset:0
    s_waitcnt lgkmcnt(2)
    v_mfma_f32_32x32x16_bf16 v[96:111], v[40:43], a[60:63], v[96:111]
    ds_read_b128 v[36:39], v11 offset:1024
    s_waitcnt lgkmcnt(2)
    v_mfma_f32_32x32x16_bf16 v[112:127], v[44:47], a[60:63], v[112:127]
    ds_read_b128 v[40:43], v11 offset:2048
    s_add_u32 s39, s28, 8192
    buffer_load_dwordx4 a[88:91], v10, s[4:7], s39 offen offset:3072 sc1
    s_waitcnt vmcnt(10) lgkmcnt(2)
    v_mfma_f32_32x32x16_bf16 v[64:79], v[32:35], a[64:67], v[64:79]
    ds_read_b128 v[44:47], v11 offset:3072
    s_waitcnt lgkmcnt(2)
    v_mfma_f32_32x32x16_bf16 v[80:95], v[36:39], a[64:67], v[80:95]
    ds_read_b128 v[32:35], v11 offset:4096
    s_add_u32 s39, s28, 8192
    buffer_load_dwordx4 a[92:95], v10, s[4:7], s39 offen offset:3584 sc1
    s_waitcnt lgkmcnt(2)
    v_mfma_f32_32x32x16_bf16 v[96:111], v[40:43], a[64:67], v[96:111]
    ds_read_b128 v[36:39], v11 offset:5120
    s_waitcnt lgkmcnt(2)
    v_mfma_f32_32x32x16_bf16 v[112:127], v[44:47], a[64:67], v[112:127]
    ds_read_b128 v[40:43], v11 offset:6144
    s_add_u32 m0, s36, 32768
    s_add_u32 s38, s30, 24576
    buffer_load_dwordx4 v11, s[4:7], s38 offen sc1 lds
    s_waitcnt vmcnt(11) lgkmcnt(2)
    v_mfma_f32_32x32x16_bf16 v[64:79], v[32:35], a[68:71], v[64:79]
    ds_read_b128 v[44:47], v11 offset:7168
    s_waitcnt lgkmcnt(2)
    v_mfma_f32_32x32x16_bf16 v[80:95], v[36:39], a[68:71], v[80:95]
    ds_read_b128 v[32:35], v11 offset:8192
    s_add_u32 m0, s36, 33792
    s_add_u32 s38, s30, 65536
    buffer_load_dwordx4 v11, s[4:7], s38 offen sc1 lds
    s_waitcnt lgkmcnt(2)
    v_mfma_f32_32x32x16_bf16 v[96:111], v[40:43], a[68:71], v[96:111]
    ds_read_b128 v[36:39], v11 offset:9216
    s_waitcnt lgkmcnt(2)
    v_mfma_f32_32x32x16_bf16 v[112:127], v[44:47], a[68:71], v[112:127]
    ds_read_b128 v[40:43], v11 offset:10240
    s_add_u32 m0, s36, 34816
    s_add_u32 s38, s30, 106496
    buffer_load_dwordx4 v11, s[4:7], s38 offen sc1 lds
    s_waitcnt vmcnt(12) lgkmcnt(2)
    v_mfma_f32_32x32x16_bf16 v[64:79], v[32:35], a[72:75], v[64:79]
    ds_read_b128 v[44:47], v11 offset:11264
    s_waitcnt lgkmcnt(2)
    v_mfma_f32_32x32x16_bf16 v[80:95], v[36:39], a[72:75], v[80:95]
    ds_read_b128 v[32:35], v11 offset:12288
    s_add_u32 m0, s36, 35840
    s_add_u32 s38, s30, 147456
    buffer_load_dwordx4 v11, s[4:7], s38 offen sc1 lds
    s_waitcnt lgkmcnt(2)
    v_mfma_f32_32x32x16_bf16 v[96:111], v[40:43], a[72:75], v[96:111]
    ds_read_b128 v[36:39], v11 offset:13312
    s_waitcnt lgkmcnt(2)
    v_mfma_f32_32x32x16_bf16 v[112:127], v[44:47], a[72:75], v[112:127]
    ds_read_b128 v[40:43], v11 offset:14336
    s_add_u32 s39, s28, 12288
    buffer_load_dwordx4 a[96:99], v10, s[4:7], s39 offen offset:0 sc1
    s_waitcnt vmcnt(13) lgkmcnt(2)
    v_mfma_f32_32x32x16_bf16 v[64:79], v[32:35], a[76:79], v[64:79]
    ds_read_b128 v[44:47], v11 offset:15360
    s_waitcnt lgkmcnt(2)
    v_mfma_f32_32x32x16_bf16 v[80:95], v[36:39], a[76:79], v[80:95]
    s_waitcnt vmcnt(9)
    s_barrier
    ds_read_b128 v[32:35], v11 offset:16384
    s_add_u32 s39, s28, 12288
    buffer_load_dwordx4 a[100:103], v10, s[4:7], s39 offen offset:512 sc1
    s_waitcnt lgkmcnt(2)
    v_mfma_f32_32x32x16_bf16 v[96:111], v[40:43], a[76:79], v[96:111]
    ds_read_b128 v[36:39], v11 offset:17408
    s_waitcnt lgkmcnt(2)
    v_mfma_f32_32x32x16_bf16 v[112:127], v[44:47], a[76:79], v[112:127]
    ds_read_b128 v[40:43], v11 offset:18432
    s_add_u32 s39, s28, 12288
    buffer_load_dwordx4 a[104:107], v10, s[4:7], s39 offen offset:1024 sc1
    s_waitcnt vmcnt(10) lgkmcnt(2)
    v_mfma_f32_32x32x16_bf16 v[64:79], v[32:35], a[80:83], v[64:79]
    ds_read_b128 v[44:47], v11 offset:19456
    s_waitcnt lgkmcnt(2)
    v_mfma_f32_32x32x16_bf16 v[80:95], v[36:39], a[80:83], v[80:95]
    ds_read_b128 v[32:35], v11 offset:20480
    s_add_u32 s39, s28, 12288
    buffer_load_dwordx4 a[108:111], v10, s[4:7], s39 offen offset:1536 sc1
    s_waitcnt lgkmcnt(2)
    v_mfma_f32_32x32x16_bf16 v[96:111], v[40:43], a[80:83], v[96:111]
    ds_read_b128 v[36:39], v11 offset:21504
    s_waitcnt lgkmcnt(2)
    v_mfma_f32_32x32x16_bf16 v[112:127], v[44:47], a[80:83], v[112:127]
    ds_read_b128 v[40:43], v11 offset:22528
    s_waitcnt vmcnt(10) lgkmcnt(2)
    v_mfma_f32_32x32x16_bf16 v[64:79], v[32:35], a[84:87], v[64:79]
    ds_read_b128 v[44:47], v11 offset:23552
    s_add_u32 m0, s36, 49152
    s_add_u32 s38, s30, 28672
    buffer_load_dwordx4 v11, s[4:7], s38 offen sc1 lds
    s_waitcnt lgkmcnt(2)
    v_mfma_f32_32x32x16_bf16 v[80:95], v[36:39], a[84:87], v[80:95]
    ds_read_b128 v[32:35], v11 offset:24576
    s_waitcnt lgkmcnt(2)
    v_mfma_f32_32x32x16_bf16 v[96:111], v[40:43], a[84:87], v[96:111]
    ds_read_b128 v[36:39], v11 offset:25600
    s_add_u32 m0, s36, 50176
    s_add_u32 s38, s30, 69632
    buffer_load_dwordx4 v11, s[4:7], s38 offen sc1 lds
    s_waitcnt lgkmcnt(2)
    v_mfma_f32_32x32x16_bf16 v[112:127], v[44:47], a[84:87], v[112:127]
    ds_read_b128 v[40:43], v11 offset:26624
    s_waitcnt vmcnt(11) lgkmcnt(2)
    v_mfma_f32_32x32x16_bf16 v[64:79], v[32:35], a[88:91], v[64:79]
    ds_read_b128 v[44:47], v11 offset:27648
    s_add_u32 m0, s36, 51200
    s_add_u32 s38, s30, 110592
    buffer_load_dwordx4 v11, s[4:7], s38 offen sc1 lds
    s_waitcnt lgkmcnt(2)
    v_mfma_f32_32x32x16_bf16 v[80:95], v[36:39], a[88:91], v[80:95]
    ds_read_b128 v[32:35], v11 offset:28672
    s_waitcnt lgkmcnt(2)
    v_mfma_f32_32x32x16_bf16 v[96:111], v[40:43], a[88:91], v[96:111]
    ds_read_b128 v[36:39], v11 offset:29696
    s_add_u32 m0, s36, 52224
    s_add_u32 s38, s30, 151552
    buffer_load_dwordx4 v11, s[4:7], s38 offen sc1 lds
    s_waitcnt lgkmcnt(2)
    v_mfma_f32_32x32x16_bf16 v[112:127], v[44:47], a[88:91], v[112:127]
    ds_read_b128 v[40:43], v11 offset:30720
    s_waitcnt vmcnt(12) lgkmcnt(2)
    v_mfma_f32_32x32x16_bf16 v[64:79], v[32:35], a[92:95], v[64:79]
    ds_read_b128 v[44:47], v11 offset:31744
    s_add_u32 s39, s28, 12288
    buffer_load_dwordx4 a[112:115], v10, s[4:7], s39 offen offset:2048 sc1
    s_waitcnt lgkmcnt(2)
    v_mfma_f32_32x32x16_bf16 v[80:95], v[36:39], a[92:95], v[80:95]
    s_waitcnt vmcnt(9)
    s_barrier
    ds_read_b128 v[32:35], v11 offset:32768
    s_waitcnt lgkmcnt(2)
    v_mfma_f32_32x32x16_bf16 v[96:111], v[40:43], a[92:95], v[96:111]
    ds_read_b128 v[36:39], v11 offset:33792
    s_add_u32 s39, s28, 12288
    buffer_load_dwordx4 a[116:119], v10, s[4:7], s39 offen offset:2560 sc1
    s_waitcnt lgkmcnt(2)
    v_mfma_f32_32x32x16_bf16 v[112:127], v[44:47], a[92:95], v[112:127]
    ds_read_b128 v[40:43], v11 offset:34816
    s_waitcnt vmcnt(9) lgkmcnt(2)
    v_mfma_f32_32x32x16_bf16 v[64:79], v[32:35], a[96:99], v[64:79]
    ds_read_b128 v[44:47], v11 offset:35840
    s_add_u32 s39, s28, 12288
    buffer_load_dwordx4 a[120:123], v10, s[4:7], s39 offen offset:3072 sc1
    s_waitcnt lgkmcnt(2)
    v_mfma_f32_32x32x16_bf16 v[80:95], v[36:39], a[96:99], v[80:95]
    ds_read_b128 v[32:35], v11 offset:36864
    s_waitcnt lgkmcnt(2)
    v_mfma_f32_32x32x16_bf16 v[96:111], v[40:43], a[96:99], v[96:111]
    ds_read_b128 v[36:39], v11 offset:37888
    s_add_u32 s39, s28, 12288
    buffer_load_dwordx4 a[124:127], v10, s[4:7], s39 offen offset:3584 sc1
    s_waitcnt lgkmcnt(2)
    v_mfma_f32_32x32x16_bf16 v[112:127], v[44:47], a[96:99], v[112:127]
    ds_read_b128 v[40:43], v11 offset:38912
    s_waitcnt vmcnt(10) lgkmcnt(2)
    v_mfma_f32_32x32x16_bf16 v[64:79], v[32:35], a[100:103], v[64:79]
    ds_read_b128 v[44:47], v11 offset:39936
    s_add_u32 m0, s36, 0
    s_add_u32 s38, s30, 32768
    buffer_load_dwordx4 v11, s[4:7], s38 offen sc1 lds
    s_waitcnt lgkmcnt(2)
    v_mfma_f32_32x32x16_bf16 v[80:95], v[36:39], a[100:103], v[80:95]
    ds_read_b128 v[32:35], v11 offset:40960
    s_waitcnt lgkmcnt(2)
    v_mfma_f32_32x32x16_bf16 v[96:111], v[40:43], a[100:103], v[96:111]
    ds_read_b128 v[36:39], v11 offset:41984
    s_add_u32 m0, s36, 1024
    s_add_u32 s38, s30, 73728
    buffer_load_dwordx4 v11, s[4:7], s38 offen sc1 lds
    s_waitcnt lgkmcnt(2)
    v_mfma_f32_32x32x16_bf16 v[112:127], v[44:47], a[100:103], v[112:127]
    ds_read_b128 v[40:43], v11 offset:43008
    s_waitcnt vmcnt(11) lgkmcnt(2)
    v_mfma_f32_32x32x16_bf16 v[64:79], v[32:35], a[104:107], v[64:79]
    ds_read_b128 v[44:47], v11 offset:44032
    s_waitcnt lgkmcnt(2)
    v_mfma_f32_32x32x16_bf16 v[80:95], v[36:39], a[104:107], v[80:95]
    ds_read_b128 v[32:35], v11 offset:45056
    s_add_u32 m0, s36, 2048
    s_add_u32 s38, s30, 114688
    buffer_load_dwordx4 v11, s[4:7], s38 offen sc1 lds
    s_waitcnt lgkmcnt(2)
    v_mfma_f32_32x32x16_bf16 v[96:111], v[40:43], a[104:107], v[96:111]
    ds_read_b128 v[36:39], v11 offset:46080
    s_waitcnt lgkmcnt(2)
    v_mfma_f32_32x32x16_bf16 v[112:127], v[44:47], a[104:107], v[112:127]
    ds_read_b128 v[40:43], v11 offset:47104
    s_add_u32 m0, s36, 3072
    s_add_u32 s38, s30, 155648
    buffer_load_dwordx4 v11, s[4:7], s38 offen sc1 lds
    s_waitcnt vmcnt(12) lgkmcnt(2)
    v_mfma_f32_32x32x16_bf16 v[64:79], v[32:35], a[108:111], v[64:79]
    ds_read_b128 v[44:47], v11 offset:48128
    s_waitcnt lgkmcnt(2)
    v_mfma_f32_32x32x16_bf16 v[80:95], v[36:39], a[108:111], v[80:95]
    s_waitcnt vmcnt(8)
    s_barrier
    ds_read_b128 v[32:35], v11 offset:49152
    s_add_u32 s39, s28, 16384
    buffer_load_dwordx4 a[128:131], v10, s[4:7], s39 offen offset:0 sc1
    s_waitcnt lgkmcnt(2)
    v_mfma_f32_32x32x16_bf16 v[96:111], v[40:43], a[108:111], v[96:111]
    ds_read_b128 v[36:39], v11 offset:50176
    s_waitcnt lgkmcnt(2)
    v_mfma_f32_32x32x16_bf16 v[112:127], v[44:47], a[108:111], v[112:127]
    ds_read_b128 v[40:43], v11 offset:51200
    s_add_u32 s39, s28, 16384
    buffer_load_dwordx4 a[132:135], v10, s[4:7], s39 offen offset:512 sc1
    s_waitcnt vmcnt(9) lgkmcnt(2)
    v_mfma_f32_32x32x16_bf16 v[64:79], v[32:35], a[112:115], v[64:79]
    ds_read_b128 v[44:47], v11 offset:52224
    s_waitcnt lgkmcnt(2)
    v_mfma_f32_32x32x16_bf16 v[80:95], v[36:39], a[112:115], v[80:95]
    ds_read_b128 v[32:35], v11 offset:53248
    s_add_u32 s39, s28, 16384
    buffer_load_dwordx4 a[136:139], v10, s[4:7], s39 offen offset:1024 sc1
    s_waitcnt lgkmcnt(2)
    v_mfma_f32_32x32x16_bf16 v[96:111], v[40:43], a[112:115], v[96:111]
    ds_read_b128 v[36:39], v11 offset:54272
    s_waitcnt lgkmcnt(2)
    v_mfma_f32_32x32x16_bf16 v[112:127], v[44:47], a[112:115], v[112:127]
    ds_read_b128 v[40:43], v11 offset:55296
    s_add_u32 s39, s28, 16384
    buffer_load_dwordx4 a[140:143], v10, s[4:7], s39 offen offset:1536 sc1
    s_waitcnt vmcnt(10) lgkmcnt(2)
    v_mfma_f32_32x32x16_bf16 v[64:79], v[32:35], a[116:119], v[64:79]
    ds_read_b128 v[44:47], v11 offset:56320
    s_waitcnt lgkmcnt(2)
    v_mfma_f32_32x32x16_bf16 v[80:95], v[36:39], a[116:119], v[80:95]
    ds_read_b128 v[32:35], v11 offset:57344
    s_add_u32 m0, s36, 16384
    s_add_u32 s38, s30, 36864
    buffer_load_dwordx4 v11, s[4:7], s38 offen sc1 lds
    s_waitcnt lgkmcnt(2)
    v_mfma_f32_32x32x16_bf16 v[96:111], v[40:43], a[116:119], v[96:111]
    ds_read_b128 v[36:39], v11 offset:58368
    s_waitcnt lgkmcnt(2)
    v_mfma_f32_32x32x16_bf16 v[112:127], v[44:47], a[116:119], v[112:127]
    ds_read_b128 v[40:43], v11 offset:59392
    s_add_u32 m0, s36, 17408
    s_add_u32 s38, s30, 77824
    buffer_load_dwordx4 v11, s[4:7], s38 offen sc1 lds
    s_waitcnt vmcnt(11) lgkmcnt(2)
    v_mfma_f32_32x32x16_bf16 v[64:79], v[32:35], a[120:123], v[64:79]
    ds_read_b128 v[44:47], v11 offset:60416
    s_waitcnt lgkmcnt(2)
    v_mfma_f32_32x32x16_bf16 v[80:95], v[36:39], a[120:123], v[80:95]
    ds_read_b128 v[32:35], v11 offset:61440
    s_add_u32 m0, s36, 18432
    s_add_u32 s38, s30, 118784
    buffer_load_dwordx4 v11, s[4:7], s38 offen sc1 lds
    s_waitcnt lgkmcnt(2)
    v_mfma_f32_32x32x16_bf16 v[96:111], v[40:43], a[120:123], v[96:111]
    ds_read_b128 v[36:39], v11 offset:62464
    s_waitcnt lgkmcnt(2)
    v_mfma_f32_32x32x16_bf16 v[112:127], v[44:47], a[120:123], v[112:127]
    ds_read_b128 v[40:43], v11 offset:63488
    s_add_u32 m0, s36, 19456
    s_add_u32 s38, s30, 159744
    buffer_load_dwordx4 v11, s[4:7], s38 offen sc1 lds
    s_waitcnt vmcnt(12) lgkmcnt(2)
    v_mfma_f32_32x32x16_bf16 v[64:79], v[32:35], a[124:127], v[64:79]
    ds_read_b128 v[44:47], v11 offset:64512
    s_waitcnt lgkmcnt(2)
    v_mfma_f32_32x32x16_bf16 v[80:95], v[36:39], a[124:127], v[80:95]
    s_waitcnt vmcnt(8)
    s_barrier
    ds_read_b128 v[32:35], v11 offset:0
    s_waitcnt lgkmcnt(2)
    v_mfma_f32_32x32x16_bf16 v[96:111], v[40:43], a[124:127], v[96:111]
    ds_read_b128 v[36:39], v11 offset:1024
    s_add_u32 s39, s28, 16384
    buffer_load_dwordx4 a[144:147], v10, s[4:7], s39 offen offset:2048 sc1
    s_waitcnt lgkmcnt(2)
    v_mfma_f32_32x32x16_bf16 v[112:127], v[44:47], a[124:127], v[112:127]
    ds_read_b128 v[40:43], v11 offset:2048
    s_waitcnt vmcnt(8) lgkmcnt(2)
    v_mfma_f32_32x32x16_bf16 v[64:79], v[32:35], a[128:131], v[64:79]
    ds_read_b128 v[44:47], v11 offset:3072
    s_add_u32 s39, s28, 16384
    buffer_load_dwordx4 a[148:151], v10, s[4:7], s39 offen offset:2560 sc1
    s_waitcnt lgkmcnt(2)
    v_mfma_f32_32x32x16_bf16 v[80:95], v[36:39], a[128:131], v[80:95]
    ds_read_b128 v[32:35], v11 offset:4096
    s_waitcnt lgkmcnt(2)
    v_mfma_f32_32x32x16_bf16 v[96:111], v[40:43], a[128:131], v[96:111]
    ds_read_b128 v[36:39], v11 offset:5120
    s_add_u32 s39, s28, 16384
    buffer_load_dwordx4 a[152:155], v10, s[4:7], s39 offen offset:3072 sc1
    s_waitcnt lgkmcnt(2)
    v_mfma_f32_32x32x16_bf16 v[112:127], v[44:47], a[128:131], v[112:127]
    ds_read_b128 v[40:43], v11 offset:6144
    s_waitcnt vmcnt(9) lgkmcnt(2)
    v_mfma_f32_32x32x16_bf16 v[64:79], v[32:35], a[132:135], v[64:79]
    ds_read_b128 v[44:47], v11 offset:7168
    s_add_u32 s39, s28, 16384
    buffer_load_dwordx4 a[156:159], v10, s[4:7], s39 offen offset:3584 sc1
    s_waitcnt lgkmcnt(2)
    v_mfma_f32_32x32x16_bf16 v[80:95], v[36:39], a[132:135], v[80:95]
    ds_read_b128 v[32:35], v11 offset:8192
    s_waitcnt lgkmcnt(2)
    v_mfma_f32_32x32x16_bf16 v[96:111], v[40:43], a[132:135], v[96:111]
    ds_read_b128 v[36:39], v11 offset:9216
    s_add_u32 m0, s34, 32768
    s_add_u32 s38, s30, 163840
    buffer_load_dwordx4 v11, s[4:7], s38 offen sc1 lds
    s_waitcnt lgkmcnt(2)
    v_mfma_f32_32x32x16_bf16 v[112:127], v[44:47], a[132:135], v[112:127]
    ds_read_b128 v[40:43], v11 offset:10240
    s_waitcnt vmcnt(10) lgkmcnt(2)
    v_mfma_f32_32x32x16_bf16 v[64:79], v[32:35], a[136:139], v[64:79]
    ds_read_b128 v[44:47], v11 offset:11264
    s_add_u32 m0, s34, 33792
    s_add_u32 s38, s30, 204800
    buffer_load_dwordx4 v11, s[4:7], s38 offen sc1 lds
    s_waitcnt lgkmcnt(2)
    v_mfma_f32_32x32x16_bf16 v[80:95], v[36:39], a[136:139], v[80:95]
    ds_read_b128 v[32:35], v11 offset:12288
    s_waitcnt lgkmcnt(2)
    v_mfma_f32_32x32x16_bf16 v[96:111], v[40:43], a[136:139], v[96:111]
    ds_read_b128 v[36:39], v11 offset:13312
    s_add_u32 m0, s34, 40960
    s_add_u32 s38, s30, 167936
    buffer_load_dwordx4 v11, s[4:7], s38 offen sc1 lds
    s_waitcnt lgkmcnt(2)
    v_mfma_f32_32x32x16_bf16 v[112:127], v[44:47], a[136:139], v[112:127]
    ds_read_b128 v[40:43], v11 offset:14336
    s_waitcnt vmcnt(11) lgkmcnt(2)
    v_mfma_f32_32x32x16_bf16 v[64:79], v[32:35], a[140:143], v[64:79]
    ds_read_b128 v[44:47], v11 offset:15360
    s_add_u32 m0, s34, 41984
    s_add_u32 s38, s30, 208896
    buffer_load_dwordx4 v11, s[4:7], s38 offen sc1 lds
    s_waitcnt lgkmcnt(2)
    v_mfma_f32_32x32x16_bf16 v[80:95], v[36:39], a[140:143], v[80:95]
    v_and_b32 v236, 7, v0
    v_mul_u32_u24 v236, 256, v236
    s_mov_b32 s57, 34406400
    buffer_load_dword v237, v236, s[4:7], s57 offen sc1
    s_waitcnt vmcnt(9)
    s_barrier
    ds_read_b128 v[32:35], v11 offset:16384
    s_waitcnt lgkmcnt(2)
    v_mfma_f32_32x32x16_bf16 v[96:111], v[40:43], a[140:143], v[96:111]
    ds_read_b128 v[36:39], v11 offset:17408
    s_add_u32 m0, s34, 49152
    s_add_u32 s38, s30, 172032
    buffer_load_dwordx4 v11, s[4:7], s38 offen sc1 lds
    s_waitcnt lgkmcnt(2)
    v_mfma_f32_32x32x16_bf16 v[112:127], v[44:47], a[140:143], v[112:127]
    ds_read_b128 v[40:43], v11 offset:18432
    s_waitcnt vmcnt(9) lgkmcnt(2)
    v_mfma_f32_32x32x16_bf16 v[64:79], v[32:35], a[144:147], v[64:79]
    ds_read_b128 v[44:47], v11 offset:19456
    s_add_u32 m0, s34, 50176
    s_add_u32 s38, s30, 212992
    buffer_load_dwordx4 v11, s[4:7], s38 offen sc1 lds
    s_waitcnt lgkmcnt(2)
    v_mfma_f32_32x32x16_bf16 v[80:95], v[36:39], a[144:147], v[80:95]
    ds_read_b128 v[32:35], v11 offset:20480
    s_waitcnt lgkmcnt(2)
    v_mfma_f32_32x32x16_bf16 v[96:111], v[40:43], a[144:147], v[96:111]
    ds_read_b128 v[36:39], v11 offset:21504
    s_waitcnt lgkmcnt(2)
    v_mfma_f32_32x32x16_bf16 v[112:127], v[44:47], a[144:147], v[112:127]
    ds_read_b128 v[40:43], v11 offset:22528
    s_add_u32 m0, s34, 57344
    s_add_u32 s38, s30, 176128
    buffer_load_dwordx4 v11, s[4:7], s38 offen sc1 lds
    s_waitcnt vmcnt(10) lgkmcnt(2)
    v_mfma_f32_32x32x16_bf16 v[64:79], v[32:35], a[148:151], v[64:79]
    ds_read_b128 v[44:47], v11 offset:23552
    s_waitcnt lgkmcnt(2)
    v_mfma_f32_32x32x16_bf16 v[80:95], v[36:39], a[148:151], v[80:95]
    ds_read_b128 v[32:35], v11 offset:24576
    s_add_u32 m0, s34, 58368
    s_add_u32 s38, s30, 217088
    buffer_load_dwordx4 v11, s[4:7], s38 offen sc1 lds
    s_waitcnt lgkmcnt(2)
    v_mfma_f32_32x32x16_bf16 v[96:111], v[40:43], a[148:151], v[96:111]
    ds_read_b128 v[36:39], v11 offset:25600
    s_waitcnt lgkmcnt(2)
    v_mfma_f32_32x32x16_bf16 v[112:127], v[44:47], a[148:151], v[112:127]
    ds_read_b128 v[40:43], v11 offset:26624
    s_waitcnt vmcnt(10) lgkmcnt(2)
    v_mfma_f32_32x32x16_bf16 v[64:79], v[32:35], a[152:155], v[64:79]
    ds_read_b128 v[44:47], v11 offset:27648
    s_waitcnt lgkmcnt(2)
    v_mfma_f32_32x32x16_bf16 v[80:95], v[36:39], a[152:155], v[80:95]
    ds_read_b128 v[32:35], v11 offset:28672
    s_waitcnt lgkmcnt(2)
    v_mfma_f32_32x32x16_bf16 v[96:111], v[40:43], a[152:155], v[96:111]
    ds_read_b128 v[36:39], v11 offset:29696
    s_waitcnt lgkmcnt(2)
    v_mfma_f32_32x32x16_bf16 v[112:127], v[44:47], a[152:155], v[112:127]
    ds_read_b128 v[40:43], v11 offset:30720
    s_waitcnt vmcnt(9) lgkmcnt(2)
    v_mfma_f32_32x32x16_bf16 v[64:79], v[32:35], a[156:159], v[64:79]
    ds_read_b128 v[44:47], v11 offset:31744
    s_waitcnt lgkmcnt(2)
    v_mfma_f32_32x32x16_bf16 v[80:95], v[36:39], a[156:159], v[80:95]
    s_mov_b32 s62, 0
    s_waitcnt vmcnt(4)
    v_cmp_gt_u32 vcc, 15, v237
    s_nop 1
    s_cmp_eq_u64 vcc, 0
    s_cbranch_scc1 L30_apd
    v_and_b32 v236, 7, v0
    v_mul_u32_u24 v236, 256, v236
    s_mov_b32 s57, 34406400
L29_ap:
    buffer_load_dword v237, v236, s[4:7], s57 offen sc1
    s_waitcnt vmcnt(0)
    v_cmp_gt_u32 vcc, 15, v237
    s_add_u32 s62, s62, 1
    s_nop 1
    s_cmp_eq_u64 vcc, 0
    s_cbranch_scc1 L30_apd
    s_cmp_lt_u32 s62, 65536
    s_cbranch_scc1 L29_ap
L30_apd:
    s_barrier
    ds_read_b128 v[32:35], v11 offset:32768
    s_add_u32 m0, s34, 0
    s_add_u32 s38, s30, 180224
    buffer_load_dwordx4 v11, s[4:7], s38 offen sc1 lds
    s_waitcnt lgkmcnt(2)
    v_mfma_f32_32x32x16_bf16 v[96:111], v[40:43], a[156:159], v[96:111]
    ds_read_b128 v[36:39], v11 offset:33792
    s_add_u32 m0, s34, 1024
    s_add_u32 s38, s30, 221184
    buffer_load_dwordx4 v11, s[4:7], s38 offen sc1 lds
    s_waitcnt lgkmcnt(2)
    v_mfma_f32_32x32x16_bf16 v[112:127], v[44:47], a[156:159], v[112:127]
    ds_read_b128 v[40:43], v11 offset:34816
    s_waitcnt lgkmcnt(2)
    v_mfma_f32_32x32x16_bf16 v[128:143], v[32:35], a[0:3], 0
    ds_read_b128 v[44:47], v11 offset:35840
    s_add_u32 m0, s34, 8192
    s_add_u32 s38, s30, 184320
    buffer_load_dwordx4 v11, s[4:7], s38 offen sc1 lds
    ds_read_b128 v[200:203], v13 offset:0
    ds_read_b128 v[204:207], v13 offset:32
    ds_read_b128 v[208:211], v13 offset:64
    s_waitcnt lgkmcnt(5)
    v_mfma_f32_32x32x16_bf16 v[144:159], v[36:39], a[0:3], 0
    ds_read_b128 v[32:35], v11 offset:36864
    ds_read_b128 v[212:215], v13 offset:96
    s_waitcnt lgkmcnt(4)
    v_fma_f32 v64, v56, v200, v64
    v_fma_f32 v65, v56, v201, v65
    v_fma_f32 v66, v56, v202, v66
    v_fma_f32 v67, v56, v203, v67
    v_mfma_f32_32x32x16_bf16 v[128:143], v[40:43], a[4:7], v[128:143]
    ds_read_b128 v[36:39], v11 offset:37888
    s_waitcnt lgkmcnt(4)
    v_fma_f32 v68, v56, v204, v68
    v_fma_f32 v69, v56, v205, v69
    v_fma_f32 v70, v56, v206, v70
    v_fma_f32 v71, v56, v207, v71
    v_mul_f32 v64, v58, v64
    v_mfma_f32_32x32x16_bf16 v[144:159], v[44:47], a[4:7], v[144:159]
    ds_read_b128 v[40:43], v11 offset:38912
    s_add_u32 m0, s34, 9216
    s_add_u32 s38, s30, 225280
    buffer_load_dwordx4 v11, s[4:7], s38 offen sc1 lds
    v_mul_f32 v65, v58, v65
    v_mul_f32 v66, v58, v66
    v_mul_f32 v67, v58, v67
    s_waitcnt lgkmcnt(3)
    v_mfma_f32_32x32x16_bf16 v[128:143], v[32:35], a[8:11], v[128:143]
    ds_read_b128 v[44:47], v11 offset:39936
    v_mul_f32 v68, v58, v68
    v_mul_f32 v69, v58, v69
    v_mul_f32 v70, v58, v70
    v_mul_f32 v71, v58, v71
    s_waitcnt lgkmcnt(2)
    v_mfma_f32_32x32x16_bf16 v[144:159], v[36:39], a[8:11], v[144:159]
    ds_read_b128 v[32:35], v11 offset:40960
    s_add_u32 s45, s44, 0
    buffer_load_dwordx4 a[160:163], v11, s[4:7], s45 offen offset:0 sc1
    v_exp_f32 v64, v64
    v_fma_f32 v72, v56, v208, v72
    s_waitcnt lgkmcnt(2)
    v_mfma_f32_32x32x16_bf16 v[128:143], v[40:43], a[12:15], v[128:143]
    ds_read_b128 v[36:39], v11 offset:41984
    v_exp_f32 v65, v65
    v_fma_f32 v73, v56, v209, v73
    v_exp_f32 v66, v66
    s_waitcnt lgkmcnt(2)
    v_mfma_f32_32x32x16_bf16 v[144:159], v[44:47], a[12:15], v[144:159]
    ds_read_b128 v[40:43], v11 offset:43008
    s_add_u32 s45, s44, 0
    buffer_load_dwordx4 a[164:167], v11, s[4:7], s45 offen offset:1024 sc1
    v_fma_f32 v74, v56, v210, v74
    v_exp_f32 v67, v67
    s_waitcnt lgkmcnt(2)
    v_mfma_f32_32x32x16_bf16 v[128:143], v[32:35], a[16:19], v[128:143]
    ds_read_b128 v[44:47], v11 offset:44032
    v_fma_f32 v75, v56, v211, v75
    v_exp_f32 v68, v68
    v_fma_f32 v76, v56, v212, v76
    s_waitcnt lgkmcnt(2)
    v_mfma_f32_32x32x16_bf16 v[144:159], v[36:39], a[16:19], v[144:159]
    ds_read_b128 v[32:35], v11 offset:45056
    s_add_u32 s45, s44, 0
    buffer_load_dwordx4 a[168:171], v11, s[4:7], s45 offen offset:2048 sc1
    v_exp_f32 v69, v69
    v_fma_f32 v77, v56, v213, v77
    s_waitcnt lgkmcnt(2)
    v_mfma_f32_32x32x16_bf16 v[128:143], v[40:43], a[20:23], v[128:143]
    ds_read_b128 v[36:39], v11 offset:46080
    v_exp_f32 v70, v70
    v_fma_f32 v78, v56, v214, v78
    v_exp_f32 v71, v71
    s_waitcnt lgkmcnt(2)
    v_mfma_f32_32x32x16_bf16 v[144:159], v[44:47], a[20:23], v[144:159]
    ds_read_b128 v[40:43], v11 offset:47104
    s_add_u32 s45, s44, 0
    buffer_load_dwordx4 a[172:175], v11, s[4:7], s45 offen offset:3072 sc1
    v_fma_f32 v79, v56, v215, v79
    v_fma_f32 v64, v64, v57, v57
    v_fma_f32 v65, v65, v57, v57
    s_waitcnt lgkmcnt(2)
    v_mfma_f32_32x32x16_bf16 v[128:143], v[32:35], a[24:27], v[128:143]
    ds_read_b128 v[44:47], v11 offset:48128
    v_rcp_f32 v64, v64
    v_fma_f32 v66, v66, v57, v57
    v_rcp_f32 v65, v65
    s_waitcnt lgkmcnt(2)
    v_mfma_f32_32x32x16_bf16 v[144:159], v[36:39], a[24:27], v[144:159]
    s_waitcnt vmcnt(8)
    s_barrier
    ds_read_b128 v[32:35], v11 offset:49152
    s_add_u32 m0, s34, 16384
    s_add_u32 s38, s30, 188416
    buffer_load_dwordx4 v11, s[4:7], s38 offen sc1 lds
    v_fma_f32 v67, v67, v57, v57
    v_rcp_f32 v66, v66
    s_waitcnt lgkmcnt(2)
    v_mfma_f32_32x32x16_bf16 v[128:143], v[40:43], a[28:31], v[128:143]
    ds_read_b128 v[36:39], v11 offset:50176
    v_fma_f32 v68, v68, v57, v57
    v_rcp_f32 v67, v67
    v_fma_f32 v69, v69, v57, v57
    s_waitcnt lgkmcnt(2)
    v_mfma_f32_32x32x16_bf16 v[144:159], v[44:47], a[28:31], v[144:159]
    ds_read_b128 v[40:43], v11 offset:51200
    s_add_u32 m0, s34, 17408
    s_add_u32 s38, s30, 229376
    buffer_load_dwordx4 v11, s[4:7], s38 offen sc1 lds
    v_rcp_f32 v68, v68
    v_fma_f32 v70, v70, v57, v57
    s_waitcnt lgkmcnt(2)
    v_mfma_f32_32x32x16_bf16 v[128:143], v[32:35], a[32:35], v[128:143]
    ds_read_b128 v[44:47], v11 offset:52224
    v_rcp_f32 v69, v69
    v_fma_f32 v71, v71, v57, v57
    v_rcp_f32 v70, v70
    s_waitcnt lgkmcnt(2)
    v_mfma_f32_32x32x16_bf16 v[144:159], v[36:39], a[32:35], v[144:159]
    ds_read_b128 v[32:35], v11 offset:53248
    s_add_u32 m0, s34, 24576
    s_add_u32 s38, s30, 192512
    buffer_load_dwordx4 v11, s[4:7], s38 offen sc1 lds
    v_rcp_f32 v71, v71
    v_mul_f32 v72, v72, v64
    s_waitcnt lgkmcnt(2)
    v_mfma_f32_32x32x16_bf16 v[128:143], v[40:43], a[36:39], v[128:143]
    ds_read_b128 v[36:39], v11 offset:54272
    v_mul_f32 v73, v73, v65
    v_mul_f32 v74, v74, v66
    v_mul_f32 v75, v75, v67
    v_mul_f32 v76, v76, v68
    v_mul_f32 v77, v77, v69
    s_waitcnt lgkmcnt(2)
    v_mfma_f32_32x32x16_bf16 v[144:159], v[44:47], a[36:39], v[144:159]
    ds_read_b128 v[40:43], v11 offset:55296
    s_add_u32 m0, s34, 25600
    s_add_u32 s38, s30, 233472
    buffer_load_dwordx4 v11, s[4:7], s38 offen sc1 lds
    v_mul_f32 v78, v78, v70
    v_mul_f32 v79, v79, v71
    v_cvt_pk_bf16_f32 v216, v72, v73
    s_waitcnt lgkmcnt(2)
    v_mfma_f32_32x32x16_bf16 v[128:143], v[32:35], a[40:43], v[128:143]
    ds_read_b128 v[44:47], v11 offset:56320
    v_cvt_pk_bf16_f32 v217, v74, v75
    v_cvt_pk_bf16_f32 v218, v76, v77
    v_cvt_pk_bf16_f32 v219, v78, v79
    buffer_store_dwordx4 v[216:219], v12, s[4:7], s47 offen sc1
    ds_read_b128 v[200:203], v13 offset:128
    s_waitcnt lgkmcnt(3)
    v_mfma_f32_32x32x16_bf16 v[144:159], v[36:39], a[40:43], v[144:159]
    ds_read_b128 v[32:35], v11 offset:57344
    ds_read_b128 v[204:207], v13 offset:160
    ds_read_b128 v[208:211], v13 offset:192
    ds_read_b128 v[212:215], v13 offset:224
    s_waitcnt lgkmcnt(4)
    v_fma_f32 v80, v56, v200, v80
    v_fma_f32 v81, v56, v201, v81
    v_mfma_f32_32x32x16_bf16 v[128:143], v[40:43], a[44:47], v[128:143]
    ds_read_b128 v[36:39], v11 offset:58368
    v_fma_f32 v82, v56, v202, v82
    v_fma_f32 v83, v56, v203, v83
    s_waitcnt lgkmcnt(3)
    v_fma_f32 v84, v56, v204, v84
    v_fma_f32 v85, v56, v205, v85
    v_fma_f32 v86, v56, v206, v86
    v_mfma_f32_32x32x16_bf16 v[144:159], v[44:47], a[44:47], v[144:159]
    ds_read_b128 v[40:43], v11 offset:59392
    v_fma_f32 v87, v56, v207, v87
    v_mul_f32 v80, v58, v80
    v_mul_f32 v81, v58, v81
    v_mul_f32 v82, v58, v82
    v_mul_f32 v83, v58, v83
    v_mfma_f32_32x32x16_bf16 v[128:143], v[32:35], a[48:51], v[128:143]
    ds_read_b128 v[44:47], v11 offset:60416
    s_add_u32 s45, s44, 4096
    buffer_load_dwordx4 a[176:179], v11, s[4:7], s45 offen offset:0 sc1
    v_mul_f32 v84, v58, v84
    v_mul_f32 v85, v58, v85
    v_mul_f32 v86, v58, v86
    s_waitcnt lgkmcnt(2)
    v_mfma_f32_32x32x16_bf16 v[144:159], v[36:39], a[48:51], v[144:159]
    ds_read_b128 v[32:35], v11 offset:61440
    v_mul_f32 v87, v58, v87
    v_exp_f32 v80, v80
    v_fma_f32 v88, v56, v208, v88
    s_waitcnt lgkmcnt(2)
    v_mfma_f32_32x32x16_bf16 v[128:143], v[40:43], a[52:55], v[128:143]
    ds_read_b128 v[36:39], v11 offset:62464
    s_add_u32 s45, s44, 5120
    buffer_load_dwordx4 a[180:183], v11, s[4:7], s45 offen offset:0 sc1
    v_exp_f32 v81, v81
    v_fma_f32 v89, v56, v209, v89
    s_waitcnt lgkmcnt(2)
    v_mfma_f32_32x32x16_bf16 v[144:159], v[44:47], a[52:55], v[144:159]
    ds_read_b128 v[40:43], v11 offset:63488
    v_exp_f32 v82, v82
    v_fma_f32 v90, v56, v210, v90
    v_exp_f32 v83, v83
    s_waitcnt lgkmcnt(2)
    v_mfma_f32_32x32x16_bf16 v[128:143], v[32:35], a[56:59], v[128:143]
    ds_read_b128 v[44:47], v11 offset:64512
    s_add_u32 s45, s44, 5120
    buffer_load_dwordx4 a[184:187], v11, s[4:7], s45 offen offset:1024 sc1
    v_fma_f32 v91, v56, v211, v91
    v_exp_f32 v84, v84
    s_waitcnt lgkmcnt(2)
    v_mfma_f32_32x32x16_bf16 v[144:159], v[36:39], a[56:59], v[144:159]
    s_waitcnt vmcnt(12)
    s_barrier
    ds_read_b128 v[32:35], v11 offset:0
    v_fma_f32 v92, v56, v212, v92
    v_exp_f32 v85, v85
    v_fma_f32 v93, v56, v213, v93
    s_waitcnt lgkmcnt(2)
    v_mfma_f32_32x32x16_bf16 v[128:143], v[40:43], a[60:63], v[128:143]
    ds_read_b128 v[36:39], v11 offset:1024
    s_add_u32 m0, s34, 32768
    s_add_u32 s38, s30, 196608
    buffer_load_dwordx4 v11, s[4:7], s38 offen sc1 lds
    v_exp_f32 v86, v86
    v_fma_f32 v94, v56, v214, v94
    s_waitcnt lgkmcnt(2)
    v_mfma_f32_32x32x16_bf16 v[144:159], v[44:47], a[60:63], v[144:159]
    ds_read_b128 v[40:43], v11 offset:2048
    v_exp_f32 v87, v87
    v_fma_f32 v95, v56, v215, v95
    v_fma_f32 v80, v80, v57, v57
    v_fma_f32 v81, v81, v57, v57
    s_waitcnt lgkmcnt(2)
    v_mfma_f32_32x32x16_bf16 v[128:143], v[32:35], a[64:67], v[128:143]
    ds_read_b128 v[44:47], v11 offset:3072
    s_add_u32 m0, s34, 33792
    s_add_u32 s38, s30, 237568
    buffer_load_dwordx4 v11, s[4:7], s38 offen sc1 lds
    v_rcp_f32 v80, v80
    v_fma_f32 v82, v82, v57, v57
    s_waitcnt lgkmcnt(2)
    v_mfma_f32_32x32x16_bf16 v[144:159], v[36:39], a[64:67], v[144:159]
    ds_read_b128 v[32:35], v11 offset:4096
    v_rcp_f32 v81, v81
    v_fma_f32 v83, v83, v57, v57
    v_rcp_f32 v82, v82
    s_waitcnt lgkmcnt(2)
    v_mfma_f32_32x32x16_bf16 v[128:143], v[40:43], a[68:71], v[128:143]
    ds_read_b128 v[36:39], v11 offset:5120
    s_add_u32 m0, s34, 40960
    s_add_u32 s38, s30, 200704
    buffer_load_dwordx4 v11, s[4:7], s38 offen sc1 lds
    v_fma_f32 v84, v84, v57, v57
    v_rcp_f32 v83, v83
    s_waitcnt lgkmcnt(2)
    v_mfma_f32_32x32x16_bf16 v[144:159], v[44:47], a[68:71], v[144:159]
    ds_read_b128 v[40:43], v11 offset:6144
    v_fma_f32 v85, v85, v57, v57
    v_rcp_f32 v84, v84
    v_fma_f32 v86, v86, v57, v57
    s_waitcnt lgkmcnt(2)
    v_mfma_f32_32x32x16_bf16 v[128:143], v[32:35], a[72:75], v[128:143]
    ds_read_b128 v[44:47], v11 offset:7168
    s_add_u32 m0, s34, 41984
    s_add_u32 s38, s30, 241664
    buffer_load_dwordx4 v11, s[4:7], s38 offen sc1 lds
    v_rcp_f32 v85, v85
    v_fma_f32 v87, v87, v57, v57
    s_waitcnt lgkmcnt(2)
    v_mfma_f32_32x32x16_bf16 v[144:159], v[36:39], a[72:75], v[144:159]
    ds_read_b128 v[32:35], v11 offset:8192
    v_rcp_f32 v86, v86
    v_rcp_f32 v87, v87
    v_mul_f32 v88, v88, v80
    s_waitcnt lgkmcnt(2)
    v_mfma_f32_32x32x16_bf16 v[128:143], v[40:43], a[76:79], v[128:143]
    ds_read_b128 v[36:39], v11 offset:9216
    s_add_u32 s45, s44, 5120
    buffer_load_dwordx4 a[188:191], v11, s[4:7], s45 offen offset:2048 sc1
    v_mul_f32 v89, v89, v81
    v_mul_f32 v90, v90, v82
    v_mul_f32 v91, v91, v83
    s_waitcnt lgkmcnt(2)
    v_mfma_f32_32x32x16_bf16 v[144:159], v[44:47], a[76:79], v[144:159]
    ds_read_b128 v[40:43], v11 offset:10240
    v_mul_f32 v92, v92, v84
    v_mul_f32 v93, v93, v85
    v_mul_f32 v94, v94, v86
    v_mul_f32 v95, v95, v87
    v_cvt_pk_bf16_f32 v220, v88, v89
    s_waitcnt lgkmcnt(2)
    v_mfma_f32_32x32x16_bf16 v[128:143], v[32:35], a[80:83], v[128:143]
    ds_read_b128 v[44:47], v11 offset:11264
    s_add_u32 s45, s44, 5120
    buffer_load_dwordx4 a[192:195], v11, s[4:7], s45 offen offset:3072 sc1
    v_cvt_pk_bf16_f32 v221, v90, v91
    v_cvt_pk_bf16_f32 v222, v92, v93
    v_cvt_pk_bf16_f32 v223, v94, v95
    s_waitcnt lgkmcnt(2)
    v_mfma_f32_32x32x16_bf16 v[144:159], v[36:39], a[80:83], v[144:159]
    ds_read_b128 v[32:35], v11 offset:12288
    buffer_store_dwordx4 v[220:223], v12, s[4:7], s48 offen sc1
    ds_read_b128 v[200:203], v13 offset:256
    ds_read_b128 v[204:207], v13 offset:288
    ds_read_b128 v[208:211], v13 offset:320
    ds_read_b128 v[212:215], v13 offset:352
    s_waitcnt lgkmcnt(6)
    v_mfma_f32_32x32x16_bf16 v[128:143], v[40:43], a[84:87], v[128:143]
    ds_read_b128 v[36:39], v11 offset:13312
    s_waitcnt lgkmcnt(4)
    v_fma_f32 v96, v56, v200, v96
    v_fma_f32 v97, v56, v201, v97
    v_fma_f32 v98, v56, v202, v98
    v_fma_f32 v99, v56, v203, v99
    s_waitcnt lgkmcnt(3)
    v_fma_f32 v100, v56, v204, v100
    v_mfma_f32_32x32x16_bf16 v[144:159], v[44:47], a[84:87], v[144:159]
    ds_read_b128 v[40:43], v11 offset:14336
    v_fma_f32 v101, v56, v205, v101
    v_fma_f32 v102, v56, v206, v102
    v_fma_f32 v103, v56, v207, v103
    v_mul_f32 v96, v58, v96
    v_mul_f32 v97, v58, v97
    v_mfma_f32_32x32x16_bf16 v[128:143], v[32:35], a[88:91], v[128:143]
    ds_read_b128 v[44:47], v11 offset:15360
    v_mul_f32 v98, v58, v98
    v_mul_f32 v99, v58, v99
    v_mul_f32 v100, v58, v100
    v_mul_f32 v101, v58, v101
    v_mul_f32 v102, v58, v102
    s_waitcnt lgkmcnt(2)
    v_mfma_f32_32x32x16_bf16 v[144:159], v[36:39], a[88:91], v[144:159]
    s_waitcnt vmcnt(11)
    s_barrier
    ds_read_b128 v[32:35], v11 offset:16384
    s_add_u32 m0, s33, 49152
    s_add_u32 s38, s30, 245760
    buffer_load_dwordx4 v11, s[4:7], s38 offen sc1 lds
    v_mul_f32 v103, v58, v103
    v_exp_f32 v96, v96
    s_waitcnt lgkmcnt(2)
    v_mfma_f32_32x32x16_bf16 v[128:143], v[40:43], a[92:95], v[128:143]
    ds_read_b128 v[36:39], v11 offset:17408
    v_fma_f32 v104, v56, v208, v104
    v_exp_f32 v97, v97
    v_fma_f32 v105, v56, v209, v105
    s_waitcnt lgkmcnt(2)
    v_mfma_f32_32x32x16_bf16 v[144:159], v[44:47], a[92:95], v[144:159]
    ds_read_b128 v[40:43], v11 offset:18432
    s_add_u32 m0, s33, 53248
    s_add_u32 s38, s30, 249856
    buffer_load_dwordx4 v11, s[4:7], s38 offen sc1 lds
    v_exp_f32 v98, v98
    v_fma_f32 v106, v56, v210, v106
    s_waitcnt lgkmcnt(2)
    v_mfma_f32_32x32x16_bf16 v[128:143], v[32:35], a[96:99], v[128:143]
    ds_read_b128 v[44:47], v11 offset:19456
    v_exp_f32 v99, v99
    v_fma_f32 v107, v56, v211, v107
    v_exp_f32 v100, v100
    s_waitcnt lgkmcnt(2)
    v_mfma_f32_32x32x16_bf16 v[144:159], v[36:39], a[96:99], v[144:159]
    ds_read_b128 v[32:35], v11 offset:20480
    s_add_u32 s45, s44, 9216
    buffer_load_dwordx4 a[196:199], v11, s[4:7], s45 offen offset:0 sc1
    v_fma_f32 v108, v56, v212, v108
    v_exp_f32 v101, v101
    s_waitcnt lgkmcnt(2)
    v_mfma_f32_32x32x16_bf16 v[128:143], v[40:43], a[100:103], v[128:143]
    ds_read_b128 v[36:39], v11 offset:21504
    v_fma_f32 v109, v56, v213, v109
    v_exp_f32 v102, v102
    v_fma_f32 v110, v56, v214, v110
    s_waitcnt lgkmcnt(2)
    v_mfma_f32_32x32x16_bf16 v[144:159], v[44:47], a[100:103], v[144:159]
    ds_read_b128 v[40:43], v11 offset:22528
    s_add_u32 s45, s44, 10240
    buffer_load_dwordx4 a[200:203], v11, s[4:7], s45 offen offset:0 sc1
    v_exp_f32 v103, v103
    v_fma_f32 v111, v56, v215, v111
    s_waitcnt lgkmcnt(2)
    v_mfma_f32_32x32x16_bf16 v[128:143], v[32:35], a[104:107], v[128:143]
    ds_read_b128 v[44:47], v11 offset:23552
    v_fma_f32 v96, v96, v57, v57
    v_fma_f32 v97, v97, v57, v57
    v_rcp_f32 v96, v96
    v_fma_f32 v98, v98, v57, v57
    s_waitcnt lgkmcnt(2)
    v_mfma_f32_32x32x16_bf16 v[144:159], v[36:39], a[104:107], v[144:159]
    ds_read_b128 v[32:35], v11 offset:24576
    s_add_u32 s45, s44, 10240
    buffer_load_dwordx4 a[204:207], v11, s[4:7], s45 offen offset:1024 sc1
    v_rcp_f32 v97, v97
    v_fma_f32 v99, v99, v57, v57
    s_waitcnt lgkmcnt(2)
    v_mfma_f32_32x32x16_bf16 v[128:143], v[40:43], a[108:111], v[128:143]
    ds_read_b128 v[36:39], v11 offset:25600
    v_rcp_f32 v98, v98
    v_fma_f32 v100, v100, v57, v57
    v_rcp_f32 v99, v99
    s_waitcnt lgkmcnt(2)
    v_mfma_f32_32x32x16_bf16 v[144:159], v[44:47], a[108:111], v[144:159]
    ds_read_b128 v[40:43], v11 offset:26624
    s_add_u32 s45, s44, 10240
    buffer_load_dwordx4 a[208:211], v11, s[4:7], s45 offen offset:2048 sc1
    v_fma_f32 v101, v101, v57, v57
    v_rcp_f32 v100, v100
    s_waitcnt lgkmcnt(2)
    v_mfma_f32_32x32x16_bf16 v[128:143], v[32:35], a[112:115], v[128:143]
    ds_read_b128 v[44:47], v11 offset:27648
    v_fma_f32 v102, v102, v57, v57
    v_rcp_f32 v101, v101
    v_fma_f32 v103, v103, v57, v57
    s_waitcnt lgkmcnt(2)
    v_mfma_f32_32x32x16_bf16 v[144:159], v[36:39], a[112:115], v[144:159]
    ds_read_b128 v[32:35], v11 offset:28672
    s_add_u32 s45, s44, 10240
    buffer_load_dwordx4 a[212:215], v11, s[4:7], s45 offen offset:3072 sc1
    v_rcp_f32 v102, v102
    s_waitcnt lgkmcnt(2)
    v_mfma_f32_32x32x16_bf16 v[128:143], v[40:43], a[116:119], v[128:143]
    ds_read_b128 v[36:39], v11 offset:29696
    v_rcp_f32 v103, v103
    v_mul_f32 v104, v104, v96
    v_mul_f32 v105, v105, v97
    v_mul_f32 v106, v106, v98
    s_waitcnt lgkmcnt(2)
    v_mfma_f32_32x32x16_bf16 v[144:159], v[44:47], a[116:119], v[144:159]
    ds_read_b128 v[40:43], v11 offset:30720
    s_add_u32 s45, s44, 14336
    buffer_load_dwordx4 a[216:219], v11, s[4:7], s45 offen offset:0 sc1
    v_mul_f32 v107, v107, v99
    v_mul_f32 v108, v108, v100
    v_mul_f32 v109, v109, v101
    s_waitcnt lgkmcnt(2)
    v_mfma_f32_32x32x16_bf16 v[128:143], v[32:35], a[120:123], v[128:143]
    ds_read_b128 v[44:47], v11 offset:31744
    v_mul_f32 v110, v110, v102
    v_mul_f32 v111, v111, v103
    v_cvt_pk_bf16_f32 v216, v104, v105
    v_cvt_pk_bf16_f32 v217, v106, v107
    v_cvt_pk_bf16_f32 v218, v108, v109
    s_waitcnt lgkmcnt(2)
    v_mfma_f32_32x32x16_bf16 v[144:159], v[36:39], a[120:123], v[144:159]
    s_waitcnt vmcnt(11)
    s_barrier
    ds_read_b128 v[32:35], v11 offset:32768
    s_add_u32 m0, s33, 0
    s_add_u32 s38, s30, 253952
    buffer_load_dwordx4 v11, s[4:7], s38 offen sc1 lds
    v_cvt_pk_bf16_f32 v219, v110, v111
    buffer_store_dwordx4 v[216:219], v12, s[4:7], s49 offen sc1
    ds_read_b128 v[200:203], v13 offset:384
    s_waitcnt lgkmcnt(3)
    v_mfma_f32_32x32x16_bf16 v[128:143], v[40:43], a[124:127], v[128:143]
    ds_read_b128 v[36:39], v11 offset:33792
    ds_read_b128 v[204:207], v13 offset:416
    ds_read_b128 v[208:211], v13 offset:448
    ds_read_b128 v[212:215], v13 offset:480
    s_waitcnt lgkmcnt(4)
    v_fma_f32 v112, v56, v200, v112
    v_fma_f32 v113, v56, v201, v113
    v_mfma_f32_32x32x16_bf16 v[144:159], v[44:47], a[124:127], v[144:159]
    ds_read_b128 v[40:43], v11 offset:34816
    v_fma_f32 v114, v56, v202, v114
    v_fma_f32 v115, v56, v203, v115
    s_waitcnt lgkmcnt(3)
    v_fma_f32 v116, v56, v204, v116
    v_fma_f32 v117, v56, v205, v117
    v_fma_f32 v118, v56, v206, v118
    v_mfma_f32_32x32x16_bf16 v[128:143], v[32:35], a[128:131], v[128:143]
    ds_read_b128 v[44:47], v11 offset:35840
    v_fma_f32 v119, v56, v207, v119
    v_mul_f32 v112, v58, v112
    v_mul_f32 v113, v58, v113
    v_mul_f32 v114, v58, v114
    v_mul_f32 v115, v58, v115
    v_mfma_f32_32x32x16_bf16 v[144:159], v[36:39], a[128:131], v[144:159]
    ds_read_b128 v[32:35], v11 offset:36864
    v_mul_f32 v116, v58, v116
    v_mul_f32 v117, v58, v117
    v_mul_f32 v118, v58, v118
    v_mul_f32 v119, v58, v119
    s_waitcnt lgkmcnt(2)
    v_mfma_f32_32x32x16_bf16 v[128:143], v[40:43], a[132:135], v[128:143]
    ds_read_b128 v[36:39], v11 offset:37888
    s_add_u32 m0, s33, 4096
    s_add_u32 s38, s30, 258048
    buffer_load_dwordx4 v11, s[4:7], s38 offen sc1 lds
    v_exp_f32 v112, v112
    v_fma_f32 v120, v56, v208, v120
    s_waitcnt lgkmcnt(2)
    v_mfma_f32_32x32x16_bf16 v[144:159], v[44:47], a[132:135], v[144:159]
    ds_read_b128 v[40:43], v11 offset:38912
    v_exp_f32 v113, v113
    v_fma_f32 v121, v56, v209, v121
    v_exp_f32 v114, v114
    s_waitcnt lgkmcnt(2)
    v_mfma_f32_32x32x16_bf16 v[128:143], v[32:35], a[136:139], v[128:143]
    ds_read_b128 v[44:47], v11 offset:39936
    s_add_u32 s45, s44, 15360
    buffer_load_dwordx4 a[220:223], v11, s[4:7], s45 offen offset:0 sc1
    v_fma_f32 v122, v56, v210, v122
    v_exp_f32 v115, v115
    s_waitcnt lgkmcnt(2)
    v_mfma_f32_32x32x16_bf16 v[144:159], v[36:39], a[136:139], v[144:159]
    ds_read_b128 v[32:35], v11 offset:40960
    v_fma_f32 v123, v56, v211, v123
    v_exp_f32 v116, v116
    v_fma_f32 v124, v56, v212, v124
    s_waitcnt lgkmcnt(2)
    v_mfma_f32_32x32x16_bf16 v[128:143], v[40:43], a[140:143], v[128:143]
    ds_read_b128 v[36:39], v11 offset:41984
    s_add_u32 s45, s44, 15360
    buffer_load_dwordx4 a[224:227], v11, s[4:7], s45 offen offset:1024 sc1
    v_exp_f32 v117, v117
    v_fma_f32 v125, v56, v213, v125
    s_waitcnt lgkmcnt(2)
    v_mfma_f32_32x32x16_bf16 v[144:159], v[44:47], a[140:143], v[144:159]
    ds_read_b128 v[40:43], v11 offset:43008
    v_exp_f32 v118, v118
    v_fma_f32 v126, v56, v214, v126
    v_exp_f32 v119, v119
    s_waitcnt lgkmcnt(2)
    v_mfma_f32_32x32x16_bf16 v[128:143], v[32:35], a[144:147], v[128:143]
    ds_read_b128 v[44:47], v11 offset:44032
    s_add_u32 s45, s44, 15360
    buffer_load_dwordx4 a[228:231], v11, s[4:7], s45 offen offset:2048 sc1
    v_fma_f32 v127, v56, v215, v127
    v_fma_f32 v112, v112, v57, v57
    v_fma_f32 v113, v113, v57, v57
    s_waitcnt lgkmcnt(2)
    v_mfma_f32_32x32x16_bf16 v[144:159], v[36:39], a[144:147], v[144:159]
    ds_read_b128 v[32:35], v11 offset:45056
    v_rcp_f32 v112, v112
    v_fma_f32 v114, v114, v57, v57
    v_rcp_f32 v113, v113
    s_waitcnt lgkmcnt(2)
    v_mfma_f32_32x32x16_bf16 v[128:143], v[40:43], a[148:151], v[128:143]
    ds_read_b128 v[36:39], v11 offset:46080
    s_add_u32 s45, s44, 15360
    buffer_load_dwordx4 a[232:235], v11, s[4:7], s45 offen offset:3072 sc1
    v_fma_f32 v115, v115, v57, v57
    v_rcp_f32 v114, v114
    s_waitcnt lgkmcnt(2)
    v_mfma_f32_32x32x16_bf16 v[144:159], v[44:47], a[148:151], v[144:159]
    ds_read_b128 v[40:43], v11 offset:47104
    v_fma_f32 v116, v116, v57, v57
    v_rcp_f32 v115, v115
    v_fma_f32 v117, v117, v57, v57
    s_waitcnt lgkmcnt(2)
    v_mfma_f32_32x32x16_bf16 v[128:143], v[32:35], a[152:155], v[128:143]
    ds_read_b128 v[44:47], v11 offset:48128
    s_add_u32 s45, s44, 19456
    buffer_load_dwordx4 a[236:239], v11, s[4:7], s45 offen offset:0 sc1
    v_rcp_f32 v116, v116
    v_fma_f32 v118, v118, v57, v57
    s_waitcnt lgkmcnt(2)
    v_mfma_f32_32x32x16_bf16 v[144:159], v[36:39], a[152:155], v[144:159]
    s_waitcnt vmcnt(14)
    s_barrier
    ds_read_b128 v[32:35], v11 offset:49152
    v_rcp_f32 v117, v117
    v_fma_f32 v119, v119, v57, v57
    v_rcp_f32 v118, v118
    s_waitcnt lgkmcnt(2)
    v_mfma_f32_32x32x16_bf16 v[128:143], v[40:43], a[156:159], v[128:143]
    ds_read_b128 v[36:39], v11 offset:50176
    s_add_u32 m0, s33, 16384
    s_add_u32 s38, s30, 262144
    buffer_load_dwordx4 v11, s[4:7], s38 offen sc1 lds
    v_rcp_f32 v119, v119
    v_mul_f32 v120, v120, v112
    s_waitcnt lgkmcnt(2)
    v_mfma_f32_32x32x16_bf16 v[144:159], v[44:47], a[156:159], v[144:159]
    ds_read_b128 v[40:43], v11 offset:51200
    v_mul_f32 v121, v121, v113
    v_mul_f32 v122, v122, v114
    v_mul_f32 v123, v123, v115
    v_mul_f32 v124, v124, v116
    v_mul_f32 v125, v125, v117
    s_waitcnt lgkmcnt(2)
    v_mfma_f32_32x32x16_bf16 v[64:79], v[32:35], a[0:3], 0
    ds_read_b128 v[44:47], v11 offset:52224
    s_add_u32 m0, s33, 20480
    s_add_u32 s38, s30, 266240
    buffer_load_dwordx4 v11, s[4:7], s38 offen sc1 lds
    v_mul_f32 v126, v126, v118
    v_mul_f32 v127, v127, v119
    v_cvt_pk_bf16_f32 v220, v120, v121
    s_waitcnt lgkmcnt(2)
    v_mfma_f32_32x32x16_bf16 v[64:79], v[36:39], a[4:7], v[64:79]
    ds_read_b128 v[32:35], v11 offset:53248
    v_cvt_pk_bf16_f32 v221, v122, v123
    v_cvt_pk_bf16_f32 v222, v124, v125
    v_cvt_pk_bf16_f32 v223, v126, v127
    buffer_store_dwordx4 v[220:223], v12, s[4:7], s66 offen sc1
    ds_read_b128 v[200:203], v13 offset:512
    s_waitcnt lgkmcnt(3)
    v_mfma_f32_32x32x16_bf16 v[64:79], v[40:43], a[8:11], v[64:79]
    ds_read_b128 v[36:39], v11 offset:54272
    ds_read_b128 v[204:207], v13 offset:544
    ds_read_b128 v[208:211], v13 offset:576
    ds_read_b128 v[212:215], v13 offset:608
    s_waitcnt lgkmcnt(4)
    v_fma_f32 v128, v56, v200, v128
    v_fma_f32 v129, v56, v201, v129
    v_mfma_f32_32x32x16_bf16 v[64:79], v[44:47], a[12:15], v[64:79]
    ds_read_b128 v[40:43], v11 offset:55296
    v_fma_f32 v130, v56, v202, v130
    v_fma_f32 v131, v56, v203, v131
    s_waitcnt lgkmcnt(3)
    v_fma_f32 v132, v56, v204, v132
    v_fma_f32 v133, v56, v205, v133
    v_fma_f32 v134, v56, v206, v134
    v_mfma_f32_32x32x16_bf16 v[64:79], v[32:35], a[16:19], v[64:79]
    ds_read_b128 v[44:47], v11 offset:56320
    s_add_u32 s45, s44, 20480
    buffer_load_dwordx4 a[240:243], v11, s[4:7], s45 offen offset:0 sc1
    v_fma_f32 v135, v56, v207, v135
    v_mul_f32 v128, v58, v128
    v_mul_f32 v129, v58, v129
    v_mfma_f32_32x32x16_bf16 v[64:79], v[36:39], a[20:23], v[64:79]
    s_waitcnt vmcnt(9)
    s_barrier
    ds_read_b128 v[32:35], v11 offset:0
    v_mul_f32 v130, v58, v130
    v_mul_f32 v131, v58, v131
    v_mul_f32 v132, v58, v132
    v_mul_f32 v133, v58, v133
    v_mul_f32 v134, v58, v134
    s_waitcnt lgkmcnt(2)
    v_mfma_f32_32x32x16_bf16 v[64:79], v[40:43], a[24:27], v[64:79]
    ds_read_b128 v[36:39], v11 offset:1024
    v_mul_f32 v135, v58, v135
    v_exp_f32 v128, v128
    v_fma_f32 v136, v56, v208, v136
    s_waitcnt lgkmcnt(2)
    v_mfma_f32_32x32x16_bf16 v[64:79], v[44:47], a[28:31], v[64:79]
    ds_read_b128 v[40:43], v11 offset:2048
    s_add_u32 m0, s33, 32768
    s_add_u32 s38, s30, 270336
    buffer_load_dwordx4 v11, s[4:7], s38 offen sc1 lds
    v_exp_f32 v129, v129
    v_fma_f32 v137, v56, v209, v137
    s_waitcnt lgkmcnt(2)
    v_mfma_f32_32x32x16_bf16 v[64:79], v[32:35], a[32:35], v[64:79]
    ds_read_b128 v[44:47], v11 offset:3072
    v_exp_f32 v130, v130
    v_fma_f32 v138, v56, v210, v138
    v_exp_f32 v131, v131
    s_waitcnt lgkmcnt(2)
    v_mfma_f32_32x32x16_bf16 v[64:79], v[36:39], a[36:39], v[64:79]
    ds_read_b128 v[32:35], v11 offset:4096
    s_add_u32 m0, s33, 36864
    s_add_u32 s38, s30, 274432
    buffer_load_dwordx4 v11, s[4:7], s38 offen sc1 lds
    v_fma_f32 v139, v56, v211, v139
    v_exp_f32 v132, v132
    s_waitcnt lgkmcnt(2)
    v_mfma_f32_32x32x16_bf16 v[64:79], v[40:43], a[40:43], v[64:79]
    ds_read_b128 v[36:39], v11 offset:5120
    v_fma_f32 v140, v56, v212, v140
    v_exp_f32 v133, v133
    v_fma_f32 v141, v56, v213, v141
    s_waitcnt lgkmcnt(2)
    v_mfma_f32_32x32x16_bf16 v[64:79], v[44:47], a[44:47], v[64:79]
    ds_read_b128 v[40:43], v11 offset:6144
    s_add_u32 s45, s44, 20480
    buffer_load_dwordx4 a[244:247], v11, s[4:7], s45 offen offset:1024 sc1
    v_exp_f32 v134, v134
    v_fma_f32 v142, v56, v214, v142
    s_waitcnt lgkmcnt(2)
    v_mfma_f32_32x32x16_bf16 v[64:79], v[32:35], a[48:51], v[64:79]
    ds_read_b128 v[44:47], v11 offset:7168
    v_exp_f32 v135, v135
    v_fma_f32 v143, v56, v215, v143
    v_fma_f32 v128, v128, v57, v57
    v_fma_f32 v129, v129, v57, v57
    s_waitcnt lgkmcnt(2)
    v_mfma_f32_32x32x16_bf16 v[64:79], v[36:39], a[52:55], v[64:79]
    s_waitcnt vmcnt(4)
    s_barrier
    s_cmp_eq_u32 s20, 0
    s_cbranch_scc1 L31_ct
    s_getpc_b64 s[58:59]
L32_cp:
    s_sub_u32 s60, s20, 1
    s_lshl_b32 s60, s60, 13
    v_lshlrev_b32 v254, 7, v0
    v_add_u32 v254, s60, v254
    s_mov_b32 s60, L_exit-L32_cp
    v_min_u32 v254, s60, v254
    v_mov_b32 v255, s59
    v_add_co_u32 v254, vcc, s58, v254
    s_nop 1
    v_addc_co_u32 v255, vcc, 0, v255, vcc
    global_load_dword v60, v[254:255], off
L31_ct:
    s_lshl_b32 s61, s73, 8
    s_add_u32 s61, s61, 34412544
    s_cmp_lg_u32 s20, 0
    s_cbranch_scc1 L33_ol
    s_mov_b64 exec, 1
    v_mov_b32 v254, 1
    v_mov_b32 v255, 0
    buffer_atomic_add v254, v255, s[4:7], s61 offen sc1
    s_mov_b64 exec, -1
L33_ol:
    ds_read_b128 v[32:35], v11 offset:16384
    s_add_u32 m0, s33, 49152
    s_add_u32 s38, s30, 278528
    buffer_load_dwordx4 v11, s[4:7], s38 offen sc1 lds
    v_rcp_f32 v128, v128
    v_fma_f32 v130, v130, v57, v57
    s_waitcnt lgkmcnt(2)
    v_mfma_f32_32x32x16_bf16 v[64:79], v[40:43], a[56:59], v[64:79]
    ds_read_b128 v[36:39], v11 offset:17408
    v_rcp_f32 v129, v129
    v_fma_f32 v131, v131, v57, v57
    v_rcp_f32 v130, v130
    s_waitcnt lgkmcnt(2)
    v_mfma_f32_32x32x16_bf16 v[64:79], v[44:47], a[60:63], v[64:79]
    ds_read_b128 v[40:43], v11 offset:18432
    s_add_u32 m0, s33, 53248
    s_add_u32 s38, s30, 282624
    buffer_load_dwordx4 v11, s[4:7], s38 offen sc1 lds
    v_fma_f32 v132, v132, v57, v57
    v_rcp_f32 v131, v131
    s_waitcnt lgkmcnt(2)
    v_mfma_f32_32x32x16_bf16 v[64:79], v[32:35], a[64:67], v[64:79]
    ds_read_b128 v[44:47], v11 offset:19456
    v_fma_f32 v133, v133, v57, v57
    v_rcp_f32 v132, v132
    v_fma_f32 v134, v134, v57, v57
    s_waitcnt lgkmcnt(2)
    v_mfma_f32_32x32x16_bf16 v[64:79], v[36:39], a[68:71], v[64:79]
    ds_read_b128 v[32:35], v11 offset:20480
    s_add_u32 s45, s44, 20480
    buffer_load_dwordx4 a[248:251], v11, s[4:7], s45 offen offset:2048 sc1
    v_rcp_f32 v133, v133
    v_fma_f32 v135, v135, v57, v57
    s_waitcnt lgkmcnt(2)
    v_mfma_f32_32x32x16_bf16 v[64:79], v[40:43], a[72:75], v[64:79]
    ds_read_b128 v[36:39], v11 offset:21504
    v_rcp_f32 v134, v134
    v_rcp_f32 v135, v135
    v_mul_f32 v136, v136, v128
    s_waitcnt lgkmcnt(2)
    v_mfma_f32_32x32x16_bf16 v[64:79], v[44:47], a[76:79], v[64:79]
    ds_read_b128 v[40:43], v11 offset:22528
    s_add_u32 s45, s44, 20480
    buffer_load_dwordx4 a[252:255], v11, s[4:7], s45 offen offset:3072 sc1
    v_mul_f32 v137, v137, v129
    v_mul_f32 v138, v138, v130
    v_mul_f32 v139, v139, v131
    s_waitcnt lgkmcnt(2)
    v_mfma_f32_32x32x16_bf16 v[64:79], v[32:35], a[80:83], v[64:79]
    ds_read_b128 v[44:47], v11 offset:23552
    v_mul_f32 v140, v140, v132
    v_mul_f32 v141, v141, v133
    v_mul_f32 v142, v142, v134
    v_mul_f32 v143, v143, v135
    v_cvt_pk_bf16_f32 v216, v136, v137
    s_waitcnt lgkmcnt(2)
    v_mfma_f32_32x32x16_bf16 v[64:79], v[36:39], a[84:87], v[64:79]
    s_waitcnt vmcnt(5)
    s_barrier
    ds_read_b128 v[32:35], v11 offset:32768
    s_add_u32 s45, s44, 24576
    buffer_load_dwordx4 v[160:163], v11, s[4:7], s45 offen offset:0 sc1
    v_cvt_pk_bf16_f32 v217, v138, v139
    v_cvt_pk_bf16_f32 v218, v140, v141
    v_cvt_pk_bf16_f32 v219, v142, v143
    s_waitcnt lgkmcnt(2)
    v_mfma_f32_32x32x16_bf16 v[64:79], v[40:43], a[88:91], v[64:79]
    ds_read_b128 v[36:39], v11 offset:33792
    buffer_store_dwordx4 v[216:219], v12, s[4:7], s67 offen sc1
    ds_read_b128 v[200:203], v13 offset:640
    ds_read_b128 v[204:207], v13 offset:672
    ds_read_b128 v[208:211], v13 offset:704
    ds_read_b128 v[212:215], v13 offset:736
    s_waitcnt lgkmcnt(6)
    v_mfma_f32_32x32x16_bf16 v[64:79], v[44:47], a[92:95], v[64:79]
    ds_read_b128 v[40:43], v11 offset:34816
    s_waitcnt lgkmcnt(4)
    v_fma_f32 v144, v56, v200, v144
    v_fma_f32 v145, v56, v201, v145
    v_fma_f32 v146, v56, v202, v146
    v_fma_f32 v147, v56, v203, v147
    s_waitcnt lgkmcnt(3)
    v_fma_f32 v148, v56, v204, v148
    v_mfma_f32_32x32x16_bf16 v[64:79], v[32:35], a[96:99], v[64:79]
    ds_read_b128 v[44:47], v11 offset:35840
    v_fma_f32 v149, v56, v205, v149
    v_fma_f32 v150, v56, v206, v150
    v_fma_f32 v151, v56, v207, v151
    v_mul_f32 v144, v58, v144
    v_mul_f32 v145, v58, v145
    v_mfma_f32_32x32x16_bf16 v[64:79], v[36:39], a[100:103], v[64:79]
    ds_read_b128 v[32:35], v11 offset:36864
    s_add_u32 s45, s44, 25600
    buffer_load_dwordx4 v[164:167], v11, s[4:7], s45 offen offset:0 sc1
    v_mul_f32 v146, v58, v146
    v_mul_f32 v147, v58, v147
    v_mul_f32 v148, v58, v148
    s_waitcnt lgkmcnt(2)
    v_mfma_f32_32x32x16_bf16 v[64:79], v[40:43], a[104:107], v[64:79]
    ds_read_b128 v[36:39], v11 offset:37888
    v_mul_f32 v149, v58, v149
    v_mul_f32 v150, v58, v150
    v_mul_f32 v151, v58, v151
    v_exp_f32 v144, v144
    s_waitcnt lgkmcnt(2)
    v_mfma_f32_32x32x16_bf16 v[64:79], v[44:47], a[108:111], v[64:79]
    ds_read_b128 v[40:43], v11 offset:38912
    v_fma_f32 v152, v56, v208, v152
    v_exp_f32 v145, v145
    v_fma_f32 v153, v56, v209, v153
    s_waitcnt lgkmcnt(2)
    v_mfma_f32_32x32x16_bf16 v[64:79], v[32:35], a[112:115], v[64:79]
    ds_read_b128 v[44:47], v11 offset:39936
    s_add_u32 s45, s44, 25600
    buffer_load_dwordx4 v[168:171], v11, s[4:7], s45 offen offset:1024 sc1
    v_exp_f32 v146, v146
    v_fma_f32 v154, v56, v210, v154
    s_waitcnt lgkmcnt(2)
    v_mfma_f32_32x32x16_bf16 v[64:79], v[36:39], a[116:119], v[64:79]
    s_waitcnt vmcnt(6)
    s_barrier
    ds_read_b128 v[32:35], v11 offset:49152
    v_exp_f32 v147, v147
    v_fma_f32 v155, v56, v211, v155
    v_exp_f32 v148, v148
    s_waitcnt lgkmcnt(2)
    v_mfma_f32_32x32x16_bf16 v[64:79], v[40:43], a[120:123], v[64:79]
    ds_read_b128 v[36:39], v11 offset:50176
    s_add_u32 s45, s44, 25600
    buffer_load_dwordx4 v[172:175], v11, s[4:7], s45 offen offset:2048 sc1
    v_fma_f32 v156, v56, v212, v156
    v_exp_f32 v149, v149
    s_waitcnt lgkmcnt(2)
    v_mfma_f32_32x32x16_bf16 v[64:79], v[44:47], a[124:127], v[64:79]
    ds_read_b128 v[40:43], v11 offset:51200
    v_fma_f32 v157, v56, v213, v157
    v_exp_f32 v150, v150
    v_fma_f32 v158, v56, v214, v158
    s_waitcnt lgkmcnt(2)
    v_mfma_f32_32x32x16_bf16 v[64:79], v[32:35], a[128:131], v[64:79]
    ds_read_b128 v[44:47], v11 offset:52224
    s_add_u32 s45, s44, 25600
    buffer_load_dwordx4 v[176:179], v11, s[4:7], s45 offen offset:3072 sc1
    v_exp_f32 v151, v151
    v_fma_f32 v159, v56, v215, v159
    s_waitcnt lgkmcnt(2)
    v_mfma_f32_32x32x16_bf16 v[64:79], v[36:39], a[132:135], v[64:79]
    ds_read_b128 v[32:35], v11 offset:53248
    v_fma_f32 v144, v144, v57, v57
    v_fma_f32 v145, v145, v57, v57
    v_rcp_f32 v144, v144
    v_fma_f32 v146, v146, v57, v57
    s_waitcnt lgkmcnt(2)
    v_mfma_f32_32x32x16_bf16 v[64:79], v[40:43], a[136:139], v[64:79]
    ds_read_b128 v[36:39], v11 offset:54272
    s_add_u32 s45, s44, 29696
    buffer_load_dwordx4 v[180:183], v11, s[4:7], s45 offen offset:0 sc1
    v_rcp_f32 v145, v145
    v_fma_f32 v147, v147, v57, v57
    s_waitcnt lgkmcnt(2)
    v_mfma_f32_32x32x16_bf16 v[64:79], v[44:47], a[140:143], v[64:79]
    ds_read_b128 v[40:43], v11 offset:55296
    v_rcp_f32 v146, v146
    v_fma_f32 v148, v148, v57, v57
    v_rcp_f32 v147, v147
    s_waitcnt lgkmcnt(2)
    v_mfma_f32_32x32x16_bf16 v[64:79], v[32:35], a[144:147], v[64:79]
    ds_read_b128 v[44:47], v11 offset:56320
    s_add_u32 s45, s44, 30720
    buffer_load_dwordx4 v[184:187], v11, s[4:7], s45 offen offset:0 sc1
    v_fma_f32 v149, v149, v57, v57
    v_rcp_f32 v148, v148
    s_waitcnt lgkmcnt(2)
    v_mfma_f32_32x32x16_bf16 v[64:79], v[36:39], a[148:151], v[64:79]
    v_fma_f32 v150, v150, v57, v57
    v_rcp_f32 v149, v149
    v_fma_f32 v151, v151, v57, v57
    s_waitcnt lgkmcnt(1)
    v_mfma_f32_32x32x16_bf16 v[64:79], v[40:43], a[152:155], v[64:79]
    s_add_u32 s45, s44, 30720
    buffer_load_dwordx4 v[188:191], v11, s[4:7], s45 offen offset:1024 sc1
    v_rcp_f32 v150, v150
    s_waitcnt lgkmcnt(0)
    v_mfma_f32_32x32x16_bf16 v[64:79], v[44:47], a[156:159], v[64:79]
    v_rcp_f32 v151, v151
    v_mul_f32 v152, v152, v144
    v_mul_f32 v153, v153, v145
    v_mul_f32 v154, v154, v146
    v_mul_f32 v155, v155, v147
    v_mul_f32 v156, v156, v148
    v_mul_f32 v157, v157, v149
    v_mul_f32 v158, v158, v150
    v_mul_f32 v159, v159, v151
    v_cvt_pk_bf16_f32 v220, v152, v153
    v_cvt_pk_bf16_f32 v221, v154, v155
    v_cvt_pk_bf16_f32 v222, v156, v157
    v_cvt_pk_bf16_f32 v223, v158, v159
    buffer_store_dwordx4 v[220:223], v12, s[4:7], s68 offen sc1
    ds_read_b128 v[200:203], v13 offset:768
    ds_read_b128 v[204:207], v13 offset:800
    ds_read_b128 v[208:211], v13 offset:832
    ds_read_b128 v[212:215], v13 offset:864
    s_waitcnt lgkmcnt(3)
    v_fma_f32 v64, v56, v200, v64
    v_fma_f32 v65, v56, v201, v65
    v_fma_f32 v66, v56, v202, v66
    v_fma_f32 v67, v56, v203, v67
    s_waitcnt lgkmcnt(2)
    v_fma_f32 v68, v56, v204, v68
    v_fma_f32 v69, v56, v205, v69
    v_fma_f32 v70, v56, v206, v70
    v_fma_f32 v71, v56, v207, v71
    v_mul_f32 v64, v58, v64
    v_mul_f32 v65, v58, v65
    v_mul_f32 v66, v58, v66
    v_mul_f32 v67, v58, v67
    v_mul_f32 v68, v58, v68
    v_mul_f32 v69, v58, v69
    v_mul_f32 v70, v58, v70
    v_mul_f32 v71, v58, v71
    v_exp_f32 v64, v64
    s_waitcnt lgkmcnt(1)
    v_fma_f32 v72, v56, v208, v72
    v_exp_f32 v65, v65
    v_fma_f32 v73, v56, v209, v73
    v_exp_f32 v66, v66
    v_fma_f32 v74, v56, v210, v74
    v_exp_f32 v67, v67
    v_fma_f32 v75, v56, v211, v75
    v_exp_f32 v68, v68
    s_waitcnt lgkmcnt(0)
    v_fma_f32 v76, v56, v212, v76
    v_exp_f32 v69, v69
    v_fma_f32 v77, v56, v213, v77
    v_exp_f32 v70, v70
    v_fma_f32 v78, v56, v214, v78
    v_exp_f32 v71, v71
    v_fma_f32 v79, v56, v215, v79
    v_fma_f32 v64, v64, v57, v57
    v_fma_f32 v65, v65, v57, v57
    v_rcp_f32 v64, v64
    v_fma_f32 v66, v66, v57, v57
    v_rcp_f32 v65, v65
    v_fma_f32 v67, v67, v57, v57
    v_rcp_f32 v66, v66
    v_fma_f32 v68, v68, v57, v57
    v_rcp_f32 v67, v67
    v_fma_f32 v69, v69, v57, v57
    v_rcp_f32 v68, v68
    v_fma_f32 v70, v70, v57, v57
    v_rcp_f32 v69, v69
    v_fma_f32 v71, v71, v57, v57
    v_rcp_f32 v70, v70
    v_rcp_f32 v71, v71
    v_mul_f32 v72, v72, v64
    v_mul_f32 v73, v73, v65
    v_mul_f32 v74, v74, v66
    v_mul_f32 v75, v75, v67
    s_waitcnt vmcnt(0)
    s_barrier
    s_lshl_b32 s61, s73, 8
    s_add_u32 s61, s61, 34427648
    s_cmp_lg_u32 s20, 0
    s_cbranch_scc1 L34_ol
    s_mov_b64 exec, 1
    v_mov_b32 v254, 1
    v_mov_b32 v255, 0
    buffer_atomic_add v254, v255, s[4:7], s61 offen sc1
    s_mov_b64 exec, -1
L34_ol:
    s_lshl_b32 s57, s70, 8
    s_add_u32 s57, s57, 34412544
    v_mov_b32 v236, 0
    buffer_load_dword v237, v236, s[4:7], s57 offen sc1
    v_mul_f32 v76, v76, v68
    v_mul_f32 v77, v77, v69
    v_mul_f32 v78, v78, v70
    v_mul_f32 v79, v79, v71
    v_cvt_pk_bf16_f32 v216, v72, v73
    v_cvt_pk_bf16_f32 v217, v74, v75
    v_cvt_pk_bf16_f32 v218, v76, v77
    v_cvt_pk_bf16_f32 v219, v78, v79
    buffer_store_dwordx4 v[216:219], v12, s[4:7], s69 offen sc1
    s_mov_b32 s22, s70
    s_mov_b32 s23, s71
    s_mov_b32 s24, s72
    v_and_b32 v1, 15, v0
    v_lshrrev_b32 v2, 4, v0
    s_lshl_b32 s30, s22, 1
    s_add_u32 s30, s30, s23
    s_mul_i32 s30, s30, 221184
    s_add_u32 s30, s30, 17469440
    s_mul_i32 s31, s20, 7
    s_mul_i32 s29, s20, 3
    s_add_u32 s29, s29, 21
    s_lshl_b32 s41, s20, 2
    s_add_u32 s41, s41, 30
    s_cmp_eq_u32 s20, 3
    s_cselect_b32 s28, 1, 0
    s_sub_u32 s41, s41, s28
    s_lshl_b32 s31, s31, 12
    s_add_u32 s31, s31, s30
    s_lshl_b32 s29, s29, 12
    s_add_u32 s29, s29, s30
    s_lshl_b32 s41, s41, 12
    s_add_u32 s41, s41, s30
    s_add_u32 s28, s20, 0
    s_and_b32 s28, s28, 3
    s_lshl_b32 s28, s28, 10
    s_add_u32 s32, s31, s28
    s_add_u32 s36, s29, s28
    s_add_u32 s52, s41, s28
    s_add_u32 s28, s20, 1
    s_and_b32 s28, s28, 3
    s_lshl_b32 s28, s28, 10
    s_add_u32 s33, s31, s28
    s_add_u32 s37, s29, s28
    s_add_u32 s53, s41, s28
    s_add_u32 s28, s20, 2
    s_and_b32 s28, s28, 3
    s_lshl_b32 s28, s28, 10
    s_add_u32 s34, s31, s28
    s_add_u32 s38, s29, s28
    s_add_u32 s54, s41, s28
    s_add_u32 s28, s20, 3
    s_and_b32 s28, s28, 3
    s_lshl_b32 s28, s28, 10
    s_add_u32 s35, s31, s28
    s_add_u32 s39, s29, s28
    s_add_u32 s55, s41, s28
    s_lshl_b32 s43, s23, 2
    s_add_u32 s43, s43, s20
    s_mov_b32 s62, 0
    s_waitcnt vmcnt(1)
    v_cmp_gt_u32 vcc, 16, v237
    s_nop 1
    s_cmp_eq_u64 vcc, 0
    s_cbranch_scc1 L36_apd
    s_lshl_b32 s57, s70, 8
    s_add_u32 s57, s57, 34412544
L35_ap:
    buffer_load_dword v237, v236, s[4:7], s57 offen sc1
    s_waitcnt vmcnt(0)
    v_cmp_gt_u32 vcc, 16, v237
    s_add_u32 s62, s62, 1
    s_nop 1
    s_cmp_eq_u64 vcc, 0
    s_cbranch_scc1 L36_apd
    s_cmp_lt_u32 s62, 65536
    s_cbranch_scc1 L35_ap
L36_apd:
    s_add_u32 s40, s32, 0
    buffer_load_dwordx4 a[120:123], v11, s[4:7], s40 offen sc1
    s_add_u32 s40, s33, 0
    buffer_load_dwordx4 a[124:127], v11, s[4:7], s40 offen sc1
    s_add_u32 s40, s34, 0
    buffer_load_dwordx4 a[128:131], v11, s[4:7], s40 offen sc1
    s_add_u32 s40, s35, 0
    buffer_load_dwordx4 a[132:135], v11, s[4:7], s40 offen sc1
    s_add_u32 s40, s32, 4096
    buffer_load_dwordx4 a[136:139], v11, s[4:7], s40 offen sc1
    s_add_u32 s40, s33, 4096
    buffer_load_dwordx4 a[140:143], v11, s[4:7], s40 offen sc1
    s_add_u32 s40, s34, 4096
    buffer_load_dwordx4 a[144:147], v11, s[4:7], s40 offen sc1
    s_add_u32 s40, s35, 4096
    buffer_load_dwordx4 a[148:151], v11, s[4:7], s40 offen sc1
    s_add_u32 s40, s32, 8192
    buffer_load_dwordx4 v[144:147], v11, s[4:7], s40 offen sc1
    s_add_u32 s40, s33, 8192
    buffer_load_dwordx4 v[148:151], v11, s[4:7], s40 offen sc1
    s_add_u32 s40, s34, 8192
    buffer_load_dwordx4 v[152:155], v11, s[4:7], s40 offen sc1
    s_add_u32 s40, s35, 8192
    buffer_load_dwordx4 v[156:159], v11, s[4:7], s40 offen sc1
    s_waitcnt vmcnt(12)
    s_barrier
    s_lshl_b32 s61, s73, 8
    s_add_u32 s61, s61, 34385920
    s_cmp_lg_u32 s20, 0
    s_cbranch_scc1 L37_ol
    s_mov_b64 exec, 1
    v_mov_b32 v254, 1
    v_mov_b32 v255, 0
    buffer_atomic_add v254, v255, s[4:7], s61 offen sc1
    s_mov_b64 exec, -1
L37_ol:
    v_mul_u32_u24 v5, 163840, v1
    v_lshl_add_u32 v12, v2, 3, v5
    v_add_u32 v13, s100, v11
    s_waitcnt vmcnt(11)
    v_mfma_f32_16x16x32_bf16 v[64:67], a[160:163], a[120:123], 0
    s_add_u32 s40, s32, 12288
    buffer_load_dwordx4 v[200:203], v11, s[4:7], s40 offen sc1
    s_waitcnt vmcnt(11)
    v_mfma_f32_16x16x32_bf16 v[84:87], a[160:163], a[124:127], 0
    s_add_u32 s40, s33, 12288
    buffer_load_dwordx4 v[204:207], v11, s[4:7], s40 offen sc1
    s_waitcnt vmcnt(11)
    v_mfma_f32_16x16x32_bf16 v[104:107], a[160:163], a[128:131], 0
    s_add_u32 s40, s34, 12288
    buffer_load_dwordx4 v[208:211], v11, s[4:7], s40 offen sc1
    s_waitcnt vmcnt(11)
    v_mfma_f32_16x16x32_bf16 v[124:127], a[160:163], a[132:135], 0
    s_add_u32 s40, s35, 12288
    buffer_load_dwordx4 v[212:215], v11, s[4:7], s40 offen sc1
    v_mfma_f32_16x16x32_bf16 v[68:71], a[164:167], a[120:123], 0
    s_add_u32 s45, s44, 30720
    buffer_load_dwordx4 v[192:195], v11, s[4:7], s45 offen offset:2048 sc1
    v_mfma_f32_16x16x32_bf16 v[88:91], a[164:167], a[124:127], 0
    s_add_u32 s45, s44, 30720
    buffer_load_dwordx4 v[196:199], v11, s[4:7], s45 offen offset:3072 sc1
    v_mfma_f32_16x16x32_bf16 v[108:111], a[164:167], a[128:131], 0
    s_add_u32 s45, s44, 34816
    buffer_load_dwordx4 v[224:227], v11, s[4:7], s45 offen offset:0 sc1
    v_mfma_f32_16x16x32_bf16 v[128:131], a[164:167], a[132:135], 0
    s_add_u32 s45, s46, 35840
    buffer_load_dwordx4 v[228:231], v11, s[4:7], s45 offen offset:0 sc1
    v_mfma_f32_16x16x32_bf16 v[72:75], a[168:171], a[120:123], 0
    s_add_u32 s45, s46, 35840
    buffer_load_dwordx4 v[232:235], v11, s[4:7], s45 offen offset:1024 sc1
    v_mfma_f32_16x16x32_bf16 v[92:95], a[168:171], a[124:127], 0
    s_add_u32 s45, s46, 35840
    buffer_load_dwordx4 v[16:19], v11, s[4:7], s45 offen offset:2048 sc1
    v_mfma_f32_16x16x32_bf16 v[112:115], a[168:171], a[128:131], 0
    v_mfma_f32_16x16x32_bf16 v[132:135], a[168:171], a[132:135], 0
    v_mfma_f32_16x16x32_bf16 v[76:79], a[172:175], a[120:123], 0
    v_mfma_f32_16x16x32_bf16 v[96:99], a[172:175], a[124:127], 0
    v_mfma_f32_16x16x32_bf16 v[116:119], a[172:175], a[128:131], 0
    v_mfma_f32_16x16x32_bf16 v[136:139], a[172:175], a[132:135], 0
    v_mfma_f32_16x16x32_bf16 v[80:83], a[176:179], a[120:123], 0
    v_mfma_f32_16x16x32_bf16 v[100:103], a[176:179], a[124:127], 0
    v_mfma_f32_16x16x32_bf16 v[120:123], a[176:179], a[128:131], 0
    v_mfma_f32_16x16x32_bf16 v[140:143], a[176:179], a[132:135], 0
    s_lshl_b32 s57, s70, 8
    s_add_u32 s57, s57, 34427648
    v_mov_b32 v236, 0
    buffer_load_dword v237, v236, s[4:7], s57 offen sc1
    s_waitcnt vmcnt(18)
    v_mfma_f32_16x16x32_bf16 v[64:67], a[180:183], a[136:139], v[64:67]
    s_add_u32 s40, s32, 16384
    buffer_load_dwordx4 v[216:219], v11, s[4:7], s40 offen sc1
    s_waitcnt vmcnt(18)
    v_mfma_f32_16x16x32_bf16 v[84:87], a[180:183], a[140:143], v[84:87]
    s_add_u32 s40, s33, 16384
    buffer_load_dwordx4 v[220:223], v11, s[4:7], s40 offen sc1
    s_waitcnt vmcnt(18)
    v_mfma_f32_16x16x32_bf16 v[104:107], a[180:183], a[144:147], v[104:107]
    s_add_u32 s40, s34, 16384
    buffer_load_dwordx4 a[152:155], v11, s[4:7], s40 offen sc1
    s_waitcnt vmcnt(18)
    v_mfma_f32_16x16x32_bf16 v[124:127], a[180:183], a[148:151], v[124:127]
    s_add_u32 s40, s35, 16384
    buffer_load_dwordx4 a[156:159], v11, s[4:7], s40 offen sc1
    v_mfma_f32_16x16x32_bf16 v[68:71], a[184:187], a[136:139], v[68:71]
    s_add_u32 s45, s46, 35840
    buffer_load_dwordx4 v[20:23], v11, s[4:7], s45 offen offset:3072 sc1
    v_mfma_f32_16x16x32_bf16 v[88:91], a[184:187], a[140:143], v[88:91]
    s_add_u32 s45, s46, 39936
    buffer_load_dwordx4 v[24:27], v11, s[4:7], s45 offen offset:0 sc1
    v_mfma_f32_16x16x32_bf16 v[108:111], a[184:187], a[144:147], v[108:111]
    s_add_u32 m0, s100, 0
    s_add_u32 s45, s46, 40960
    buffer_load_dwordx4 v11, s[4:7], s45 offen sc1 lds
    v_mfma_f32_16x16x32_bf16 v[128:131], a[184:187], a[148:151], v[128:131]
    s_add_u32 m0, s100, 1024
    s_add_u32 s45, s46, 41984
    buffer_load_dwordx4 v11, s[4:7], s45 offen sc1 lds
    v_mfma_f32_16x16x32_bf16 v[72:75], a[188:191], a[136:139], v[72:75]
    s_add_u32 m0, s100, 2048
    s_add_u32 s45, s46, 43008
    buffer_load_dwordx4 v11, s[4:7], s45 offen sc1 lds
    v_mfma_f32_16x16x32_bf16 v[92:95], a[188:191], a[140:143], v[92:95]
    s_add_u32 m0, s100, 3072
    s_add_u32 s45, s46, 44032
    buffer_load_dwordx4 v11, s[4:7], s45 offen sc1 lds
    v_mfma_f32_16x16x32_bf16 v[112:115], a[188:191], a[144:147], v[112:115]
    v_mfma_f32_16x16x32_bf16 v[132:135], a[188:191], a[148:151], v[132:135]
    v_mfma_f32_16x16x32_bf16 v[76:79], a[192:195], a[136:139], v[76:79]
    v_mfma_f32_16x16x32_bf16 v[96:99], a[192:195], a[140:143], v[96:99]
    v_mfma_f32_16x16x32_bf16 v[116:119], a[192:195], a[144:147], v[116:119]
    v_mfma_f32_16x16x32_bf16 v[136:139], a[192:195], a[148:151], v[136:139]
    v_mfma_f32_16x16x32_bf16 v[80:83], a[196:199], a[136:139], v[80:83]
    v_mfma_f32_16x16x32_bf16 v[100:103], a[196:199], a[140:143], v[100:103]
    v_mfma_f32_16x16x32_bf16 v[120:123], a[196:199], a[144:147], v[120:123]
    v_mfma_f32_16x16x32_bf16 v[140:143], a[196:199], a[148:151], v[140:143]
    s_mov_b32 s62, 0
    s_waitcnt vmcnt(10)
    v_cmp_gt_u32 vcc, 16, v237
    s_nop 1
    s_cmp_eq_u64 vcc, 0
    s_cbranch_scc1 L40_apd
    s_lshl_b32 s57, s70, 8
    s_add_u32 s57, s57, 34427648
L39_ap:
    buffer_load_dword v237, v236, s[4:7], s57 offen sc1
    s_waitcnt vmcnt(0)
    v_cmp_gt_u32 vcc, 16, v237
    s_add_u32 s62, s62, 1
    s_nop 1
    s_cmp_eq_u64 vcc, 0
    s_cbranch_scc1 L40_apd
    s_cmp_lt_u32 s62, 65536
    s_cbranch_scc1 L39_ap
L40_apd:
    v_mfma_f32_16x16x32_bf16 v[64:67], a[200:203], v[144:147], v[64:67]
    s_add_u32 s40, s32, 20480
    buffer_load_dwordx4 a[120:123], v11, s[4:7], s40 offen sc1
    v_mfma_f32_16x16x32_bf16 v[84:87], a[200:203], v[148:151], v[84:87]
    s_add_u32 s40, s33, 20480
    buffer_load_dwordx4 a[124:127], v11, s[4:7], s40 offen sc1
    v_mfma_f32_16x16x32_bf16 v[104:107], a[200:203], v[152:155], v[104:107]
    s_add_u32 s40, s34, 20480
    buffer_load_dwordx4 a[128:131], v11, s[4:7], s40 offen sc1
    v_mfma_f32_16x16x32_bf16 v[124:127], a[200:203], v[156:159], v[124:127]
    s_add_u32 s40, s35, 20480
    buffer_load_dwordx4 a[132:135], v11, s[4:7], s40 offen sc1
    v_mfma_f32_16x16x32_bf16 v[68:71], a[204:207], v[144:147], v[68:71]
    s_add_u32 m0, s100, 4096
    s_add_u32 s45, s46, 45056
    buffer_load_dwordx4 v11, s[4:7], s45 offen sc1 lds
    v_mfma_f32_16x16x32_bf16 v[88:91], a[204:207], v[148:151], v[88:91]
    s_add_u32 m0, s100, 5120
    s_add_u32 s45, s46, 46080
    buffer_load_dwordx4 v11, s[4:7], s45 offen sc1 lds
    v_mfma_f32_16x16x32_bf16 v[108:111], a[204:207], v[152:155], v[108:111]
    s_add_u32 m0, s100, 6144
    s_add_u32 s45, s46, 47104
    buffer_load_dwordx4 v11, s[4:7], s45 offen sc1 lds
    v_mfma_f32_16x16x32_bf16 v[128:131], a[204:207], v[156:159], v[128:131]
    s_add_u32 m0, s100, 7168
    s_add_u32 s45, s46, 48128
    buffer_load_dwordx4 v11, s[4:7], s45 offen sc1 lds
    v_mfma_f32_16x16x32_bf16 v[72:75], a[208:211], v[144:147], v[72:75]
    s_add_u32 m0, s100, 8192
    s_add_u32 s45, s46, 49152
    buffer_load_dwordx4 v11, s[4:7], s45 offen sc1 lds
    v_mfma_f32_16x16x32_bf16 v[92:95], a[208:211], v[148:151], v[92:95]
    s_add_u32 m0, s100, 9216
    s_add_u32 s45, s46, 50176
    buffer_load_dwordx4 v11, s[4:7], s45 offen sc1 lds
    v_mfma_f32_16x16x32_bf16 v[112:115], a[208:211], v[152:155], v[112:115]
    v_mfma_f32_16x16x32_bf16 v[132:135], a[208:211], v[156:159], v[132:135]
    v_mfma_f32_16x16x32_bf16 v[76:79], a[212:215], v[144:147], v[76:79]
    v_mfma_f32_16x16x32_bf16 v[96:99], a[212:215], v[148:151], v[96:99]
    v_mfma_f32_16x16x32_bf16 v[116:119], a[212:215], v[152:155], v[116:119]
    v_mfma_f32_16x16x32_bf16 v[136:139], a[212:215], v[156:159], v[136:139]
    v_mfma_f32_16x16x32_bf16 v[80:83], a[216:219], v[144:147], v[80:83]
    v_mfma_f32_16x16x32_bf16 v[100:103], a[216:219], v[148:151], v[100:103]
    v_mfma_f32_16x16x32_bf16 v[120:123], a[216:219], v[152:155], v[120:123]
    v_mfma_f32_16x16x32_bf16 v[140:143], a[216:219], v[156:159], v[140:143]
    v_mfma_f32_16x16x32_bf16 v[64:67], a[220:223], v[200:203], v[64:67]
    s_add_u32 s40, s32, 24576
    buffer_load_dwordx4 a[136:139], v11, s[4:7], s40 offen sc1
    v_mfma_f32_16x16x32_bf16 v[84:87], a[220:223], v[204:207], v[84:87]
    s_add_u32 s40, s33, 24576
    buffer_load_dwordx4 a[140:143], v11, s[4:7], s40 offen sc1
    v_mfma_f32_16x16x32_bf16 v[104:107], a[220:223], v[208:211], v[104:107]
    s_add_u32 s40, s34, 24576
    buffer_load_dwordx4 a[144:147], v11, s[4:7], s40 offen sc1
    v_mfma_f32_16x16x32_bf16 v[124:127], a[220:223], v[212:215], v[124:127]
    s_add_u32 s40, s35, 24576
    buffer_load_dwordx4 a[148:151], v11, s[4:7], s40 offen sc1
    v_mfma_f32_16x16x32_bf16 v[68:71], a[224:227], v[200:203], v[68:71]
    s_add_u32 m0, s100, 10240
    s_add_u32 s45, s101, 51200
    buffer_load_dwordx4 v11, s[4:7], s45 offen sc1 lds
    v_mfma_f32_16x16x32_bf16 v[88:91], a[224:227], v[204:207], v[88:91]
    s_add_u32 m0, s100, 11264
    s_add_u32 s45, s101, 52224
    buffer_load_dwordx4 v11, s[4:7], s45 offen sc1 lds
    v_mfma_f32_16x16x32_bf16 v[108:111], a[224:227], v[208:211], v[108:111]
    s_add_u32 m0, s100, 12288
    s_add_u32 s45, s101, 53248
    buffer_load_dwordx4 v11, s[4:7], s45 offen sc1 lds
    v_mfma_f32_16x16x32_bf16 v[128:131], a[224:227], v[212:215], v[128:131]
    s_add_u32 m0, s100, 13312
    s_add_u32 s45, s101, 54272
    buffer_load_dwordx4 v11, s[4:7], s45 offen sc1 lds
    v_mfma_f32_16x16x32_bf16 v[72:75], a[228:231], v[200:203], v[72:75]
    s_add_u32 m0, s100, 14336
    s_add_u32 s45, s101, 55296
    buffer_load_dwordx4 v11, s[4:7], s45 offen sc1 lds
    v_mfma_f32_16x16x32_bf16 v[92:95], a[228:231], v[204:207], v[92:95]
    s_add_u32 m0, s100, 15360
    s_add_u32 s45, s101, 56320
    buffer_load_dwordx4 v11, s[4:7], s45 offen sc1 lds
    v_mfma_f32_16x16x32_bf16 v[112:115], a[228:231], v[208:211], v[112:115]
    s_add_u32 s40, s36, 28672
    buffer_load_dwordx4 v[144:147], v11, s[4:7], s40 offen sc1
    v_mfma_f32_16x16x32_bf16 v[132:135], a[228:231], v[212:215], v[132:135]
    s_add_u32 s40, s37, 28672
    buffer_load_dwordx4 v[148:151], v11, s[4:7], s40 offen sc1
    v_mfma_f32_16x16x32_bf16 v[76:79], a[232:235], v[200:203], v[76:79]
    s_add_u32 s40, s38, 28672
    buffer_load_dwordx4 v[152:155], v11, s[4:7], s40 offen sc1
    v_mfma_f32_16x16x32_bf16 v[96:99], a[232:235], v[204:207], v[96:99]
    s_add_u32 s40, s39, 28672
    buffer_load_dwordx4 v[156:159], v11, s[4:7], s40 offen sc1
    v_mfma_f32_16x16x32_bf16 v[116:119], a[232:235], v[208:211], v[116:119]
    v_mfma_f32_16x16x32_bf16 v[136:139], a[232:235], v[212:215], v[136:139]
    v_mfma_f32_16x16x32_bf16 v[80:83], a[236:239], v[200:203], v[80:83]
    v_mfma_f32_16x16x32_bf16 v[100:103], a[236:239], v[204:207], v[100:103]
    v_mfma_f32_16x16x32_bf16 v[120:123], a[236:239], v[208:211], v[120:123]
    v_mfma_f32_16x16x32_bf16 v[140:143], a[236:239], v[212:215], v[140:143]
    s_lshl_b32 s57, s70, 8
    s_add_u32 s57, s57, 34385920
    v_mov_b32 v236, 0
    buffer_load_dword v237, v236, s[4:7], s57 offen sc1
    s_waitcnt vmcnt(34)
    v_mfma_f32_16x16x32_bf16 v[64:67], a[240:243], v[216:219], v[64:67]
    s_add_u32 m0, s100, 16384
    s_add_u32 s45, s101, 57344
    buffer_load_dwordx4 v11, s[4:7], s45 offen sc1 lds
    s_waitcnt vmcnt(34)
    v_mfma_f32_16x16x32_bf16 v[84:87], a[240:243], v[220:223], v[84:87]
    s_add_u32 m0, s100, 17408
    s_add_u32 s45, s101, 58368
    buffer_load_dwordx4 v11, s[4:7], s45 offen sc1 lds
    s_waitcnt vmcnt(34)
    v_mfma_f32_16x16x32_bf16 v[104:107], a[240:243], a[152:155], v[104:107]
    s_add_u32 m0, s100, 18432
    s_add_u32 s45, s101, 59392
    buffer_load_dwordx4 v11, s[4:7], s45 offen sc1 lds
    s_waitcnt vmcnt(34)
    v_mfma_f32_16x16x32_bf16 v[124:127], a[240:243], a[156:159], v[124:127]
    s_add_u32 m0, s100, 19456
    s_add_u32 s45, s101, 60416
    buffer_load_dwordx4 v11, s[4:7], s45 offen sc1 lds
    v_mfma_f32_16x16x32_bf16 v[68:71], a[244:247], v[216:219], v[68:71]
    s_add_u32 m0, s100, 20480
    s_add_u32 s45, s101, 61440
    buffer_load_dwordx4 v11, s[4:7], s45 offen sc1 lds
    v_mfma_f32_16x16x32_bf16 v[88:91], a[244:247], v[220:223], v[88:91]
    s_add_u32 m0, s100, 21504
    s_add_u32 s45, s101, 62464
    buffer_load_dwordx4 v11, s[4:7], s45 offen sc1 lds
    v_mfma_f32_16x16x32_bf16 v[108:111], a[244:247], a[152:155], v[108:111]
    s_add_u32 s40, s36, 32768
    buffer_load_dwordx4 v[200:203], v11, s[4:7], s40 offen sc1
    v_mfma_f32_16x16x32_bf16 v[128:131], a[244:247], a[156:159], v[128:131]
    s_add_u32 s40, s37, 32768
    buffer_load_dwordx4 v[204:207], v11, s[4:7], s40 offen sc1
    v_mfma_f32_16x16x32_bf16 v[72:75], a[248:251], v[216:219], v[72:75]
    s_add_u32 s40, s38, 32768
    buffer_load_dwordx4 v[208:211], v11, s[4:7], s40 offen sc1
    v_mfma_f32_16x16x32_bf16 v[92:95], a[248:251], v[220:223], v[92:95]
    s_add_u32 s40, s39, 32768
    buffer_load_dwordx4 v[212:215], v11, s[4:7], s40 offen sc1
    v_mfma_f32_16x16x32_bf16 v[112:115], a[248:251], a[152:155], v[112:115]
    v_mfma_f32_16x16x32_bf16 v[132:135], a[248:251], a[156:159], v[132:135]
    v_mfma_f32_16x16x32_bf16 v[76:79], a[252:255], v[216:219], v[76:79]
    v_mfma_f32_16x16x32_bf16 v[96:99], a[252:255], v[220:223], v[96:99]
    v_mfma_f32_16x16x32_bf16 v[116:119], a[252:255], a[152:155], v[116:119]
    v_mfma_f32_16x16x32_bf16 v[136:139], a[252:255], a[156:159], v[136:139]
    v_mfma_f32_16x16x32_bf16 v[80:83], v[160:163], v[216:219], v[80:83]
    v_mfma_f32_16x16x32_bf16 v[100:103], v[160:163], v[220:223], v[100:103]
    v_mfma_f32_16x16x32_bf16 v[120:123], v[160:163], a[152:155], v[120:123]
    v_mfma_f32_16x16x32_bf16 v[140:143], v[160:163], a[156:159], v[140:143]
    s_mov_b32 s62, 0
    s_waitcnt vmcnt(10)
    v_cmp_gt_u32 vcc, 16, v237
    s_nop 1
    s_cmp_eq_u64 vcc, 0
    s_cbranch_scc1 L42_apd
    s_lshl_b32 s57, s70, 8
    s_add_u32 s57, s57, 34385920
L41_ap:
    buffer_load_dword v237, v236, s[4:7], s57 offen sc1
    s_waitcnt vmcnt(0)
    v_cmp_gt_u32 vcc, 16, v237
    s_add_u32 s62, s62, 1
    s_nop 1
    s_cmp_eq_u64 vcc, 0
    s_cbranch_scc1 L42_apd
    s_cmp_lt_u32 s62, 65536
    s_cbranch_scc1 L41_ap
L42_apd:
    v_mfma_f32_16x16x32_bf16 v[64:67], v[164:167], a[120:123], v[64:67]
    s_add_u32 s45, s101, 63488
    buffer_load_dwordx4 a[0:3], v11, s[4:7], s45 offen sc1
    v_mfma_f32_16x16x32_bf16 v[84:87], v[164:167], a[124:127], v[84:87]
    s_add_u32 s45, s101, 64512
    buffer_load_dwordx4 a[4:7], v11, s[4:7], s45 offen sc1
    v_mfma_f32_16x16x32_bf16 v[104:107], v[164:167], a[128:131], v[104:107]
    s_add_u32 s45, s101, 65536
    buffer_load_dwordx4 a[8:11], v11, s[4:7], s45 offen sc1
    v_mfma_f32_16x16x32_bf16 v[124:127], v[164:167], a[132:135], v[124:127]
    s_add_u32 s45, s101, 66560
    buffer_load_dwordx4 a[12:15], v11, s[4:7], s45 offen sc1
    v_mfma_f32_16x16x32_bf16 v[68:71], v[168:171], a[120:123], v[68:71]
    s_add_u32 s45, s101, 67584
    buffer_load_dwordx4 a[16:19], v11, s[4:7], s45 offen sc1
    v_mfma_f32_16x16x32_bf16 v[88:91], v[168:171], a[124:127], v[88:91]
    s_add_u32 s45, s101, 68608
    buffer_load_dwordx4 a[20:23], v11, s[4:7], s45 offen sc1
    v_mfma_f32_16x16x32_bf16 v[108:111], v[168:171], a[128:131], v[108:111]
    s_add_u32 s45, s101, 69632
    buffer_load_dwordx4 a[24:27], v11, s[4:7], s45 offen sc1
    v_mfma_f32_16x16x32_bf16 v[128:131], v[168:171], a[132:135], v[128:131]
    s_add_u32 s45, s101, 70656
    buffer_load_dwordx4 a[28:31], v11, s[4:7], s45 offen sc1
    v_mfma_f32_16x16x32_bf16 v[72:75], v[172:175], a[120:123], v[72:75]
    s_add_u32 s40, s36, 36864
    buffer_load_dwordx4 v[216:219], v11, s[4:7], s40 offen sc1
    v_mfma_f32_16x16x32_bf16 v[92:95], v[172:175], a[124:127], v[92:95]
    s_add_u32 s40, s37, 36864
    buffer_load_dwordx4 v[220:223], v11, s[4:7], s40 offen sc1
    v_mfma_f32_16x16x32_bf16 v[112:115], v[172:175], a[128:131], v[112:115]
    s_add_u32 s40, s38, 36864
    buffer_load_dwordx4 a[152:155], v11, s[4:7], s40 offen sc1
    v_mfma_f32_16x16x32_bf16 v[132:135], v[172:175], a[132:135], v[132:135]
    s_add_u32 s40, s39, 36864
    buffer_load_dwordx4 a[156:159], v11, s[4:7], s40 offen sc1
    v_mfma_f32_16x16x32_bf16 v[76:79], v[176:179], a[120:123], v[76:79]
    v_mfma_f32_16x16x32_bf16 v[96:99], v[176:179], a[124:127], v[96:99]
    v_mfma_f32_16x16x32_bf16 v[116:119], v[176:179], a[128:131], v[116:119]
    v_mfma_f32_16x16x32_bf16 v[136:139], v[176:179], a[132:135], v[136:139]
    v_mfma_f32_16x16x32_bf16 v[80:83], v[180:183], a[120:123], v[80:83]
    v_mfma_f32_16x16x32_bf16 v[100:103], v[180:183], a[124:127], v[100:103]
    v_mfma_f32_16x16x32_bf16 v[120:123], v[180:183], a[128:131], v[120:123]
    v_mfma_f32_16x16x32_bf16 v[140:143], v[180:183], a[132:135], v[140:143]
    v_mfma_f32_16x16x32_bf16 v[64:67], v[184:187], a[136:139], v[64:67]
    v_mfma_f32_16x16x32_bf16 v[84:87], v[184:187], a[140:143], v[84:87]
    v_mfma_f32_16x16x32_bf16 v[104:107], v[184:187], a[144:147], v[104:107]
    v_mfma_f32_16x16x32_bf16 v[124:127], v[184:187], a[148:151], v[124:127]
    s_add_u32 s40, s52, 40960
    buffer_load_dwordx4 a[120:123], v11, s[4:7], s40 offen sc1
    v_mfma_f32_16x16x32_bf16 v[68:71], v[188:191], a[136:139], v[68:71]
    v_mfma_f32_16x16x32_bf16 v[88:91], v[188:191], a[140:143], v[88:91]
    v_mfma_f32_16x16x32_bf16 v[108:111], v[188:191], a[144:147], v[108:111]
    v_mfma_f32_16x16x32_bf16 v[128:131], v[188:191], a[148:151], v[128:131]
    s_add_u32 s40, s53, 40960
    buffer_load_dwordx4 a[124:127], v11, s[4:7], s40 offen sc1
    v_mfma_f32_16x16x32_bf16 v[72:75], v[192:195], a[136:139], v[72:75]
    v_mfma_f32_16x16x32_bf16 v[92:95], v[192:195], a[140:143], v[92:95]
    v_mfma_f32_16x16x32_bf16 v[112:115], v[192:195], a[144:147], v[112:115]
    v_mfma_f32_16x16x32_bf16 v[132:135], v[192:195], a[148:151], v[132:135]
    s_add_u32 s40, s54, 40960
    buffer_load_dwordx4 a[128:131], v11, s[4:7], s40 offen sc1
    v_mfma_f32_16x16x32_bf16 v[76:79], v[196:199], a[136:139], v[76:79]
    v_mfma_f32_16x16x32_bf16 v[96:99], v[196:199], a[140:143], v[96:99]
    v_mfma_f32_16x16x32_bf16 v[116:119], v[196:199], a[144:147], v[116:119]
    v_mfma_f32_16x16x32_bf16 v[136:139], v[196:199], a[148:151], v[136:139]
    s_add_u32 s40, s55, 40960
    buffer_load_dwordx4 a[132:135], v11, s[4:7], s40 offen sc1
    v_mfma_f32_16x16x32_bf16 v[80:83], v[224:227], a[136:139], v[80:83]
    v_mfma_f32_16x16x32_bf16 v[100:103], v[224:227], a[140:143], v[100:103]
    v_mfma_f32_16x16x32_bf16 v[120:123], v[224:227], a[144:147], v[120:123]
    v_mfma_f32_16x16x32_bf16 v[140:143], v[224:227], a[148:151], v[140:143]
    v_mfma_f32_16x16x32_bf16 v[64:67], v[228:231], v[144:147], v[64:67]
    ds_read_b128 a[32:35], v13 offset:0
    v_mfma_f32_16x16x32_bf16 v[84:87], v[228:231], v[148:151], v[84:87]
    v_mfma_f32_16x16x32_bf16 v[104:107], v[228:231], v[152:155], v[104:107]
    v_mfma_f32_16x16x32_bf16 v[124:127], v[228:231], v[156:159], v[124:127]
    s_add_u32 s40, s52, 45056
    buffer_load_dwordx4 a[136:139], v11, s[4:7], s40 offen sc1
    ds_read_b128 a[36:39], v13 offset:1024
    v_mfma_f32_16x16x32_bf16 v[68:71], v[232:235], v[144:147], v[68:71]
    v_mfma_f32_16x16x32_bf16 v[88:91], v[232:235], v[148:151], v[88:91]
    v_mfma_f32_16x16x32_bf16 v[108:111], v[232:235], v[152:155], v[108:111]
    ds_read_b128 a[40:43], v13 offset:2048
    v_mfma_f32_16x16x32_bf16 v[128:131], v[232:235], v[156:159], v[128:131]
    s_add_u32 s40, s53, 45056
    buffer_load_dwordx4 a[140:143], v11, s[4:7], s40 offen sc1
    v_mfma_f32_16x16x32_bf16 v[72:75], v[16:19], v[144:147], v[72:75]
    v_mfma_f32_16x16x32_bf16 v[92:95], v[16:19], v[148:151], v[92:95]
    ds_read_b128 a[44:47], v13 offset:3072
    v_mfma_f32_16x16x32_bf16 v[112:115], v[16:19], v[152:155], v[112:115]
    v_mfma_f32_16x16x32_bf16 v[132:135], v[16:19], v[156:159], v[132:135]
    s_add_u32 s40, s54, 45056
    buffer_load_dwordx4 a[144:147], v11, s[4:7], s40 offen sc1
    v_mfma_f32_16x16x32_bf16 v[76:79], v[20:23], v[144:147], v[76:79]
    ds_read_b128 a[48:51], v13 offset:4096
    v_mfma_f32_16x16x32_bf16 v[96:99], v[20:23], v[148:151], v[96:99]
    v_mfma_f32_16x16x32_bf16 v[116:119], v[20:23], v[152:155], v[116:119]
    v_mfma_f32_16x16x32_bf16 v[136:139], v[20:23], v[156:159], v[136:139]
    s_add_u32 s40, s55, 45056
    buffer_load_dwordx4 a[148:151], v11, s[4:7], s40 offen sc1
    v_mfma_f32_16x16x32_bf16 v[80:83], v[24:27], v[144:147], v[80:83]
    v_mfma_f32_16x16x32_bf16 v[100:103], v[24:27], v[148:151], v[100:103]
    v_mfma_f32_16x16x32_bf16 v[120:123], v[24:27], v[152:155], v[120:123]
    v_mfma_f32_16x16x32_bf16 v[140:143], v[24:27], v[156:159], v[140:143]
    s_waitcnt vmcnt(23) lgkmcnt(4)
    v_mfma_f32_16x16x32_bf16 v[64:67], a[32:35], v[200:203], v[64:67]
    ds_read_b128 a[52:55], v13 offset:5120
    s_waitcnt vmcnt(22)
    v_mfma_f32_16x16x32_bf16 v[84:87], a[32:35], v[204:207], v[84:87]
    s_waitcnt vmcnt(21)
    v_mfma_f32_16x16x32_bf16 v[104:107], a[32:35], v[208:211], v[104:107]
    s_waitcnt vmcnt(20)
    v_mfma_f32_16x16x32_bf16 v[124:127], a[32:35], v[212:215], v[124:127]
    s_add_u32 s40, s52, 49152
    buffer_load_dwordx4 v[144:147], v11, s[4:7], s40 offen sc1
    ds_read_b128 a[56:59], v13 offset:6144
    s_waitcnt lgkmcnt(5)
    v_mfma_f32_16x16x32_bf16 v[68:71], a[36:39], v[200:203], v[68:71]
    v_mfma_f32_16x16x32_bf16 v[88:91], a[36:39], v[204:207], v[88:91]
    v_mfma_f32_16x16x32_bf16 v[108:111], a[36:39], v[208:211], v[108:111]
    ds_read_b128 a[60:63], v13 offset:7168
    v_mfma_f32_16x16x32_bf16 v[128:131], a[36:39], v[212:215], v[128:131]
    s_add_u32 s40, s53, 49152
    buffer_load_dwordx4 v[148:151], v11, s[4:7], s40 offen sc1
    s_waitcnt lgkmcnt(5)
    v_mfma_f32_16x16x32_bf16 v[72:75], a[40:43], v[200:203], v[72:75]
    v_mfma_f32_16x16x32_bf16 v[92:95], a[40:43], v[204:207], v[92:95]
    ds_read_b128 a[64:67], v13 offset:8192
    v_mfma_f32_16x16x32_bf16 v[112:115], a[40:43], v[208:211], v[112:115]
    v_mfma_f32_16x16x32_bf16 v[132:135], a[40:43], v[212:215], v[132:135]
    s_add_u32 s40, s54, 49152
    buffer_load_dwordx4 v[152:155], v11, s[4:7], s40 offen sc1
    s_waitcnt lgkmcnt(5)
    v_mfma_f32_16x16x32_bf16 v[76:79], a[44:47], v[200:203], v[76:79]
    ds_read_b128 a[68:71], v13 offset:9216
    v_mfma_f32_16x16x32_bf16 v[96:99], a[44:47], v[204:207], v[96:99]
    v_mfma_f32_16x16x32_bf16 v[116:119], a[44:47], v[208:211], v[116:119]
    v_mfma_f32_16x16x32_bf16 v[136:139], a[44:47], v[212:215], v[136:139]
    s_add_u32 s40, s55, 49152
    buffer_load_dwordx4 v[156:159], v11, s[4:7], s40 offen sc1
    s_waitcnt lgkmcnt(5)
    v_mfma_f32_16x16x32_bf16 v[80:83], a[48:51], v[200:203], v[80:83]
    v_mfma_f32_16x16x32_bf16 v[100:103], a[48:51], v[204:207], v[100:103]
    v_mfma_f32_16x16x32_bf16 v[120:123], a[48:51], v[208:211], v[120:123]
    v_mfma_f32_16x16x32_bf16 v[140:143], a[48:51], v[212:215], v[140:143]
    s_waitcnt vmcnt(15) lgkmcnt(4)
    v_mfma_f32_16x16x32_bf16 v[64:67], a[52:55], v[216:219], v[64:67]
    ds_read_b128 a[32:35], v13 offset:10240
    s_waitcnt vmcnt(14)
    v_mfma_f32_16x16x32_bf16 v[84:87], a[52:55], v[220:223], v[84:87]
    s_waitcnt vmcnt(13)
    v_mfma_f32_16x16x32_bf16 v[104:107], a[52:55], a[152:155], v[104:107]
    s_waitcnt vmcnt(12)
    v_mfma_f32_16x16x32_bf16 v[124:127], a[52:55], a[156:159], v[124:127]
    s_add_u32 s40, s52, 53248
    buffer_load_dwordx4 v[200:203], v11, s[4:7], s40 offen sc1
    ds_read_b128 a[36:39], v13 offset:11264
    s_waitcnt lgkmcnt(5)
    v_mfma_f32_16x16x32_bf16 v[68:71], a[56:59], v[216:219], v[68:71]
    v_mfma_f32_16x16x32_bf16 v[88:91], a[56:59], v[220:223], v[88:91]
    v_mfma_f32_16x16x32_bf16 v[108:111], a[56:59], a[152:155], v[108:111]
    ds_read_b128 a[40:43], v13 offset:12288
    v_mfma_f32_16x16x32_bf16 v[128:131], a[56:59], a[156:159], v[128:131]
    s_add_u32 s40, s53, 53248
    buffer_load_dwordx4 v[204:207], v11, s[4:7], s40 offen sc1
    s_waitcnt lgkmcnt(5)
    v_mfma_f32_16x16x32_bf16 v[72:75], a[60:63], v[216:219], v[72:75]
    v_mfma_f32_16x16x32_bf16 v[92:95], a[60:63], v[220:223], v[92:95]
    ds_read_b128 a[44:47], v13 offset:13312
    v_mfma_f32_16x16x32_bf16 v[112:115], a[60:63], a[152:155], v[112:115]
    v_mfma_f32_16x16x32_bf16 v[132:135], a[60:63], a[156:159], v[132:135]
    s_add_u32 s40, s54, 53248
    buffer_load_dwordx4 v[208:211], v11, s[4:7], s40 offen sc1
    s_waitcnt lgkmcnt(5)
    v_mfma_f32_16x16x32_bf16 v[76:79], a[64:67], v[216:219], v[76:79]
    ds_read_b128 a[48:51], v13 offset:14336
    v_mfma_f32_16x16x32_bf16 v[96:99], a[64:67], v[220:223], v[96:99]
    v_mfma_f32_16x16x32_bf16 v[116:119], a[64:67], a[152:155], v[116:119]
    v_mfma_f32_16x16x32_bf16 v[136:139], a[64:67], a[156:159], v[136:139]
    s_add_u32 s40, s55, 53248
    buffer_load_dwordx4 v[212:215], v11, s[4:7], s40 offen sc1
    s_waitcnt lgkmcnt(5)
    v_mfma_f32_16x16x32_bf16 v[80:83], a[68:71], v[216:219], v[80:83]
    v_mfma_f32_16x16x32_bf16 v[100:103], a[68:71], v[220:223], v[100:103]
    v_mfma_f32_16x16x32_bf16 v[120:123], a[68:71], a[152:155], v[120:123]
    v_mfma_f32_16x16x32_bf16 v[140:143], a[68:71], a[156:159], v[140:143]
    s_waitcnt vmcnt(15) lgkmcnt(4)
    v_mfma_f32_16x16x32_bf16 v[64:67], a[32:35], a[120:123], v[64:67]
    ds_read_b128 a[52:55], v13 offset:15360
    s_waitcnt vmcnt(14)
    v_mfma_f32_16x16x32_bf16 v[84:87], a[32:35], a[124:127], v[84:87]
    s_waitcnt vmcnt(13)
    v_mfma_f32_16x16x32_bf16 v[104:107], a[32:35], a[128:131], v[104:107]
    s_waitcnt vmcnt(12)
    v_mfma_f32_16x16x32_bf16 v[124:127], a[32:35], a[132:135], v[124:127]
    ds_read_b128 a[56:59], v13 offset:16384
    s_waitcnt lgkmcnt(5)
    v_mfma_f32_16x16x32_bf16 v[68:71], a[36:39], a[120:123], v[68:71]
    v_mfma_f32_16x16x32_bf16 v[88:91], a[36:39], a[124:127], v[88:91]
    v_mfma_f32_16x16x32_bf16 v[108:111], a[36:39], a[128:131], v[108:111]
    ds_read_b128 a[60:63], v13 offset:17408
    v_mfma_f32_16x16x32_bf16 v[128:131], a[36:39], a[132:135], v[128:131]
    s_waitcnt lgkmcnt(5)
    v_mfma_f32_16x16x32_bf16 v[72:75], a[40:43], a[120:123], v[72:75]
    v_mfma_f32_16x16x32_bf16 v[92:95], a[40:43], a[124:127], v[92:95]
    ds_read_b128 a[64:67], v13 offset:18432
    v_mfma_f32_16x16x32_bf16 v[112:115], a[40:43], a[128:131], v[112:115]
    v_mfma_f32_16x16x32_bf16 v[132:135], a[40:43], a[132:135], v[132:135]
    s_waitcnt lgkmcnt(5)
    v_mfma_f32_16x16x32_bf16 v[76:79], a[44:47], a[120:123], v[76:79]
    ds_read_b128 a[68:71], v13 offset:19456
    v_mfma_f32_16x16x32_bf16 v[96:99], a[44:47], a[124:127], v[96:99]
    v_mfma_f32_16x16x32_bf16 v[116:119], a[44:47], a[128:131], v[116:119]
    v_mfma_f32_16x16x32_bf16 v[136:139], a[44:47], a[132:135], v[136:139]
    s_waitcnt lgkmcnt(5)
    v_mfma_f32_16x16x32_bf16 v[80:83], a[48:51], a[120:123], v[80:83]
    v_mfma_f32_16x16x32_bf16 v[100:103], a[48:51], a[124:127], v[100:103]
    v_mfma_f32_16x16x32_bf16 v[120:123], a[48:51], a[128:131], v[120:123]
    v_mfma_f32_16x16x32_bf16 v[140:143], a[48:51], a[132:135], v[140:143]
    s_waitcnt vmcnt(11) lgkmcnt(4)
    v_mfma_f32_16x16x32_bf16 v[64:67], a[52:55], a[136:139], v[64:67]
    ds_read_b128 a[32:35], v13 offset:20480
    s_waitcnt vmcnt(10)
    v_mfma_f32_16x16x32_bf16 v[84:87], a[52:55], a[140:143], v[84:87]
    s_waitcnt vmcnt(9)
    v_mfma_f32_16x16x32_bf16 v[104:107], a[52:55], a[144:147], v[104:107]
    s_waitcnt vmcnt(8)
    v_mfma_f32_16x16x32_bf16 v[124:127], a[52:55], a[148:151], v[124:127]
    ds_read_b128 a[36:39], v13 offset:21504
    s_waitcnt lgkmcnt(5)
    v_mfma_f32_16x16x32_bf16 v[68:71], a[56:59], a[136:139], v[68:71]
    v_mfma_f32_16x16x32_bf16 v[88:91], a[56:59], a[140:143], v[88:91]
    v_mfma_f32_16x16x32_bf16 v[108:111], a[56:59], a[144:147], v[108:111]
    v_mfma_f32_16x16x32_bf16 v[128:131], a[56:59], a[148:151], v[128:131]
    s_waitcnt lgkmcnt(4)
    v_mfma_f32_16x16x32_bf16 v[72:75], a[60:63], a[136:139], v[72:75]
    v_mfma_f32_16x16x32_bf16 v[92:95], a[60:63], a[140:143], v[92:95]
    v_mfma_f32_16x16x32_bf16 v[112:115], a[60:63], a[144:147], v[112:115]
    v_mfma_f32_16x16x32_bf16 v[132:135], a[60:63], a[148:151], v[132:135]
    s_waitcnt lgkmcnt(3)
    v_mfma_f32_16x16x32_bf16 v[76:79], a[64:67], a[136:139], v[76:79]
    v_mfma_f32_16x16x32_bf16 v[96:99], a[64:67], a[140:143], v[96:99]
    v_mfma_f32_16x16x32_bf16 v[116:119], a[64:67], a[144:147], v[116:119]
    v_mfma_f32_16x16x32_bf16 v[136:139], a[64:67], a[148:151], v[136:139]
    s_waitcnt lgkmcnt(2)
    v_mfma_f32_16x16x32_bf16 v[80:83], a[68:71], a[136:139], v[80:83]
    v_mfma_f32_16x16x32_bf16 v[100:103], a[68:71], a[140:143], v[100:103]
    v_mfma_f32_16x16x32_bf16 v[120:123], a[68:71], a[144:147], v[120:123]
    v_mfma_f32_16x16x32_bf16 v[140:143], a[68:71], a[148:151], v[140:143]
    s_waitcnt vmcnt(7) lgkmcnt(1)
    v_mfma_f32_16x16x32_bf16 v[64:67], a[32:35], v[144:147], v[64:67]
    s_waitcnt vmcnt(6)
    v_mfma_f32_16x16x32_bf16 v[84:87], a[32:35], v[148:151], v[84:87]
    s_waitcnt vmcnt(5)
    v_mfma_f32_16x16x32_bf16 v[104:107], a[32:35], v[152:155], v[104:107]
    s_waitcnt vmcnt(4)
    v_mfma_f32_16x16x32_bf16 v[124:127], a[32:35], v[156:159], v[124:127]
    s_waitcnt lgkmcnt(0)
    v_mfma_f32_16x16x32_bf16 v[68:71], a[36:39], v[144:147], v[68:71]
    v_mfma_f32_16x16x32_bf16 v[88:91], a[36:39], v[148:151], v[88:91]
    v_mfma_f32_16x16x32_bf16 v[108:111], a[36:39], v[152:155], v[108:111]
    v_mfma_f32_16x16x32_bf16 v[128:131], a[36:39], v[156:159], v[128:131]
    v_mfma_f32_16x16x32_bf16 v[72:75], a[0:3], v[144:147], v[72:75]
    v_mfma_f32_16x16x32_bf16 v[92:95], a[0:3], v[148:151], v[92:95]
    v_mfma_f32_16x16x32_bf16 v[112:115], a[0:3], v[152:155], v[112:115]
    v_mfma_f32_16x16x32_bf16 v[132:135], a[0:3], v[156:159], v[132:135]
    v_mfma_f32_16x16x32_bf16 v[76:79], a[4:7], v[144:147], v[76:79]
    v_mfma_f32_16x16x32_bf16 v[96:99], a[4:7], v[148:151], v[96:99]
    v_mfma_f32_16x16x32_bf16 v[116:119], a[4:7], v[152:155], v[116:119]
    v_mfma_f32_16x16x32_bf16 v[136:139], a[4:7], v[156:159], v[136:139]
    v_mfma_f32_16x16x32_bf16 v[80:83], a[8:11], v[144:147], v[80:83]
    v_mfma_f32_16x16x32_bf16 v[100:103], a[8:11], v[148:151], v[100:103]
    v_mfma_f32_16x16x32_bf16 v[120:123], a[8:11], v[152:155], v[120:123]
    v_mfma_f32_16x16x32_bf16 v[140:143], a[8:11], v[156:159], v[140:143]
    s_cmp_ge_u32 s20, 2
    s_cbranch_scc1 L38_b2skip
    s_waitcnt vmcnt(3)
    v_mfma_f32_16x16x32_bf16 v[64:67], a[12:15], v[200:203], v[64:67]
    s_waitcnt vmcnt(2)
    v_mfma_f32_16x16x32_bf16 v[84:87], a[12:15], v[204:207], v[84:87]
    s_waitcnt vmcnt(1)
    v_mfma_f32_16x16x32_bf16 v[104:107], a[12:15], v[208:211], v[104:107]
    s_waitcnt vmcnt(0)
    v_mfma_f32_16x16x32_bf16 v[124:127], a[12:15], v[212:215], v[124:127]
    v_mfma_f32_16x16x32_bf16 v[68:71], a[16:19], v[200:203], v[68:71]
    v_mfma_f32_16x16x32_bf16 v[88:91], a[16:19], v[204:207], v[88:91]
    v_mfma_f32_16x16x32_bf16 v[108:111], a[16:19], v[208:211], v[108:111]
    v_mfma_f32_16x16x32_bf16 v[128:131], a[16:19], v[212:215], v[128:131]
    v_mfma_f32_16x16x32_bf16 v[72:75], a[20:23], v[200:203], v[72:75]
    v_mfma_f32_16x16x32_bf16 v[92:95], a[20:23], v[204:207], v[92:95]
    v_mfma_f32_16x16x32_bf16 v[112:115], a[20:23], v[208:211], v[112:115]
    v_mfma_f32_16x16x32_bf16 v[132:135], a[20:23], v[212:215], v[132:135]
    v_mfma_f32_16x16x32_bf16 v[76:79], a[24:27], v[200:203], v[76:79]
    v_mfma_f32_16x16x32_bf16 v[96:99], a[24:27], v[204:207], v[96:99]
    v_mfma_f32_16x16x32_bf16 v[116:119], a[24:27], v[208:211], v[116:119]
    v_mfma_f32_16x16x32_bf16 v[136:139], a[24:27], v[212:215], v[136:139]
    v_mfma_f32_16x16x32_bf16 v[80:83], a[28:31], v[200:203], v[80:83]
    v_mfma_f32_16x16x32_bf16 v[100:103], a[28:31], v[204:207], v[100:103]
    v_mfma_f32_16x16x32_bf16 v[120:123], a[28:31], v[208:211], v[120:123]
    v_mfma_f32_16x16x32_bf16 v[140:143], a[28:31], v[212:215], v[140:143]
L38_b2skip:
    s_waitcnt vmcnt(0)
    s_nop 7
    v_lshlrev_b32 v10, 4, v0
    s_add_u32 s31, s20, 1
    s_and_b32 s31, s31, 3
    s_mul_i32 s31, s31, 15360
    s_add_u32 s31, s31, 0
    v_add_u32 v13, s31, v10
    ds_write_b128 v13, v[84:87] offset:0
    ds_write_b128 v13, v[88:91] offset:1024
    ds_write_b128 v13, v[92:95] offset:2048
    ds_write_b128 v13, v[96:99] offset:3072
    ds_write_b128 v13, v[100:103] offset:4096
    s_add_u32 s31, s20, 2
    s_and_b32 s31, s31, 3
    s_mul_i32 s31, s31, 15360
    s_add_u32 s31, s31, 5120
    v_add_u32 v13, s31, v10
    ds_write_b128 v13, v[104:107] offset:0
    ds_write_b128 v13, v[108:111] offset:1024
    ds_write_b128 v13, v[112:115] offset:2048
    ds_write_b128 v13, v[116:119] offset:3072
    ds_write_b128 v13, v[120:123] offset:4096
    s_add_u32 s31, s20, 3
    s_and_b32 s31, s31, 3
    s_mul_i32 s31, s31, 15360
    s_add_u32 s31, s31, 10240
    v_add_u32 v13, s31, v10
    ds_write_b128 v13, v[124:127] offset:0
    ds_write_b128 v13, v[128:131] offset:1024
    ds_write_b128 v13, v[132:135] offset:2048
    ds_write_b128 v13, v[136:139] offset:3072
    ds_write_b128 v13, v[140:143] offset:4096
    s_mul_i32 s31, s20, 15360
    v_add_u32 v13, s31, v10
    s_waitcnt lgkmcnt(0)
    s_barrier
    ds_read_b128 v[84:87], v13 offset:0
    ds_read_b128 v[88:91], v13 offset:5120
    ds_read_b128 v[92:95], v13 offset:10240
    ds_read_b128 v[96:99], v13 offset:1024
    ds_read_b128 v[100:103], v13 offset:6144
    ds_read_b128 v[104:107], v13 offset:11264
    ds_read_b128 v[108:111], v13 offset:2048
    ds_read_b128 v[112:115], v13 offset:7168
    ds_read_b128 v[116:119], v13 offset:12288
    ds_read_b128 v[120:123], v13 offset:3072
    ds_read_b128 v[124:127], v13 offset:8192
    ds_read_b128 v[128:131], v13 offset:13312
    ds_read_b128 v[132:135], v13 offset:4096
    ds_read_b128 v[136:139], v13 offset:9216
    ds_read_b128 v[140:143], v13 offset:14336
    s_waitcnt lgkmcnt(14)
    v_pk_add_f32 v[64:65], v[64:65], v[84:85]
    v_pk_add_f32 v[66:67], v[66:67], v[86:87]
    s_waitcnt lgkmcnt(13)
    v_pk_add_f32 v[64:65], v[64:65], v[88:89]
    v_pk_add_f32 v[66:67], v[66:67], v[90:91]
    s_waitcnt lgkmcnt(12)
    v_pk_add_f32 v[64:65], v[64:65], v[92:93]
    v_pk_add_f32 v[66:67], v[66:67], v[94:95]
    s_waitcnt lgkmcnt(11)
    v_pk_add_f32 v[68:69], v[68:69], v[96:97]
    v_pk_add_f32 v[70:71], v[70:71], v[98:99]
    s_waitcnt lgkmcnt(10)
    v_pk_add_f32 v[68:69], v[68:69], v[100:101]
    v_pk_add_f32 v[70:71], v[70:71], v[102:103]
    s_waitcnt lgkmcnt(9)
    v_pk_add_f32 v[68:69], v[68:69], v[104:105]
    v_pk_add_f32 v[70:71], v[70:71], v[106:107]
    s_waitcnt lgkmcnt(8)
    v_pk_add_f32 v[72:73], v[72:73], v[108:109]
    v_pk_add_f32 v[74:75], v[74:75], v[110:111]
    s_waitcnt lgkmcnt(7)
    v_pk_add_f32 v[72:73], v[72:73], v[112:113]
    v_pk_add_f32 v[74:75], v[74:75], v[114:115]
    s_waitcnt lgkmcnt(6)
    v_pk_add_f32 v[72:73], v[72:73], v[116:117]
    v_pk_add_f32 v[74:75], v[74:75], v[118:119]
    s_waitcnt lgkmcnt(5)
    v_pk_add_f32 v[76:77], v[76:77], v[120:121]
    v_pk_add_f32 v[78:79], v[78:79], v[122:123]
    s_waitcnt lgkmcnt(4)
    v_pk_add_f32 v[76:77], v[76:77], v[124:125]
    v_pk_add_f32 v[78:79], v[78:79], v[126:127]
    s_waitcnt lgkmcnt(3)
    v_pk_add_f32 v[76:77], v[76:77], v[128:129]
    v_pk_add_f32 v[78:79], v[78:79], v[130:131]
    s_waitcnt lgkmcnt(2)
    v_pk_add_f32 v[80:81], v[80:81], v[132:133]
    v_pk_add_f32 v[82:83], v[82:83], v[134:135]
    s_waitcnt lgkmcnt(1)
    v_pk_add_f32 v[80:81], v[80:81], v[136:137]
    v_pk_add_f32 v[82:83], v[82:83], v[138:139]
    s_waitcnt lgkmcnt(0)
    v_pk_add_f32 v[80:81], v[80:81], v[140:141]
    v_pk_add_f32 v[82:83], v[82:83], v[142:143]
    v_lshrrev_b32 v3, 1, v2
    v_and_b32 v4, 1, v2
    v_lshlrev_b32 v5, 4, v1
    v_lshl_add_u32 v5, v3, 8, v5
    v_lshl_add_u32 v13, v4, 3, v5
    s_lshl_b32 s38, s71, 2
    s_add_u32 s38, s38, s20
    s_mul_i32 s36, s70, 163840
    s_mul_i32 s37, s38, 20480
    s_add_u32 s36, s36, s37
    s_mul_i32 s37, s72, 2560
    s_add_u32 s36, s36, s37
    s_add_u32 s36, s36, 31625216
    v_lshlrev_b32 v14, 16, v240
    v_and_b32 v15, 0xffff0000, v240
    v_lshlrev_b32 v6, 16, v241
    v_and_b32 v7, 0xffff0000, v241
    v_pk_add_f32 v[64:65], v[64:65], v[14:15]
    v_pk_add_f32 v[66:67], v[66:67], v[6:7]
    v_cvt_pk_bf16_f32 v240, v64, v65
    v_cvt_pk_bf16_f32 v241, v66, v67
    buffer_store_dwordx2 v[240:241], v13, s[4:7], s36 offen offset:0 sc1
    v_lshlrev_b32 v14, 16, v242
    v_and_b32 v15, 0xffff0000, v242
    v_lshlrev_b32 v6, 16, v243
    v_and_b32 v7, 0xffff0000, v243
    v_pk_add_f32 v[68:69], v[68:69], v[14:15]
    v_pk_add_f32 v[70:71], v[70:71], v[6:7]
    v_cvt_pk_bf16_f32 v242, v68, v69
    v_cvt_pk_bf16_f32 v243, v70, v71
    buffer_store_dwordx2 v[242:243], v13, s[4:7], s36 offen offset:512 sc1
    v_lshlrev_b32 v14, 16, v244
    v_and_b32 v15, 0xffff0000, v244
    v_lshlrev_b32 v6, 16, v245
    v_and_b32 v7, 0xffff0000, v245
    v_pk_add_f32 v[72:73], v[72:73], v[14:15]
    v_pk_add_f32 v[74:75], v[74:75], v[6:7]
    v_cvt_pk_bf16_f32 v244, v72, v73
    v_cvt_pk_bf16_f32 v245, v74, v75
    buffer_store_dwordx2 v[244:245], v13, s[4:7], s36 offen offset:1024 sc1
    v_lshlrev_b32 v14, 16, v246
    v_and_b32 v15, 0xffff0000, v246
    v_lshlrev_b32 v6, 16, v247
    v_and_b32 v7, 0xffff0000, v247
    v_pk_add_f32 v[76:77], v[76:77], v[14:15]
    v_pk_add_f32 v[78:79], v[78:79], v[6:7]
    v_cvt_pk_bf16_f32 v246, v76, v77
    v_cvt_pk_bf16_f32 v247, v78, v79
    buffer_store_dwordx2 v[246:247], v13, s[4:7], s36 offen offset:1536 sc1
    v_lshlrev_b32 v14, 16, v248
    v_and_b32 v15, 0xffff0000, v248
    v_lshlrev_b32 v6, 16, v249
    v_and_b32 v7, 0xffff0000, v249
    v_pk_add_f32 v[80:81], v[80:81], v[14:15]
    v_pk_add_f32 v[82:83], v[82:83], v[6:7]
    v_cvt_pk_bf16_f32 v248, v80, v81
    v_cvt_pk_bf16_f32 v249, v82, v83
    buffer_store_dwordx2 v[248:249], v13, s[4:7], s36 offen offset:2048 sc1
    v_pk_mul_f32 v[52:53], v[64:65], v[64:65]
    v_pk_add_f32 v[50:51], v[64:65], v[66:67]
    v_pk_fma_f32 v[52:53], v[66:67], v[66:67], v[52:53]
    v_pk_fma_f32 v[52:53], v[68:69], v[68:69], v[52:53]
    v_pk_add_f32 v[50:51], v[50:51], v[68:69]
    v_pk_fma_f32 v[52:53], v[70:71], v[70:71], v[52:53]
    v_pk_add_f32 v[50:51], v[50:51], v[70:71]
    v_pk_fma_f32 v[52:53], v[72:73], v[72:73], v[52:53]
    v_pk_add_f32 v[50:51], v[50:51], v[72:73]
    v_pk_fma_f32 v[52:53], v[74:75], v[74:75], v[52:53]
    v_pk_add_f32 v[50:51], v[50:51], v[74:75]
    v_pk_fma_f32 v[52:53], v[76:77], v[76:77], v[52:53]
    v_pk_add_f32 v[50:51], v[50:51], v[76:77]
    v_pk_fma_f32 v[52:53], v[78:79], v[78:79], v[52:53]
    v_pk_add_f32 v[50:51], v[50:51], v[78:79]
    v_pk_fma_f32 v[52:53], v[80:81], v[80:81], v[52:53]
    v_pk_add_f32 v[50:51], v[50:51], v[80:81]
    v_pk_fma_f32 v[52:53], v[82:83], v[82:83], v[52:53]
    v_pk_add_f32 v[50:51], v[50:51], v[82:83]
    v_add_f32 v48, v50, v51
    v_add_f32 v49, v52, v53
    v_mov_b32 v3, v48
    s_nop 1
    v_permlane16_swap_b32 v48, v3
    v_add_f32 v48, v48, v3
    v_mov_b32 v3, v48
    s_nop 1
    v_permlane32_swap_b32 v48, v3
    v_add_f32 v48, v48, v3
    v_mov_b32 v3, v49
    s_nop 1
    v_permlane16_swap_b32 v49, v3
    v_add_f32 v49, v49, v3
    v_mov_b32 v3, v49
    s_nop 1
    v_permlane32_swap_b32 v49, v3
    v_add_f32 v49, v49, v3
    s_lshl_b32 s36, s70, 13
    s_lshr_b32 s37, s72, 1
    s_lshl_b32 s37, s37, 11
    s_add_u32 s36, s36, s37
    s_lshl_b32 s37, s38, 8
    s_add_u32 s36, s36, s37
    s_and_b32 s37, s72, 1
    s_lshl_b32 s37, s37, 3
    s_add_u32 s36, s36, s37
    s_add_u32 s36, s36, 34246656
    v_lshlrev_b32 v5, 4, v1
    buffer_store_dwordx2 v[48:49], v5, s[4:7], s36 offen sc1
    s_mov_b32 s38, 819200
    s_mov_b32 s39, 0x20000
    v_lshrrev_b32 v14, 4, v0
    v_and_b32 v15, 15, v0
    s_lshl_b32 s28, s20, 2
    v_add_u32 v3, s28, v14
    v_xor_b32 v3, v15, v3
    v_mul_u32_u24 v4, 1280, v14
    v_lshl_add_u32 v28, v3, 4, v4
    s_or_b32 s29, s72, s20
    s_cmp_eq_u32 s29, 0
    s_cselect_b32 s29, 409600, 0
    v_cmp_eq_u32 vcc, 0, v14
    v_mov_b32 v5, s29
    s_nop 0
    v_cndmask_b32 v5, 0, v5, vcc
    v_add_u32 v29, v28, v5
    s_mul_i32 s30, s72, 40
    s_and_b32 s31, s20, 1
    s_lshl_b32 s31, s31, 2
    s_add_u32 s30, s30, s31
    s_mul_i32 s30, s30, 1280
    s_lshl_b32 s32, s20, 10
    s_lshl_b32 s31, s71, 2
    s_add_u32 s31, s31, s20
    s_mul_i32 s29, s31, 20480
    s_mul_i32 s33, s70, 163840
    s_add_u32 s29, s29, s33
    s_add_u32 s29, s29, 31625216
    s_lshl_b32 s31, s31, 8
    s_lshl_b32 s33, s70, 13
    s_add_u32 s31, s31, s33
    s_add_u32 s31, s31, 34246656
    v_lshlrev_b32 v10, 4, v0
    v_lshlrev_b32 v11, 4, v15
    v_lshl_add_u32 v11, v14, 11, v11
    s_cmp_lt_u32 s20, 2
    s_cselect_b32 s36, s12, s16
    s_cselect_b32 s37, s13, s17
    v_add_u32 v3, 0, v14
    v_xor_b32 v3, v15, v3
    v_lshlrev_b32 v3, 4, v3
    v_lshl_add_u32 v30, v15, 8, v3
    v_add_u32 v34, 61440, v30
    v_add_u32 v3, 4, v14
    v_xor_b32 v3, v15, v3
    v_lshlrev_b32 v3, 4, v3
    v_lshl_add_u32 v31, v15, 8, v3
    v_add_u32 v35, 61440, v31
    v_add_u32 v3, 8, v14
    v_xor_b32 v3, v15, v3
    v_lshlrev_b32 v3, 4, v3
    v_lshl_add_u32 v32, v15, 8, v3
    v_add_u32 v36, 61440, v32
    v_add_u32 v3, 12, v14
    v_xor_b32 v3, v15, v3
    v_lshlrev_b32 v3, 4, v3
    v_lshl_add_u32 v33, v15, 8, v3
    v_add_u32 v37, 61440, v33
    v_mov_b32 v45, 1.0
    v_mov_b32 v6, -1.0
    v_cmp_gt_u32 vcc, 8, v15
    s_nop 1
    v_cndmask_b32 v45, v6, v45, vcc
    v_and_b32 v3, 7, v15
    v_lshrrev_b32 v4, 3, v15
    v_lshlrev_b32 v3, 4, v3
    v_lshl_add_u32 v3, v4, 3, v3
    v_mul_u32_u24 v4, 2560, v14
    v_add_u32 v3, v3, v4
    s_lshl_b32 s53, s20, 1
    v_add_u32 v3, s53, v3
    v_add_u32 v44, 61440, v3
    s_lshl_b32 s53, s20, 6
    v_add_u32 v7, s53, v0
    s_lshl_b32 s54, s70, 1
    s_add_u32 s54, s54, s71
    s_mul_i32 s54, s54, 320
    s_mul_i32 s53, s72, 40
    s_add_u32 s54, s54, s53
    s_lshl_b32 s54, s54, 4
    s_add_u32 s54, s54, 9342976
    v_add_u32 v8, 0, v7
    v_mul_u32_u24 v9, 205, v8
    v_lshrrev_b32 v9, 13, v9
    v_mul_u32_u24 v6, 40, v9
    v_sub_u32 v6, v8, v6
    v_mul_u32_u24 v9, 163840, v9
    v_lshl_add_u32 v38, v6, 4, v9
    v_lshlrev_b32 v8, 4, v8
    v_add_u32 v41, 61440, v8
    v_add_u32 v8, 256, v7
    v_mul_u32_u24 v9, 205, v8
    v_lshrrev_b32 v9, 13, v9
    v_mul_u32_u24 v6, 40, v9
    v_sub_u32 v6, v8, v6
    v_mul_u32_u24 v9, 163840, v9
    v_lshl_add_u32 v39, v6, 4, v9
    v_lshlrev_b32 v8, 4, v8
    v_add_u32 v42, 61440, v8
    v_add_u32 v8, 512, v7
    v_mul_u32_u24 v9, 205, v8
    v_lshrrev_b32 v9, 13, v9
    v_mul_u32_u24 v6, 40, v9
    v_sub_u32 v6, v8, v6
    v_mul_u32_u24 v9, 163840, v9
    v_lshl_add_u32 v40, v6, 4, v9
    v_lshlrev_b32 v8, 4, v8
    v_add_u32 v43, 61440, v8
    s_waitcnt vmcnt(0)
    s_waitcnt vmcnt(0)
    s_barrier
    s_lshl_b32 s61, s70, 1
    s_add_u32 s61, s61, s71
    s_lshl_b32 s61, s61, 8
    s_add_u32 s61, s61, 34394112
    s_cmp_lg_u32 s20, 0
    s_cbranch_scc1 L43_ol
    s_mov_b64 exec, 1
    v_mov_b32 v254, 1
    v_mov_b32 v255, 0
    buffer_atomic_add v254, v255, s[4:7], s61 offen sc1
    s_mov_b64 exec, -1
L43_ol:
    s_cmp_eq_u32 s20, 0
    s_cbranch_scc1 L44_ct
    s_getpc_b64 s[58:59]
L45_cp:
    s_sub_u32 s60, s20, 1
    s_lshl_b32 s60, s60, 13
    v_lshlrev_b32 v222, 7, v0
    v_add_u32 v222, s60, v222
    s_mov_b32 s60, L_exit-L45_cp
    v_min_u32 v222, s60, v222
    v_mov_b32 v223, s59
    v_add_co_u32 v222, vcc, s58, v222
    s_nop 1
    v_addc_co_u32 v223, vcc, 0, v223, vcc
    global_load_dword v220, v[222:223], off
L44_ct:
    s_cmp_eq_u32 s20, 0
    s_cbranch_scc1 L49_pb
    s_add_u32 m0, s32, 0
    s_add_u32 s33, s30, 0
    buffer_load_dwordx4 v29, s[36:39], s33 offen lds
    s_add_u32 m0, s32, 4096
    s_add_u32 s33, s30, 10240
    buffer_load_dwordx4 v28, s[36:39], s33 offen lds
    s_add_u32 m0, s32, 8192
    s_add_u32 s33, s30, 20480
    buffer_load_dwordx4 v28, s[36:39], s33 offen lds
    s_add_u32 m0, s32, 12288
    s_add_u32 s33, s30, 30720
    buffer_load_dwordx4 v28, s[36:39], s33 offen lds
    s_add_u32 m0, s32, 16384
    s_add_u32 s33, s30, 40960
    buffer_load_dwordx4 v28, s[36:39], s33 offen lds
    s_add_u32 m0, s32, 20480
    s_add_u32 s33, s30, 256
    buffer_load_dwordx4 v29, s[36:39], s33 offen lds
    s_add_u32 m0, s32, 24576
    s_add_u32 s33, s30, 10496
    buffer_load_dwordx4 v28, s[36:39], s33 offen lds
    s_add_u32 m0, s32, 28672
    s_add_u32 s33, s30, 20736
    buffer_load_dwordx4 v28, s[36:39], s33 offen lds
    s_add_u32 m0, s32, 32768
    s_add_u32 s33, s30, 30976
    buffer_load_dwordx4 v28, s[36:39], s33 offen lds
    s_add_u32 m0, s32, 36864
    s_add_u32 s33, s30, 41216
    buffer_load_dwordx4 v28, s[36:39], s33 offen lds
L49_pb:
    s_lshl_b32 s61, s70, 1
    s_add_u32 s61, s61, s71
    s_lshl_b32 s61, s61, 8
    s_add_u32 s61, s61, 34394112
    s_cmp_lg_u32 s20, 0
    s_cbranch_scc1 L48_ws
    v_mov_b32 v255, 0
    s_mov_b32 s62, 0
L46_w:
    buffer_load_dword v254, v255, s[4:7], s61 offen sc1
    s_waitcnt vmcnt(0)
    v_cmp_gt_u32 vcc, 8, v254
    s_add_u32 s62, s62, 1
    s_nop 1
    s_cmp_eq_u64 vcc, 0
    s_cbranch_scc1 L47_wd
    s_cmp_lt_u32 s62, 65536
    s_cbranch_scc1 L46_w
L47_wd:
L48_ws:
    s_barrier
    s_cmp_lg_u32 s20, 0
    s_cbranch_scc1 L50_pb
    s_add_u32 m0, s32, 0
    s_add_u32 s33, s30, 0
    s_nop 0
    buffer_load_dwordx4 v29, s[36:39], s33 offen lds
    s_add_u32 m0, s32, 4096
    s_add_u32 s33, s30, 10240
    s_nop 0
    buffer_load_dwordx4 v28, s[36:39], s33 offen lds
    s_add_u32 m0, s32, 8192
    s_add_u32 s33, s30, 20480
    s_nop 0
    buffer_load_dwordx4 v28, s[36:39], s33 offen lds
    s_add_u32 m0, s32, 12288
    s_add_u32 s33, s30, 30720
    s_nop 0
    buffer_load_dwordx4 v28, s[36:39], s33 offen lds
    s_add_u32 m0, s32, 16384
    s_add_u32 s33, s30, 40960
    s_nop 0
    buffer_load_dwordx4 v28, s[36:39], s33 offen lds
    s_add_u32 m0, s32, 20480
    s_add_u32 s33, s30, 256
    s_nop 0
    buffer_load_dwordx4 v29, s[36:39], s33 offen lds
    s_add_u32 m0, s32, 24576
    s_add_u32 s33, s30, 10496
    s_nop 0
    buffer_load_dwordx4 v28, s[36:39], s33 offen lds
    s_add_u32 m0, s32, 28672
    s_add_u32 s33, s30, 20736
    s_nop 0
    buffer_load_dwordx4 v28, s[36:39], s33 offen lds
    s_add_u32 m0, s32, 32768
    s_add_u32 s33, s30, 30976
    s_nop 0
    buffer_load_dwordx4 v28, s[36:39], s33 offen lds
    s_add_u32 m0, s32, 36864
    s_add_u32 s33, s30, 41216
    s_nop 0
    buffer_load_dwordx4 v28, s[36:39], s33 offen lds
L50_pb:
    s_add_u32 s33, s29, 0
    buffer_load_dwordx4 a[0:3], v10, s[4:7], s33 offen offset:0 sc1
    s_add_u32 s33, s29, 0
    buffer_load_dwordx4 a[4:7], v10, s[4:7], s33 offen offset:1024 sc1
    s_add_u32 s33, s29, 0
    buffer_load_dwordx4 a[8:11], v10, s[4:7], s33 offen offset:2048 sc1
    s_add_u32 s33, s29, 0
    buffer_load_dwordx4 a[12:15], v10, s[4:7], s33 offen offset:3072 sc1
    buffer_load_dwordx4 v[52:55], v11, s[4:7], s31 offen sc1
    s_add_u32 s33, s29, 4096
    buffer_load_dwordx4 a[16:19], v10, s[4:7], s33 offen offset:0 sc1
    s_add_u32 s33, s29, 4096
    buffer_load_dwordx4 a[20:23], v10, s[4:7], s33 offen offset:1024 sc1
    s_add_u32 s33, s29, 4096
    buffer_load_dwordx4 a[24:27], v10, s[4:7], s33 offen offset:2048 sc1
    s_add_u32 s33, s29, 4096
    buffer_load_dwordx4 a[28:31], v10, s[4:7], s33 offen offset:3072 sc1
    s_add_u32 m0, s32, 40960
    s_add_u32 s33, s30, 512
    buffer_load_dwordx4 v29, s[36:39], s33 offen lds
    s_add_u32 m0, s32, 45056
    s_add_u32 s33, s30, 10752
    buffer_load_dwordx4 v28, s[36:39], s33 offen lds
    s_add_u32 m0, s32, 49152
    s_add_u32 s33, s30, 20992
    buffer_load_dwordx4 v28, s[36:39], s33 offen lds
    s_add_u32 m0, s32, 53248
    s_add_u32 s33, s30, 31232
    buffer_load_dwordx4 v28, s[36:39], s33 offen lds
    s_add_u32 m0, s32, 57344
    s_add_u32 s33, s30, 41472
    buffer_load_dwordx4 v28, s[36:39], s33 offen lds
    s_waitcnt vmcnt(14)
    s_barrier
    ds_read_b128 v[96:99], v30 offset:0
    ds_read_b128 v[100:103], v30 offset:4096
    ds_read_b128 v[104:107], v30 offset:8192
    ds_read_b128 v[108:111], v30 offset:12288
    ds_read_b128 v[112:115], v30 offset:16384
    s_waitcnt vmcnt(13) lgkmcnt(4)
    v_mfma_f32_16x16x32_bf16 v[64:67], a[0:3], v[96:99], 0
    ds_read_b128 v[116:119], v31 offset:0
    s_waitcnt lgkmcnt(4)
    v_mfma_f32_16x16x32_bf16 v[68:71], a[0:3], v[100:103], 0
    ds_read_b128 v[120:123], v31 offset:4096
    s_waitcnt lgkmcnt(4)
    v_mfma_f32_16x16x32_bf16 v[72:75], a[0:3], v[104:107], 0
    ds_read_b128 v[124:127], v31 offset:8192
    s_add_u32 s33, s29, 8192
    buffer_load_dwordx4 a[32:35], v10, s[4:7], s33 offen offset:0 sc1
    s_waitcnt lgkmcnt(4)
    v_mfma_f32_16x16x32_bf16 v[76:79], a[0:3], v[108:111], 0
    ds_read_b128 v[128:131], v31 offset:12288
    s_waitcnt lgkmcnt(4)
    v_mfma_f32_16x16x32_bf16 v[80:83], a[0:3], v[112:115], 0
    ds_read_b128 v[132:135], v31 offset:16384
    s_waitcnt vmcnt(13) lgkmcnt(4)
    v_mfma_f32_16x16x32_bf16 v[64:67], a[4:7], v[116:119], v[64:67]
    ds_read_b128 v[96:99], v32 offset:0
    s_waitcnt lgkmcnt(4)
    v_mfma_f32_16x16x32_bf16 v[68:71], a[4:7], v[120:123], v[68:71]
    ds_read_b128 v[100:103], v32 offset:4096
    s_waitcnt lgkmcnt(4)
    v_mfma_f32_16x16x32_bf16 v[72:75], a[4:7], v[124:127], v[72:75]
    ds_read_b128 v[104:107], v32 offset:8192
    s_add_u32 s33, s29, 8192
    buffer_load_dwordx4 a[36:39], v10, s[4:7], s33 offen offset:1024 sc1
    s_waitcnt lgkmcnt(4)
    v_mfma_f32_16x16x32_bf16 v[76:79], a[4:7], v[128:131], v[76:79]
    ds_read_b128 v[108:111], v32 offset:12288
    s_waitcnt lgkmcnt(4)
    v_mfma_f32_16x16x32_bf16 v[80:83], a[4:7], v[132:135], v[80:83]
    ds_read_b128 v[112:115], v32 offset:16384
    s_waitcnt vmcnt(13) lgkmcnt(4)
    v_mfma_f32_16x16x32_bf16 v[64:67], a[8:11], v[96:99], v[64:67]
    ds_read_b128 v[116:119], v33 offset:0
    s_waitcnt lgkmcnt(4)
    v_mfma_f32_16x16x32_bf16 v[68:71], a[8:11], v[100:103], v[68:71]
    ds_read_b128 v[120:123], v33 offset:4096
    s_waitcnt lgkmcnt(4)
    v_mfma_f32_16x16x32_bf16 v[72:75], a[8:11], v[104:107], v[72:75]
    ds_read_b128 v[124:127], v33 offset:8192
    s_add_u32 s33, s29, 8192
    buffer_load_dwordx4 a[40:43], v10, s[4:7], s33 offen offset:2048 sc1
    s_waitcnt lgkmcnt(4)
    v_mfma_f32_16x16x32_bf16 v[76:79], a[8:11], v[108:111], v[76:79]
    ds_read_b128 v[128:131], v33 offset:12288
    s_waitcnt lgkmcnt(4)
    v_mfma_f32_16x16x32_bf16 v[80:83], a[8:11], v[112:115], v[80:83]
    ds_read_b128 v[132:135], v33 offset:16384
    s_waitcnt lgkmcnt(0)
    s_barrier
    s_waitcnt vmcnt(13)
    v_mfma_f32_16x16x32_bf16 v[64:67], a[12:15], v[116:119], v[64:67]
    ds_read_b128 v[96:99], v30 offset:20480
    s_add_u32 m0, s32, 0
    s_add_u32 s33, s30, 768
    buffer_load_dwordx4 v29, s[36:39], s33 offen lds
    v_mfma_f32_16x16x32_bf16 v[68:71], a[12:15], v[120:123], v[68:71]
    ds_read_b128 v[100:103], v30 offset:24576
    v_mfma_f32_16x16x32_bf16 v[72:75], a[12:15], v[124:127], v[72:75]
    ds_read_b128 v[104:107], v30 offset:28672
    s_add_u32 s33, s29, 8192
    buffer_load_dwordx4 a[44:47], v10, s[4:7], s33 offen offset:3072 sc1
    v_mfma_f32_16x16x32_bf16 v[76:79], a[12:15], v[128:131], v[76:79]
    ds_read_b128 v[108:111], v30 offset:32768
    v_mfma_f32_16x16x32_bf16 v[80:83], a[12:15], v[132:135], v[80:83]
    ds_read_b128 v[112:115], v30 offset:36864
    s_add_u32 m0, s32, 4096
    s_add_u32 s33, s30, 11008
    buffer_load_dwordx4 v28, s[36:39], s33 offen lds
    s_waitcnt vmcnt(14) lgkmcnt(4)
    v_mfma_f32_16x16x32_bf16 v[64:67], a[16:19], v[96:99], v[64:67]
    ds_read_b128 v[116:119], v31 offset:20480
    s_add_u32 m0, s32, 8192
    s_add_u32 s33, s30, 21248
    buffer_load_dwordx4 v28, s[36:39], s33 offen lds
    s_waitcnt lgkmcnt(4)
    v_mfma_f32_16x16x32_bf16 v[68:71], a[16:19], v[100:103], v[68:71]
    ds_read_b128 v[120:123], v31 offset:24576
    s_waitcnt lgkmcnt(4)
    v_mfma_f32_16x16x32_bf16 v[72:75], a[16:19], v[104:107], v[72:75]
    ds_read_b128 v[124:127], v31 offset:28672
    s_add_u32 s33, s29, 12288
    buffer_load_dwordx4 a[48:51], v10, s[4:7], s33 offen offset:0 sc1
    s_waitcnt lgkmcnt(4)
    v_mfma_f32_16x16x32_bf16 v[76:79], a[16:19], v[108:111], v[76:79]
    ds_read_b128 v[128:131], v31 offset:32768
    s_waitcnt lgkmcnt(4)
    v_mfma_f32_16x16x32_bf16 v[80:83], a[16:19], v[112:115], v[80:83]
    ds_read_b128 v[132:135], v31 offset:36864
    s_add_u32 m0, s32, 12288
    s_add_u32 s33, s30, 31488
    buffer_load_dwordx4 v28, s[36:39], s33 offen lds
    s_waitcnt vmcnt(16) lgkmcnt(4)
    v_mfma_f32_16x16x32_bf16 v[64:67], a[20:23], v[116:119], v[64:67]
    ds_read_b128 v[96:99], v32 offset:20480
    s_add_u32 m0, s32, 16384
    s_add_u32 s33, s30, 41728
    buffer_load_dwordx4 v28, s[36:39], s33 offen lds
    s_waitcnt lgkmcnt(4)
    v_mfma_f32_16x16x32_bf16 v[68:71], a[20:23], v[120:123], v[68:71]
    ds_read_b128 v[100:103], v32 offset:24576
    s_waitcnt lgkmcnt(4)
    v_mfma_f32_16x16x32_bf16 v[72:75], a[20:23], v[124:127], v[72:75]
    ds_read_b128 v[104:107], v32 offset:28672
    s_add_u32 s33, s29, 12288
    buffer_load_dwordx4 a[52:55], v10, s[4:7], s33 offen offset:1024 sc1
    s_waitcnt lgkmcnt(4)
    v_mfma_f32_16x16x32_bf16 v[76:79], a[20:23], v[128:131], v[76:79]
    ds_read_b128 v[108:111], v32 offset:32768
    s_waitcnt lgkmcnt(4)
    v_mfma_f32_16x16x32_bf16 v[80:83], a[20:23], v[132:135], v[80:83]
    ds_read_b128 v[112:115], v32 offset:36864
    s_waitcnt vmcnt(17) lgkmcnt(4)
    v_mfma_f32_16x16x32_bf16 v[64:67], a[24:27], v[96:99], v[64:67]
    ds_read_b128 v[116:119], v33 offset:20480
    s_waitcnt lgkmcnt(4)
    v_mfma_f32_16x16x32_bf16 v[68:71], a[24:27], v[100:103], v[68:71]
    ds_read_b128 v[120:123], v33 offset:24576
    s_waitcnt lgkmcnt(4)
    v_mfma_f32_16x16x32_bf16 v[72:75], a[24:27], v[104:107], v[72:75]
    ds_read_b128 v[124:127], v33 offset:28672
    s_add_u32 s33, s29, 12288
    buffer_load_dwordx4 a[56:59], v10, s[4:7], s33 offen offset:2048 sc1
    s_waitcnt lgkmcnt(4)
    v_mfma_f32_16x16x32_bf16 v[76:79], a[24:27], v[108:111], v[76:79]
    ds_read_b128 v[128:131], v33 offset:32768
    s_waitcnt lgkmcnt(4)
    v_mfma_f32_16x16x32_bf16 v[80:83], a[24:27], v[112:115], v[80:83]
    ds_read_b128 v[132:135], v33 offset:36864
    s_waitcnt lgkmcnt(0)
    s_waitcnt vmcnt(12)
    s_barrier
    v_mfma_f32_16x16x32_bf16 v[64:67], a[28:31], v[116:119], v[64:67]
    ds_read_b128 v[96:99], v30 offset:40960
    s_add_u32 m0, s32, 20480
    s_add_u32 s33, s30, 1024
    buffer_load_dwordx4 v29, s[36:39], s33 offen lds
    v_mfma_f32_16x16x32_bf16 v[68:71], a[28:31], v[120:123], v[68:71]
    ds_read_b128 v[100:103], v30 offset:45056
    v_mfma_f32_16x16x32_bf16 v[72:75], a[28:31], v[124:127], v[72:75]
    ds_read_b128 v[104:107], v30 offset:49152
    s_add_u32 s33, s29, 12288
    buffer_load_dwordx4 a[60:63], v10, s[4:7], s33 offen offset:3072 sc1
    v_mfma_f32_16x16x32_bf16 v[76:79], a[28:31], v[128:131], v[76:79]
    ds_read_b128 v[108:111], v30 offset:53248
    v_mfma_f32_16x16x32_bf16 v[80:83], a[28:31], v[132:135], v[80:83]
    ds_read_b128 v[112:115], v30 offset:57344
    s_add_u32 m0, s32, 24576
    s_add_u32 s33, s30, 11264
    buffer_load_dwordx4 v28, s[36:39], s33 offen lds
    s_waitcnt vmcnt(14) lgkmcnt(4)
    v_mfma_f32_16x16x32_bf16 v[64:67], a[32:35], v[96:99], v[64:67]
    ds_read_b128 v[116:119], v31 offset:40960
    s_add_u32 m0, s32, 28672
    s_add_u32 s33, s30, 21504
    buffer_load_dwordx4 v28, s[36:39], s33 offen lds
    s_waitcnt lgkmcnt(4)
    v_mfma_f32_16x16x32_bf16 v[68:71], a[32:35], v[100:103], v[68:71]
    ds_read_b128 v[120:123], v31 offset:45056
    s_waitcnt lgkmcnt(4)
    v_mfma_f32_16x16x32_bf16 v[72:75], a[32:35], v[104:107], v[72:75]
    ds_read_b128 v[124:127], v31 offset:49152
    s_add_u32 s33, s29, 16384
    buffer_load_dwordx4 a[64:67], v10, s[4:7], s33 offen offset:0 sc1
    s_waitcnt lgkmcnt(4)
    v_mfma_f32_16x16x32_bf16 v[76:79], a[32:35], v[108:111], v[76:79]
    ds_read_b128 v[128:131], v31 offset:53248
    s_waitcnt lgkmcnt(4)
    v_mfma_f32_16x16x32_bf16 v[80:83], a[32:35], v[112:115], v[80:83]
    ds_read_b128 v[132:135], v31 offset:57344
    s_add_u32 m0, s32, 32768
    s_add_u32 s33, s30, 31744
    buffer_load_dwordx4 v28, s[36:39], s33 offen lds
    s_waitcnt vmcnt(16) lgkmcnt(4)
    v_mfma_f32_16x16x32_bf16 v[64:67], a[36:39], v[116:119], v[64:67]
    ds_read_b128 v[96:99], v32 offset:40960
    s_add_u32 m0, s32, 36864
    s_add_u32 s33, s30, 41984
    buffer_load_dwordx4 v28, s[36:39], s33 offen lds
    s_waitcnt lgkmcnt(4)
    v_mfma_f32_16x16x32_bf16 v[68:71], a[36:39], v[120:123], v[68:71]
    ds_read_b128 v[100:103], v32 offset:45056
    s_waitcnt lgkmcnt(4)
    v_mfma_f32_16x16x32_bf16 v[72:75], a[36:39], v[124:127], v[72:75]
    ds_read_b128 v[104:107], v32 offset:49152
    s_add_u32 s33, s29, 16384
    buffer_load_dwordx4 a[68:71], v10, s[4:7], s33 offen offset:1024 sc1
    s_waitcnt lgkmcnt(4)
    v_mfma_f32_16x16x32_bf16 v[76:79], a[36:39], v[128:131], v[76:79]
    ds_read_b128 v[108:111], v32 offset:53248
    s_waitcnt lgkmcnt(4)
    v_mfma_f32_16x16x32_bf16 v[80:83], a[36:39], v[132:135], v[80:83]
    ds_read_b128 v[112:115], v32 offset:57344
    s_waitcnt vmcnt(17) lgkmcnt(4)
    v_mfma_f32_16x16x32_bf16 v[64:67], a[40:43], v[96:99], v[64:67]
    ds_read_b128 v[116:119], v33 offset:40960
    s_waitcnt lgkmcnt(4)
    v_mfma_f32_16x16x32_bf16 v[68:71], a[40:43], v[100:103], v[68:71]
    ds_read_b128 v[120:123], v33 offset:45056
    s_waitcnt lgkmcnt(4)
    v_mfma_f32_16x16x32_bf16 v[72:75], a[40:43], v[104:107], v[72:75]
    ds_read_b128 v[124:127], v33 offset:49152
    s_add_u32 s33, s29, 16384
    buffer_load_dwordx4 a[72:75], v10, s[4:7], s33 offen offset:2048 sc1
    s_waitcnt lgkmcnt(4)
    v_mfma_f32_16x16x32_bf16 v[76:79], a[40:43], v[108:111], v[76:79]
    ds_read_b128 v[128:131], v33 offset:53248
    s_waitcnt lgkmcnt(4)
    v_mfma_f32_16x16x32_bf16 v[80:83], a[40:43], v[112:115], v[80:83]
    ds_read_b128 v[132:135], v33 offset:57344
    s_waitcnt lgkmcnt(0)
    s_waitcnt vmcnt(11)
    s_barrier
    v_mfma_f32_16x16x32_bf16 v[64:67], a[44:47], v[116:119], v[64:67]
    ds_read_b128 v[96:99], v30 offset:0
    v_mfma_f32_16x16x32_bf16 v[68:71], a[44:47], v[120:123], v[68:71]
    ds_read_b128 v[100:103], v30 offset:4096
    v_mfma_f32_16x16x32_bf16 v[72:75], a[44:47], v[124:127], v[72:75]
    ds_read_b128 v[104:107], v30 offset:8192
    s_add_u32 s33, s29, 16384
    buffer_load_dwordx4 a[76:79], v10, s[4:7], s33 offen offset:3072 sc1
    v_mfma_f32_16x16x32_bf16 v[76:79], a[44:47], v[128:131], v[76:79]
    ds_read_b128 v[108:111], v30 offset:12288
    v_mfma_f32_16x16x32_bf16 v[80:83], a[44:47], v[132:135], v[80:83]
    ds_read_b128 v[112:115], v30 offset:16384
    s_waitcnt lgkmcnt(4)
    v_mfma_f32_16x16x32_bf16 v[64:67], a[48:51], v[96:99], v[64:67]
    ds_read_b128 v[116:119], v31 offset:0
    s_waitcnt lgkmcnt(4)
    v_mfma_f32_16x16x32_bf16 v[68:71], a[48:51], v[100:103], v[68:71]
    ds_read_b128 v[120:123], v31 offset:4096
    s_waitcnt lgkmcnt(4)
    v_mfma_f32_16x16x32_bf16 v[72:75], a[48:51], v[104:107], v[72:75]
    ds_read_b128 v[124:127], v31 offset:8192
    s_waitcnt lgkmcnt(4)
    v_mfma_f32_16x16x32_bf16 v[76:79], a[48:51], v[108:111], v[76:79]
    ds_read_b128 v[128:131], v31 offset:12288
    s_waitcnt lgkmcnt(4)
    v_mfma_f32_16x16x32_bf16 v[80:83], a[48:51], v[112:115], v[80:83]
    ds_read_b128 v[132:135], v31 offset:16384
    s_waitcnt vmcnt(11) lgkmcnt(4)
    v_mfma_f32_16x16x32_bf16 v[64:67], a[52:55], v[116:119], v[64:67]
    ds_read_b128 v[96:99], v32 offset:0
    s_waitcnt lgkmcnt(4)
    v_mfma_f32_16x16x32_bf16 v[68:71], a[52:55], v[120:123], v[68:71]
    ds_read_b128 v[100:103], v32 offset:4096
    s_waitcnt lgkmcnt(4)
    v_mfma_f32_16x16x32_bf16 v[72:75], a[52:55], v[124:127], v[72:75]
    ds_read_b128 v[104:107], v32 offset:8192
    s_waitcnt lgkmcnt(4)
    v_mfma_f32_16x16x32_bf16 v[76:79], a[52:55], v[128:131], v[76:79]
    ds_read_b128 v[108:111], v32 offset:12288
    s_waitcnt lgkmcnt(4)
    v_mfma_f32_16x16x32_bf16 v[80:83], a[52:55], v[132:135], v[80:83]
    ds_read_b128 v[112:115], v32 offset:16384
    s_waitcnt vmcnt(10) lgkmcnt(4)
    v_mfma_f32_16x16x32_bf16 v[64:67], a[56:59], v[96:99], v[64:67]
    ds_read_b128 v[116:119], v33 offset:0
    s_waitcnt lgkmcnt(4)
    v_mfma_f32_16x16x32_bf16 v[68:71], a[56:59], v[100:103], v[68:71]
    ds_read_b128 v[120:123], v33 offset:4096
    s_waitcnt lgkmcnt(4)
    v_mfma_f32_16x16x32_bf16 v[72:75], a[56:59], v[104:107], v[72:75]
    ds_read_b128 v[124:127], v33 offset:8192
    s_waitcnt lgkmcnt(4)
    v_mfma_f32_16x16x32_bf16 v[76:79], a[56:59], v[108:111], v[76:79]
    ds_read_b128 v[128:131], v33 offset:12288
    s_waitcnt lgkmcnt(4)
    v_mfma_f32_16x16x32_bf16 v[80:83], a[56:59], v[112:115], v[80:83]
    ds_read_b128 v[132:135], v33 offset:16384
    s_waitcnt lgkmcnt(0)
    s_waitcnt vmcnt(3)
    s_barrier
    v_mfma_f32_16x16x32_bf16 v[64:67], a[60:63], v[116:119], v[64:67]
    ds_read_b128 v[96:99], v30 offset:20480
    v_mfma_f32_16x16x32_bf16 v[68:71], a[60:63], v[120:123], v[68:71]
    ds_read_b128 v[100:103], v30 offset:24576
    v_mfma_f32_16x16x32_bf16 v[72:75], a[60:63], v[124:127], v[72:75]
    ds_read_b128 v[104:107], v30 offset:28672
    v_mfma_f32_16x16x32_bf16 v[76:79], a[60:63], v[128:131], v[76:79]
    ds_read_b128 v[108:111], v30 offset:32768
    v_mfma_f32_16x16x32_bf16 v[80:83], a[60:63], v[132:135], v[80:83]
    ds_read_b128 v[112:115], v30 offset:36864
    s_waitcnt lgkmcnt(4)
    v_mfma_f32_16x16x32_bf16 v[64:67], a[64:67], v[96:99], v[64:67]
    ds_read_b128 v[116:119], v31 offset:20480
    s_waitcnt lgkmcnt(4)
    v_mfma_f32_16x16x32_bf16 v[68:71], a[64:67], v[100:103], v[68:71]
    ds_read_b128 v[120:123], v31 offset:24576
    s_waitcnt lgkmcnt(4)
    v_mfma_f32_16x16x32_bf16 v[72:75], a[64:67], v[104:107], v[72:75]
    ds_read_b128 v[124:127], v31 offset:28672
    s_waitcnt lgkmcnt(4)
    v_mfma_f32_16x16x32_bf16 v[76:79], a[64:67], v[108:111], v[76:79]
    ds_read_b128 v[128:131], v31 offset:32768
    s_waitcnt lgkmcnt(4)
    v_mfma_f32_16x16x32_bf16 v[80:83], a[64:67], v[112:115], v[80:83]
    ds_read_b128 v[132:135], v31 offset:36864
    s_waitcnt vmcnt(2) lgkmcnt(4)
    v_mfma_f32_16x16x32_bf16 v[64:67], a[68:71], v[116:119], v[64:67]
    ds_read_b128 v[96:99], v32 offset:20480
    s_waitcnt lgkmcnt(4)
    v_mfma_f32_16x16x32_bf16 v[68:71], a[68:71], v[120:123], v[68:71]
    ds_read_b128 v[100:103], v32 offset:24576
    s_waitcnt lgkmcnt(4)
    v_mfma_f32_16x16x32_bf16 v[72:75], a[68:71], v[124:127], v[72:75]
    ds_read_b128 v[104:107], v32 offset:28672
    s_waitcnt lgkmcnt(4)
    v_mfma_f32_16x16x32_bf16 v[76:79], a[68:71], v[128:131], v[76:79]
    ds_read_b128 v[108:111], v32 offset:32768
    s_waitcnt lgkmcnt(4)
    v_mfma_f32_16x16x32_bf16 v[80:83], a[68:71], v[132:135], v[80:83]
    ds_read_b128 v[112:115], v32 offset:36864
    s_waitcnt vmcnt(1) lgkmcnt(4)
    v_mfma_f32_16x16x32_bf16 v[64:67], a[72:75], v[96:99], v[64:67]
    ds_read_b128 v[116:119], v33 offset:20480
    s_waitcnt lgkmcnt(4)
    v_mfma_f32_16x16x32_bf16 v[68:71], a[72:75], v[100:103], v[68:71]
    ds_read_b128 v[120:123], v33 offset:24576
    s_waitcnt lgkmcnt(4)
    v_mfma_f32_16x16x32_bf16 v[72:75], a[72:75], v[104:107], v[72:75]
    ds_read_b128 v[124:127], v33 offset:28672
    s_waitcnt lgkmcnt(4)
    v_mfma_f32_16x16x32_bf16 v[76:79], a[72:75], v[108:111], v[76:79]
    ds_read_b128 v[128:131], v33 offset:32768
    s_waitcnt lgkmcnt(4)
    v_mfma_f32_16x16x32_bf16 v[80:83], a[72:75], v[112:115], v[80:83]
    ds_read_b128 v[132:135], v33 offset:36864
    s_waitcnt vmcnt(0) lgkmcnt(4)
    v_mfma_f32_16x16x32_bf16 v[64:67], a[76:79], v[116:119], v[64:67]
    s_waitcnt lgkmcnt(3)
    v_mfma_f32_16x16x32_bf16 v[68:71], a[76:79], v[120:123], v[68:71]
    s_waitcnt lgkmcnt(2)
    v_mfma_f32_16x16x32_bf16 v[72:75], a[76:79], v[124:127], v[72:75]
    s_waitcnt lgkmcnt(1)
    v_mfma_f32_16x16x32_bf16 v[76:79], a[76:79], v[128:131], v[76:79]
    s_waitcnt lgkmcnt(0)
    v_mfma_f32_16x16x32_bf16 v[80:83], a[76:79], v[132:135], v[80:83]
    v_add_f32 v52, v52, v54
    v_add_f32 v53, v53, v55
    v_mov_b32 v3, v52
    s_nop 1
    v_permlane16_swap_b32 v52, v3
    v_add_f32 v52, v52, v3
    v_mov_b32 v3, v52
    s_nop 1
    v_permlane32_swap_b32 v52, v3
    v_add_f32 v52, v52, v3
    v_mov_b32 v3, v53
    s_nop 1
    v_permlane16_swap_b32 v53, v3
    v_add_f32 v53, v53, v3
    v_mov_b32 v3, v53
    s_nop 1
    v_permlane32_swap_b32 v53, v3
    v_add_f32 v53, v53, v3
    v_mul_f32 v52, 0x3acccccd, v52
    v_mul_f32 v53, 0x3acccccd, v53
    v_fma_f32 v53, -v52, v52, v53
    v_add_f32 v53, 0x3727c5ac, v53
    v_rsq_f32 v53, v53
    v_lshlrev_b32 v3, 4, v14
    v_add_u32 v4, 0, v3
    ds_bpermute_b32 v48, v4, v53
    v_add_u32 v4, 4, v3
    ds_bpermute_b32 v49, v4, v53
    v_add_u32 v4, 8, v3
    ds_bpermute_b32 v50, v4, v53
    v_add_u32 v4, 12, v3
    ds_bpermute_b32 v51, v4, v53
    s_waitcnt lgkmcnt(3)
    v_mul_f32 v64, v64, v48
    s_waitcnt lgkmcnt(2)
    v_mul_f32 v65, v65, v49
    s_waitcnt lgkmcnt(1)
    v_mul_f32 v66, v66, v50
    s_waitcnt lgkmcnt(0)
    v_mul_f32 v67, v67, v51
    v_cvt_pk_bf16_f32 v140, v64, v65
    v_cvt_pk_bf16_f32 v141, v66, v67
    v_mul_f32 v68, v68, v48
    v_mul_f32 v69, v69, v49
    v_mul_f32 v70, v70, v50
    v_mul_f32 v71, v71, v51
    v_cvt_pk_bf16_f32 v142, v68, v69
    v_cvt_pk_bf16_f32 v143, v70, v71
    v_mul_f32 v72, v72, v48
    v_mul_f32 v73, v73, v49
    v_mul_f32 v74, v74, v50
    v_mul_f32 v75, v75, v51
    v_cvt_pk_bf16_f32 v144, v72, v73
    v_cvt_pk_bf16_f32 v145, v74, v75
    v_mul_f32 v76, v76, v48
    v_mul_f32 v77, v77, v49
    v_mul_f32 v78, v78, v50
    v_mul_f32 v79, v79, v51
    v_cvt_pk_bf16_f32 v146, v76, v77
    v_cvt_pk_bf16_f32 v147, v78, v79
    v_mul_f32 v80, v80, v48
    v_mul_f32 v81, v81, v49
    v_mul_f32 v82, v82, v50
    v_mul_f32 v83, v83, v51
    v_cvt_pk_bf16_f32 v148, v80, v81
    v_cvt_pk_bf16_f32 v149, v82, v83
    v_mfma_f32_16x16x16_bf16 v[96:99], v[250:251], v[140:141], 0
    v_mfma_f32_16x16x16_bf16 v[116:119], v[252:253], v[140:141], 0
    v_mfma_f32_16x16x16_bf16 v[100:103], v[250:251], v[142:143], 0
    v_mfma_f32_16x16x16_bf16 v[120:123], v[252:253], v[142:143], 0
    v_mfma_f32_16x16x16_bf16 v[104:107], v[250:251], v[144:145], 0
    v_mfma_f32_16x16x16_bf16 v[124:127], v[252:253], v[144:145], 0
    v_mfma_f32_16x16x16_bf16 v[108:111], v[250:251], v[146:147], 0
    v_mfma_f32_16x16x16_bf16 v[128:131], v[252:253], v[146:147], 0
    v_mfma_f32_16x16x16_bf16 v[112:115], v[250:251], v[148:149], 0
    v_mfma_f32_16x16x16_bf16 v[132:135], v[252:253], v[148:149], 0
    v_fmac_f32_dpp v96, v116, v45 row_ror:8 row_mask:0xf bank_mask:0xf
    v_fmac_f32_dpp v97, v117, v45 row_ror:8 row_mask:0xf bank_mask:0xf
    v_fmac_f32_dpp v98, v118, v45 row_ror:8 row_mask:0xf bank_mask:0xf
    v_fmac_f32_dpp v99, v119, v45 row_ror:8 row_mask:0xf bank_mask:0xf
    v_cvt_pk_bf16_f32 v64, v96, v97
    ds_write_b16 v44, v64 offset:0
    ds_write_b16_d16_hi v44, v64 offset:640
    v_cvt_pk_bf16_f32 v65, v98, v99
    ds_write_b16 v44, v65 offset:1280
    ds_write_b16_d16_hi v44, v65 offset:1920
    v_fmac_f32_dpp v100, v120, v45 row_ror:8 row_mask:0xf bank_mask:0xf
    v_fmac_f32_dpp v101, v121, v45 row_ror:8 row_mask:0xf bank_mask:0xf
    v_fmac_f32_dpp v102, v122, v45 row_ror:8 row_mask:0xf bank_mask:0xf
    v_fmac_f32_dpp v103, v123, v45 row_ror:8 row_mask:0xf bank_mask:0xf
    v_cvt_pk_bf16_f32 v66, v100, v101
    ds_write_b16 v44, v66 offset:128
    ds_write_b16_d16_hi v44, v66 offset:768
    v_cvt_pk_bf16_f32 v67, v102, v103
    ds_write_b16 v44, v67 offset:1408
    ds_write_b16_d16_hi v44, v67 offset:2048
    v_fmac_f32_dpp v104, v124, v45 row_ror:8 row_mask:0xf bank_mask:0xf
    v_fmac_f32_dpp v105, v125, v45 row_ror:8 row_mask:0xf bank_mask:0xf
    v_fmac_f32_dpp v106, v126, v45 row_ror:8 row_mask:0xf bank_mask:0xf
    v_fmac_f32_dpp v107, v127, v45 row_ror:8 row_mask:0xf bank_mask:0xf
    v_cvt_pk_bf16_f32 v68, v104, v105
    ds_write_b16 v44, v68 offset:256
    ds_write_b16_d16_hi v44, v68 offset:896
    v_cvt_pk_bf16_f32 v69, v106, v107
    ds_write_b16 v44, v69 offset:1536
    ds_write_b16_d16_hi v44, v69 offset:2176
    v_fmac_f32_dpp v108, v128, v45 row_ror:8 row_mask:0xf bank_mask:0xf
    v_fmac_f32_dpp v109, v129, v45 row_ror:8 row_mask:0xf bank_mask:0xf
    v_fmac_f32_dpp v110, v130, v45 row_ror:8 row_mask:0xf bank_mask:0xf
    v_fmac_f32_dpp v111, v131, v45 row_ror:8 row_mask:0xf bank_mask:0xf
    v_cvt_pk_bf16_f32 v70, v108, v109
    ds_write_b16 v44, v70 offset:384
    ds_write_b16_d16_hi v44, v70 offset:1024
    v_cvt_pk_bf16_f32 v71, v110, v111
    ds_write_b16 v44, v71 offset:1664
    ds_write_b16_d16_hi v44, v71 offset:2304
    v_fmac_f32_dpp v112, v132, v45 row_ror:8 row_mask:0xf bank_mask:0xf
    v_fmac_f32_dpp v113, v133, v45 row_ror:8 row_mask:0xf bank_mask:0xf
    v_fmac_f32_dpp v114, v134, v45 row_ror:8 row_mask:0xf bank_mask:0xf
    v_fmac_f32_dpp v115, v135, v45 row_ror:8 row_mask:0xf bank_mask:0xf
    v_cvt_pk_bf16_f32 v72, v112, v113
    ds_write_b16 v44, v72 offset:512
    ds_write_b16_d16_hi v44, v72 offset:1152
    v_cvt_pk_bf16_f32 v73, v114, v115
    ds_write_b16 v44, v73 offset:1792
    ds_write_b16_d16_hi v44, v73 offset:2432
    s_waitcnt lgkmcnt(0)
    s_barrier
    ds_read_b128 v[74:77], v41
    ds_read_b128 v[78:81], v42
    ds_read_b128 v[82:85], v43
    s_waitcnt lgkmcnt(2)
    buffer_store_dwordx4 v[74:77], v38, s[4:7], s54 offen sc1
    s_waitcnt lgkmcnt(1)
    buffer_store_dwordx4 v[78:81], v39, s[4:7], s54 offen sc1
    s_waitcnt lgkmcnt(0)
    s_cmp_ge_u32 s20, 2
    s_cbranch_scc1 L51_zs
    buffer_store_dwordx4 v[82:85], v40, s[4:7], s54 offen sc1
L51_zs:
    s_mov_b32 s22, s70
    s_mov_b32 s23, s71
    s_mov_b32 s24, s72
    v_and_b32 v1, 15, v0
    v_lshrrev_b32 v2, 4, v0
    v_lshlrev_b32 v12, 4, v0
    s_sub_u32 s28, 16, s22
    s_and_b32 s28, s28, 15
    s_cmp_lt_u32 s24, 4
    s_cselect_b32 s28, s22, s28
    s_mul_i32 s29, s24, 80
    s_sub_u32 s30, 640, s29
    s_cmp_lt_u32 s24, 4
    s_cselect_b32 s29, s29, s30
    s_cselect_b32 s32, 16, -16
    s_lshl_b32 s31, s32, 4
    v_mul_lo_u32 v3, s32, v1
    v_mul_u32_u24 v4, 5120, v2
    v_add_u32 v3, v3, v4
    s_lshl_b32 s33, s29, 4
    v_add_u32 v10, s33, v3
    s_cmp_eq_u32 s24, 4
    s_cselect_b32 s33, 5120, 0
    v_cmp_eq_u32 vcc, 0, v1
    v_mov_b32 v5, s33
    s_nop 0
    v_cndmask_b32 v5, 0, v5, vcc
    v_sub_u32 v11, v10, v5
    s_mul_i32 s34, s28, 163840
    s_mul_i32 s35, s20, 40960
    s_add_u32 s34, s34, s35
    s_mul_i32 s35, s20, 10240
    s_lshl_b32 s38, s23, 2
    s_add_u32 s38, s38, s20
    s_waitcnt vmcnt(0)
    s_waitcnt vmcnt(0)
    s_barrier
    s_mul_i32 s61, s72, 256
    s_add_u32 s63, s61, 34404352
    s_add_u32 s61, s61, 34402304
    s_cmp_lg_u32 s20, 0
    s_cbranch_scc1 L53_ol
    s_mov_b64 exec, 1
    v_mov_b32 v254, 1
    v_mov_b32 v255, 0
    buffer_atomic_add v254, v255, s[4:7], s61 offen sc0 sc1
    s_mov_b64 exec, -1
L53_ol:
    s_cmp_lg_u32 s20, 0
    s_cbranch_scc1 L54_ol
    s_mov_b64 exec, 1
    s_waitcnt vmcnt(0)
    v_readfirstlane_b32 s62, v254
    s_nop 3
    s_cmp_lg_u32 s62, 31
    s_cbranch_scc1 L52_rel
    v_mov_b32 v254, 1
    v_mov_b32 v255, 0
    buffer_store_dword v254, v255, s[4:7], s63 offen sc1
L52_rel:
    s_mov_b64 exec, -1
L54_ol:
    v_and_b32 v48, 15, v0
    v_lshrrev_b32 v49, 4, v0
    s_lshl_b32 s55, s71, 2
    s_add_u32 s55, s55, s20
    s_lshl_b32 s55, s55, 4
    s_add_u32 s55, s55, s70
    v_lshl_add_u32 v48, v48, 7, s55
    v_lshrrev_b32 v50, 1, v49
    v_and_b32 v49, 1, v49
    v_lshl_add_u32 v49, v49, 6, v50
    s_cmp_lt_u32 s72, 4
    s_mov_b32 s56, 0x3a000000
    s_cselect_b32 s56, s56, 0xba000000
    v_cvt_f32_u32 v48, v48
    v_cvt_f32_u32 v49, v49
    v_mul_f32 v48, s56, v48
    v_mul_f32 v49, v48, v49
    v_add_f32 v50, v48, v48
    v_mul_f32 v48, 0x41800000, v48
    v_fract_f32 v51, v49
    v_add_f32 v52, v49, v48
    v_add_f32 v53, v52, v48
    v_add_f32 v54, v53, v48
    v_fract_f32 v52, v52
    v_fract_f32 v53, v53
    v_fract_f32 v54, v54
    v_add_f32 v49, v49, v50
    v_cos_f32 v55, v51
    v_cos_f32 v56, v52
    v_cos_f32 v57, v53
    v_cos_f32 v58, v54
    v_sin_f32 v51, v51
    v_sin_f32 v52, v52
    v_sin_f32 v53, v53
    v_sin_f32 v54, v54
    v_cvt_pk_bf16_f32 v55, v55, v56
    v_cvt_pk_bf16_f32 v56, v57, v58
    v_cvt_pk_bf16_f32 v51, v51, v52
    v_cvt_pk_bf16_f32 v52, v53, v54
    v_accvgpr_write_b32 a128, v55
    v_accvgpr_write_b32 a129, v56
    v_accvgpr_write_b32 a130, v51
    v_accvgpr_write_b32 a131, v52
    v_fract_f32 v51, v49
    v_add_f32 v52, v49, v48
    v_add_f32 v53, v52, v48
    v_add_f32 v54, v53, v48
    v_fract_f32 v52, v52
    v_fract_f32 v53, v53
    v_fract_f32 v54, v54
    v_add_f32 v49, v49, v50
    v_cos_f32 v55, v51
    v_cos_f32 v56, v52
    v_cos_f32 v57, v53
    v_cos_f32 v58, v54
    v_sin_f32 v51, v51
    v_sin_f32 v52, v52
    v_sin_f32 v53, v53
    v_sin_f32 v54, v54
    v_cvt_pk_bf16_f32 v55, v55, v56
    v_cvt_pk_bf16_f32 v56, v57, v58
    v_cvt_pk_bf16_f32 v51, v51, v52
    v_cvt_pk_bf16_f32 v52, v53, v54
    v_accvgpr_write_b32 a132, v55
    v_accvgpr_write_b32 a133, v56
    v_accvgpr_write_b32 a134, v51
    v_accvgpr_write_b32 a135, v52
    v_fract_f32 v51, v49
    v_add_f32 v52, v49, v48
    v_add_f32 v53, v52, v48
    v_add_f32 v54, v53, v48
    v_fract_f32 v52, v52
    v_fract_f32 v53, v53
    v_fract_f32 v54, v54
    v_add_f32 v49, v49, v50
    v_cos_f32 v55, v51
    v_cos_f32 v56, v52
    v_cos_f32 v57, v53
    v_cos_f32 v58, v54
    v_sin_f32 v51, v51
    v_sin_f32 v52, v52
    v_sin_f32 v53, v53
    v_sin_f32 v54, v54
    v_cvt_pk_bf16_f32 v55, v55, v56
    v_cvt_pk_bf16_f32 v56, v57, v58
    v_cvt_pk_bf16_f32 v51, v51, v52
    v_cvt_pk_bf16_f32 v52, v53, v54
    v_accvgpr_write_b32 a136, v55
    v_accvgpr_write_b32 a137, v56
    v_accvgpr_write_b32 a138, v51
    v_accvgpr_write_b32 a139, v52
    v_fract_f32 v51, v49
    v_add_f32 v52, v49, v48
    v_add_f32 v53, v52, v48
    v_add_f32 v54, v53, v48
    v_fract_f32 v52, v52
    v_fract_f32 v53, v53
    v_fract_f32 v54, v54
    v_add_f32 v49, v49, v50
    v_cos_f32 v55, v51
    v_cos_f32 v56, v52
    v_cos_f32 v57, v53
    v_cos_f32 v58, v54
    v_sin_f32 v51, v51
    v_sin_f32 v52, v52
    v_sin_f32 v53, v53
    v_sin_f32 v54, v54
    v_cvt_pk_bf16_f32 v55, v55, v56
    v_cvt_pk_bf16_f32 v56, v57, v58
    v_cvt_pk_bf16_f32 v51, v51, v52
    v_cvt_pk_bf16_f32 v52, v53, v54
    v_accvgpr_write_b32 a140, v55
    v_accvgpr_write_b32 a141, v56
    v_accvgpr_write_b32 a142, v51
    v_accvgpr_write_b32 a143, v52
    v_fract_f32 v51, v49
    v_add_f32 v52, v49, v48
    v_add_f32 v53, v52, v48
    v_add_f32 v54, v53, v48
    v_fract_f32 v52, v52
    v_fract_f32 v53, v53
    v_fract_f32 v54, v54
    v_add_f32 v49, v49, v50
    v_cos_f32 v55, v51
    v_cos_f32 v56, v52
    v_cos_f32 v57, v53
    v_cos_f32 v58, v54
    v_sin_f32 v51, v51
    v_sin_f32 v52, v52
    v_sin_f32 v53, v53
    v_sin_f32 v54, v54
    v_cvt_pk_bf16_f32 v55, v55, v56
    v_cvt_pk_bf16_f32 v56, v57, v58
    v_cvt_pk_bf16_f32 v51, v51, v52
    v_cvt_pk_bf16_f32 v52, v53, v54
    v_accvgpr_write_b32 a144, v55
    v_accvgpr_write_b32 a145, v56
    v_accvgpr_write_b32 a146, v51
    v_accvgpr_write_b32 a147, v52
    v_fract_f32 v51, v49
    v_add_f32 v52, v49, v48
    v_add_f32 v53, v52, v48
    v_add_f32 v54, v53, v48
    v_fract_f32 v52, v52
    v_fract_f32 v53, v53
    v_fract_f32 v54, v54
    v_add_f32 v49, v49, v50
    v_cos_f32 v55, v51
    v_cos_f32 v56, v52
    v_cos_f32 v57, v53
    v_cos_f32 v58, v54
    v_sin_f32 v51, v51
    v_sin_f32 v52, v52
    v_sin_f32 v53, v53
    v_sin_f32 v54, v54
    v_cvt_pk_bf16_f32 v55, v55, v56
    v_cvt_pk_bf16_f32 v56, v57, v58
    v_cvt_pk_bf16_f32 v51, v51, v52
    v_cvt_pk_bf16_f32 v52, v53, v54
    v_accvgpr_write_b32 a148, v55
    v_accvgpr_write_b32 a149, v56
    v_accvgpr_write_b32 a150, v51
    v_accvgpr_write_b32 a151, v52
    v_fract_f32 v51, v49
    v_add_f32 v52, v49, v48
    v_add_f32 v53, v52, v48
    v_add_f32 v54, v53, v48
    v_fract_f32 v52, v52
    v_fract_f32 v53, v53
    v_fract_f32 v54, v54
    v_add_f32 v49, v49, v50
    v_cos_f32 v55, v51
    v_cos_f32 v56, v52
    v_cos_f32 v57, v53
    v_cos_f32 v58, v54
    v_sin_f32 v51, v51
    v_sin_f32 v52, v52
    v_sin_f32 v53, v53
    v_sin_f32 v54, v54
    v_cvt_pk_bf16_f32 v55, v55, v56
    v_cvt_pk_bf16_f32 v56, v57, v58
    v_cvt_pk_bf16_f32 v51, v51, v52
    v_cvt_pk_bf16_f32 v52, v53, v54
    v_accvgpr_write_b32 a152, v55
    v_accvgpr_write_b32 a153, v56
    v_accvgpr_write_b32 a154, v51
    v_accvgpr_write_b32 a155, v52
    v_fract_f32 v51, v49
    v_add_f32 v52, v49, v48
    v_add_f32 v53, v52, v48
    v_add_f32 v54, v53, v48
    v_fract_f32 v52, v52
    v_fract_f32 v53, v53
    v_fract_f32 v54, v54
    v_cos_f32 v55, v51
    v_cos_f32 v56, v52
    v_cos_f32 v57, v53
    v_cos_f32 v58, v54
    v_sin_f32 v51, v51
    v_sin_f32 v52, v52
    v_sin_f32 v53, v53
    v_sin_f32 v54, v54
    v_cvt_pk_bf16_f32 v55, v55, v56
    v_cvt_pk_bf16_f32 v56, v57, v58
    v_cvt_pk_bf16_f32 v51, v51, v52
    v_cvt_pk_bf16_f32 v52, v53, v54
    v_accvgpr_write_b32 a156, v55
    v_accvgpr_write_b32 a157, v56
    v_accvgpr_write_b32 a158, v51
    v_accvgpr_write_b32 a159, v52
    s_lshl_b32 s50, s72, 1
    s_sub_u32 s51, 14, s50
    s_cmp_lt_u32 s72, 4
    s_cselect_b32 s52, s50, s51
    s_add_u32 s53, s52, 1
    s_add_u32 s54, s52, 2
    s_and_b32 s54, s54, 7
    s_cmp_lt_u32 s72, 4
    s_cselect_b32 s54, s52, s54
    s_cmp_eq_u32 s20, 0
    s_cbranch_scc1 L55_ct
    s_getpc_b64 s[58:59]
L56_cp:
    s_sub_u32 s60, s20, 1
    s_lshl_b32 s60, s60, 13
    v_lshlrev_b32 v222, 7, v0
    v_add_u32 v222, s60, v222
    s_mov_b32 s60, L_exit-L56_cp
    v_min_u32 v222, s60, v222
    v_mov_b32 v223, s59
    v_add_co_u32 v222, vcc, s58, v222
    s_nop 1
    v_addc_co_u32 v223, vcc, 0, v223, vcc
    global_load_dword v220, v[222:223], off
L55_ct:
    s_mov_b32 s61, 34404352
    s_cmp_lg_u32 s20, 0
    s_cbranch_scc1 L59_ws
    v_mov_b32 v255, s52
    v_mov_b32 v254, s53
    v_cmp_eq_u32 vcc, 1, v0
    s_nop 1
    v_cndmask_b32 v255, v255, v254, vcc
    v_mov_b32 v254, s54
    v_cmp_eq_u32 vcc, 2, v0
    s_nop 1
    v_cndmask_b32 v255, v255, v254, vcc
    v_mul_u32_u24 v255, 256, v255
    s_mov_b32 s62, 0
L57_w:
    buffer_load_dword v254, v255, s[4:7], s61 offen sc1
    s_waitcnt vmcnt(0)
    v_cmp_gt_u32 vcc, 1, v254
    s_add_u32 s62, s62, 1
    s_nop 1
    s_cmp_eq_u64 vcc, 0
    s_cbranch_scc1 L58_wd
    s_cmp_lt_u32 s62, 65536
    s_cbranch_scc1 L57_w
L58_wd:
L59_ws:
    s_barrier
    s_add_u32 s34, s34, 9342976
    s_mul_i32 s36, s31, 0
    s_add_u32 s36, s36, s34
    s_add_u32 m0, s35, 0
    s_nop 0
    buffer_load_dwordx4 v11, s[4:7], s36 offen sc1 lds
    s_mul_i32 s36, s31, 1
    s_add_u32 s36, s36, s34
    s_add_u32 m0, s35, 1024
    s_nop 0
    buffer_load_dwordx4 v10, s[4:7], s36 offen sc1 lds
    s_mul_i32 s36, s31, 2
    s_add_u32 s36, s36, s34
    s_add_u32 m0, s35, 2048
    s_nop 0
    buffer_load_dwordx4 v10, s[4:7], s36 offen sc1 lds
    s_mul_i32 s36, s31, 3
    s_add_u32 s36, s36, s34
    s_add_u32 m0, s35, 3072
    s_nop 0
    buffer_load_dwordx4 v10, s[4:7], s36 offen sc1 lds
    s_mul_i32 s36, s31, 4
    s_add_u32 s36, s36, s34
    s_add_u32 m0, s35, 4096
    s_nop 0
    buffer_load_dwordx4 v10, s[4:7], s36 offen sc1 lds
    s_mul_i32 s36, s31, 0
    s_add_u32 s36, s36, s34
    s_add_u32 s36, s36, 20480
    s_add_u32 m0, s35, 5120
    s_nop 0
    buffer_load_dwordx4 v11, s[4:7], s36 offen sc1 lds
    s_mul_i32 s36, s31, 1
    s_add_u32 s36, s36, s34
    s_add_u32 s36, s36, 20480
    s_add_u32 m0, s35, 6144
    s_nop 0
    buffer_load_dwordx4 v10, s[4:7], s36 offen sc1 lds
    s_mul_i32 s36, s31, 2
    s_add_u32 s36, s36, s34
    s_add_u32 s36, s36, 20480
    s_add_u32 m0, s35, 7168
    s_nop 0
    buffer_load_dwordx4 v10, s[4:7], s36 offen sc1 lds
    s_mul_i32 s36, s31, 3
    s_add_u32 s36, s36, s34
    s_add_u32 s36, s36, 20480
    s_add_u32 m0, s35, 8192
    s_nop 0
    buffer_load_dwordx4 v10, s[4:7], s36 offen sc1 lds
    s_mul_i32 s36, s31, 4
    s_add_u32 s36, s36, s34
    s_add_u32 s36, s36, 20480
    s_add_u32 m0, s35, 9216
    s_nop 0
    buffer_load_dwordx4 v10, s[4:7], s36 offen sc1 lds
    s_waitcnt vmcnt(0)
    s_barrier
    ds_read_b128 v[96:99], v12 offset:0
    ds_read_b128 v[100:103], v12 offset:1024
    ds_read_b128 v[104:107], v12 offset:2048
    ds_read_b128 v[108:111], v12 offset:3072
    ds_read_b128 v[112:115], v12 offset:4096
    s_waitcnt lgkmcnt(4)
    v_mfma_f32_16x16x32_bf16 v[64:67], v[96:99], a[128:131], 0
    ds_read_b128 v[116:119], v12 offset:5120
    s_waitcnt lgkmcnt(4)
    v_mfma_f32_16x16x32_bf16 v[68:71], v[100:103], a[128:131], 0
    ds_read_b128 v[120:123], v12 offset:6144
    s_waitcnt lgkmcnt(4)
    v_mfma_f32_16x16x32_bf16 v[72:75], v[104:107], a[128:131], 0
    ds_read_b128 v[124:127], v12 offset:7168
    s_waitcnt lgkmcnt(4)
    v_mfma_f32_16x16x32_bf16 v[76:79], v[108:111], a[128:131], 0
    ds_read_b128 v[128:131], v12 offset:8192
    s_waitcnt lgkmcnt(4)
    v_mfma_f32_16x16x32_bf16 v[80:83], v[112:115], a[128:131], 0
    ds_read_b128 v[132:135], v12 offset:9216
    s_waitcnt lgkmcnt(4)
    v_mfma_f32_16x16x32_bf16 v[64:67], v[116:119], a[132:135], v[64:67]
    ds_read_b128 v[96:99], v12 offset:10240
    s_waitcnt lgkmcnt(4)
    v_mfma_f32_16x16x32_bf16 v[68:71], v[120:123], a[132:135], v[68:71]
    ds_read_b128 v[100:103], v12 offset:11264
    s_waitcnt lgkmcnt(4)
    v_mfma_f32_16x16x32_bf16 v[72:75], v[124:127], a[132:135], v[72:75]
    ds_read_b128 v[104:107], v12 offset:12288
    s_waitcnt lgkmcnt(4)
    v_mfma_f32_16x16x32_bf16 v[76:79], v[128:131], a[132:135], v[76:79]
    ds_read_b128 v[108:111], v12 offset:13312
    s_waitcnt lgkmcnt(4)
    v_mfma_f32_16x16x32_bf16 v[80:83], v[132:135], a[132:135], v[80:83]
    ds_read_b128 v[112:115], v12 offset:14336
    s_waitcnt lgkmcnt(4)
    v_mfma_f32_16x16x32_bf16 v[64:67], v[96:99], a[136:139], v[64:67]
    ds_read_b128 v[116:119], v12 offset:15360
    s_waitcnt lgkmcnt(4)
    v_mfma_f32_16x16x32_bf16 v[68:71], v[100:103], a[136:139], v[68:71]
    ds_read_b128 v[120:123], v12 offset:16384
    s_waitcnt lgkmcnt(4)
    v_mfma_f32_16x16x32_bf16 v[72:75], v[104:107], a[136:139], v[72:75]
    ds_read_b128 v[124:127], v12 offset:17408
    s_waitcnt lgkmcnt(4)
    v_mfma_f32_16x16x32_bf16 v[76:79], v[108:111], a[136:139], v[76:79]
    ds_read_b128 v[128:131], v12 offset:18432
    s_waitcnt lgkmcnt(4)
    v_mfma_f32_16x16x32_bf16 v[80:83], v[112:115], a[136:139], v[80:83]
    ds_read_b128 v[132:135], v12 offset:19456
    s_waitcnt lgkmcnt(4)
    v_mfma_f32_16x16x32_bf16 v[64:67], v[116:119], a[140:143], v[64:67]
    ds_read_b128 v[96:99], v12 offset:20480
    s_waitcnt lgkmcnt(4)
    v_mfma_f32_16x16x32_bf16 v[68:71], v[120:123], a[140:143], v[68:71]
    ds_read_b128 v[100:103], v12 offset:21504
    s_waitcnt lgkmcnt(4)
    v_mfma_f32_16x16x32_bf16 v[72:75], v[124:127], a[140:143], v[72:75]
    ds_read_b128 v[104:107], v12 offset:22528
    s_waitcnt lgkmcnt(4)
    v_mfma_f32_16x16x32_bf16 v[76:79], v[128:131], a[140:143], v[76:79]
    ds_read_b128 v[108:111], v12 offset:23552
    s_waitcnt lgkmcnt(4)
    v_mfma_f32_16x16x32_bf16 v[80:83], v[132:135], a[140:143], v[80:83]
    ds_read_b128 v[112:115], v12 offset:24576
    s_waitcnt lgkmcnt(4)
    v_mfma_f32_16x16x32_bf16 v[64:67], v[96:99], a[144:147], v[64:67]
    ds_read_b128 v[116:119], v12 offset:25600
    s_waitcnt lgkmcnt(4)
    v_mfma_f32_16x16x32_bf16 v[68:71], v[100:103], a[144:147], v[68:71]
    ds_read_b128 v[120:123], v12 offset:26624
    s_waitcnt lgkmcnt(4)
    v_mfma_f32_16x16x32_bf16 v[72:75], v[104:107], a[144:147], v[72:75]
    ds_read_b128 v[124:127], v12 offset:27648
    s_waitcnt lgkmcnt(4)
    v_mfma_f32_16x16x32_bf16 v[76:79], v[108:111], a[144:147], v[76:79]
    ds_read_b128 v[128:131], v12 offset:28672
    s_waitcnt lgkmcnt(4)
    v_mfma_f32_16x16x32_bf16 v[80:83], v[112:115], a[144:147], v[80:83]
    ds_read_b128 v[132:135], v12 offset:29696
    s_waitcnt lgkmcnt(4)
    v_mfma_f32_16x16x32_bf16 v[64:67], v[116:119], a[148:151], v[64:67]
    ds_read_b128 v[96:99], v12 offset:30720
    s_waitcnt lgkmcnt(4)
    v_mfma_f32_16x16x32_bf16 v[68:71], v[120:123], a[148:151], v[68:71]
    ds_read_b128 v[100:103], v12 offset:31744
    s_waitcnt lgkmcnt(4)
    v_mfma_f32_16x16x32_bf16 v[72:75], v[124:127], a[148:151], v[72:75]
    ds_read_b128 v[104:107], v12 offset:32768
    s_waitcnt lgkmcnt(4)
    v_mfma_f32_16x16x32_bf16 v[76:79], v[128:131], a[148:151], v[76:79]
    ds_read_b128 v[108:111], v12 offset:33792
    s_waitcnt lgkmcnt(4)
    v_mfma_f32_16x16x32_bf16 v[80:83], v[132:135], a[148:151], v[80:83]
    ds_read_b128 v[112:115], v12 offset:34816
    s_waitcnt lgkmcnt(4)
    v_mfma_f32_16x16x32_bf16 v[64:67], v[96:99], a[152:155], v[64:67]
    ds_read_b128 v[116:119], v12 offset:35840
    s_waitcnt lgkmcnt(4)
    v_mfma_f32_16x16x32_bf16 v[68:71], v[100:103], a[152:155], v[68:71]
    ds_read_b128 v[120:123], v12 offset:36864
    s_waitcnt lgkmcnt(4)
    v_mfma_f32_16x16x32_bf16 v[72:75], v[104:107], a[152:155], v[72:75]
    ds_read_b128 v[124:127], v12 offset:37888
    s_waitcnt lgkmcnt(4)
    v_mfma_f32_16x16x32_bf16 v[76:79], v[108:111], a[152:155], v[76:79]
    ds_read_b128 v[128:131], v12 offset:38912
    s_waitcnt lgkmcnt(4)
    v_mfma_f32_16x16x32_bf16 v[80:83], v[112:115], a[152:155], v[80:83]
    ds_read_b128 v[132:135], v12 offset:39936
    s_waitcnt lgkmcnt(4)
    v_mfma_f32_16x16x32_bf16 v[64:67], v[116:119], a[156:159], v[64:67]
    s_waitcnt lgkmcnt(3)
    v_mfma_f32_16x16x32_bf16 v[68:71], v[120:123], a[156:159], v[68:71]
    s_waitcnt lgkmcnt(2)
    v_mfma_f32_16x16x32_bf16 v[72:75], v[124:127], a[156:159], v[72:75]
    s_waitcnt lgkmcnt(1)
    v_mfma_f32_16x16x32_bf16 v[76:79], v[128:131], a[156:159], v[76:79]
    s_waitcnt lgkmcnt(0)
    v_mfma_f32_16x16x32_bf16 v[80:83], v[132:135], a[156:159], v[80:83]
    s_cmp_eq_u32 s72, 0
    s_cselect_b32 s40, 0, 1
    v_mov_b32 v6, 0
    v_or_b32 v5, s40, v2
    v_cmp_eq_u32 vcc, 0, v5
    s_nop 1
    v_cndmask_b32 v64, v64, v6, vcc
    v_lshrrev_b32 v3, 1, v2
    v_and_b32 v4, 1, v2
    v_lshlrev_b32 v5, 4, v1
    v_lshl_add_u32 v5, v3, 8, v5
    v_lshl_add_u32 v13, v4, 3, v5
    s_lshl_b32 s38, s71, 2
    s_add_u32 s38, s38, s20
    s_mul_i32 s36, s70, 163840
    s_mul_i32 s37, s38, 20480
    s_add_u32 s36, s36, s37
    s_mul_i32 s37, s72, 2560
    s_add_u32 s36, s36, s37
    s_add_u32 s36, s36, 14585856
    v_lshlrev_b32 v14, 16, v240
    v_and_b32 v15, 0xffff0000, v240
    v_lshlrev_b32 v6, 16, v241
    v_and_b32 v7, 0xffff0000, v241
    v_pk_add_f32 v[64:65], v[64:65], v[14:15]
    v_pk_add_f32 v[66:67], v[66:67], v[6:7]
    v_cvt_pk_bf16_f32 v240, v64, v65
    v_cvt_pk_bf16_f32 v241, v66, v67
    buffer_store_dwordx2 v[240:241], v13, s[4:7], s36 offen offset:0 sc1
    v_lshlrev_b32 v14, 16, v242
    v_and_b32 v15, 0xffff0000, v242
    v_lshlrev_b32 v6, 16, v243
    v_and_b32 v7, 0xffff0000, v243
    v_pk_add_f32 v[68:69], v[68:69], v[14:15]
    v_pk_add_f32 v[70:71], v[70:71], v[6:7]
    v_cvt_pk_bf16_f32 v242, v68, v69
    v_cvt_pk_bf16_f32 v243, v70, v71
    buffer_store_dwordx2 v[242:243], v13, s[4:7], s36 offen offset:512 sc1
    v_lshlrev_b32 v14, 16, v244
    v_and_b32 v15, 0xffff0000, v244
    v_lshlrev_b32 v6, 16, v245
    v_and_b32 v7, 0xffff0000, v245
    v_pk_add_f32 v[72:73], v[72:73], v[14:15]
    v_pk_add_f32 v[74:75], v[74:75], v[6:7]
    v_cvt_pk_bf16_f32 v244, v72, v73
    v_cvt_pk_bf16_f32 v245, v74, v75
    buffer_store_dwordx2 v[244:245], v13, s[4:7], s36 offen offset:1024 sc1
    v_lshlrev_b32 v14, 16, v246
    v_and_b32 v15, 0xffff0000, v246
    v_lshlrev_b32 v6, 16, v247
    v_and_b32 v7, 0xffff0000, v247
    v_pk_add_f32 v[76:77], v[76:77], v[14:15]
    v_pk_add_f32 v[78:79], v[78:79], v[6:7]
    v_cvt_pk_bf16_f32 v246, v76, v77
    v_cvt_pk_bf16_f32 v247, v78, v79
    buffer_store_dwordx2 v[246:247], v13, s[4:7], s36 offen offset:1536 sc1
    v_lshlrev_b32 v14, 16, v248
    v_and_b32 v15, 0xffff0000, v248
    v_lshlrev_b32 v6, 16, v249
    v_and_b32 v7, 0xffff0000, v249
    v_pk_add_f32 v[80:81], v[80:81], v[14:15]
    v_pk_add_f32 v[82:83], v[82:83], v[6:7]
    v_cvt_pk_bf16_f32 v248, v80, v81
    v_cvt_pk_bf16_f32 v249, v82, v83
    buffer_store_dwordx2 v[248:249], v13, s[4:7], s36 offen offset:2048 sc1
    v_pk_mul_f32 v[52:53], v[64:65], v[64:65]
    v_pk_add_f32 v[50:51], v[64:65], v[66:67]
    v_pk_fma_f32 v[52:53], v[66:67], v[66:67], v[52:53]
    v_pk_fma_f32 v[52:53], v[68:69], v[68:69], v[52:53]
    v_pk_add_f32 v[50:51], v[50:51], v[68:69]
    v_pk_fma_f32 v[52:53], v[70:71], v[70:71], v[52:53]
    v_pk_add_f32 v[50:51], v[50:51], v[70:71]
    v_pk_fma_f32 v[52:53], v[72:73], v[72:73], v[52:53]
    v_pk_add_f32 v[50:51], v[50:51], v[72:73]
    v_pk_fma_f32 v[52:53], v[74:75], v[74:75], v[52:53]
    v_pk_add_f32 v[50:51], v[50:51], v[74:75]
    v_pk_fma_f32 v[52:53], v[76:77], v[76:77], v[52:53]
    v_pk_add_f32 v[50:51], v[50:51], v[76:77]
    v_pk_fma_f32 v[52:53], v[78:79], v[78:79], v[52:53]
    v_pk_add_f32 v[50:51], v[50:51], v[78:79]
    v_pk_fma_f32 v[52:53], v[80:81], v[80:81], v[52:53]
    v_pk_add_f32 v[50:51], v[50:51], v[80:81]
    v_pk_fma_f32 v[52:53], v[82:83], v[82:83], v[52:53]
    v_pk_add_f32 v[50:51], v[50:51], v[82:83]
    v_add_f32 v48, v50, v51
    v_add_f32 v49, v52, v53
    v_mov_b32 v3, v48
    s_nop 1
    v_permlane16_swap_b32 v48, v3
    v_add_f32 v48, v48, v3
    v_mov_b32 v3, v48
    s_nop 1
    v_permlane32_swap_b32 v48, v3
    v_add_f32 v48, v48, v3
    v_mov_b32 v3, v49
    s_nop 1
    v_permlane16_swap_b32 v49, v3
    v_add_f32 v49, v49, v3
    v_mov_b32 v3, v49
    s_nop 1
    v_permlane32_swap_b32 v49, v3
    v_add_f32 v49, v49, v3
    s_lshl_b32 s36, s70, 13
    s_lshr_b32 s37, s72, 1
    s_lshl_b32 s37, s37, 11
    s_add_u32 s36, s36, s37
    s_lshl_b32 s37, s38, 8
    s_add_u32 s36, s36, s37
    s_and_b32 s37, s72, 1
    s_lshl_b32 s37, s37, 3
    s_add_u32 s36, s36, s37
    s_add_u32 s36, s36, 17338368
    v_lshlrev_b32 v5, 4, v1
    buffer_store_dwordx2 v[48:49], v5, s[4:7], s36 offen sc1
    s_mul_i32 s44, s20, 7
    s_mul_i32 s46, s20, 3
    s_add_u32 s46, s46, 21
    s_lshl_b32 s101, s20, 2
    s_add_u32 s101, s101, 30
    s_cmp_eq_u32 s20, 3
    s_cselect_b32 s45, 1, 0
    s_sub_u32 s101, s101, s45
    s_mul_i32 s45, s72, 54
    s_add_u32 s44, s44, s45
    s_mul_i32 s44, s44, 5120
    s_add_u32 s44, s44, 4423680
    s_add_u32 s46, s46, s45
    s_mul_i32 s46, s46, 5120
    s_add_u32 s46, s46, 4423680
    s_add_u32 s101, s101, s45
    s_mul_i32 s101, s101, 5120
    s_add_u32 s101, s101, 4423680
    s_mul_i32 s100, s20, 22528
    s_add_u32 s100, s100, 71680
    s_mov_b32 s22, s73
    s_mov_b32 s23, s74
    s_mov_b32 s24, s75
    v_lshlrev_b32 v11, 4, v0
    s_mul_i32 s30, s24, 40960
    s_lshl_b32 s29, s20, 10
    s_add_u32 s30, s30, s29
    s_add_u32 s30, s30, 0
    s_mul_i32 s33, s20, 1024
    s_mul_i32 s34, s20, 2048
    s_mul_i32 s35, s20, 3072
    s_mul_i32 s36, s20, 4096
    v_and_b32 v1, 31, v0
    v_lshrrev_b32 v2, 5, v0
    v_lshrrev_b32 v3, 4, v1
    v_and_b32 v4, 15, v0
    v_lshlrev_b32 v5, 4, v4
    v_lshl_add_u32 v5, v2, 8, v5
    v_mul_u32_u24 v6, 20480, v3
    v_add_u32 v10, v6, v5
    v_lshl_add_u32 v12, v3, 10, v5
    v_lshlrev_b32 v13, 4, v2
    v_add_u32 v13, 65536, v13
    v_add_u32 v14, 0x10000, v11
    s_mul_i32 s28, s22, 163840
    s_mul_i32 s29, s20, 40960
    s_add_u32 s28, s28, s29
    s_add_u32 s28, s28, 14585856
    s_mul_i32 s31, s22, 442368
    s_lshr_b32 s29, s20, 1
    s_mul_i32 s29, s29, 221184
    s_add_u32 s31, s31, s29
    s_and_b32 s29, s20, 1
    s_lshl_b32 s29, s29, 11
    s_add_u32 s31, s31, s29
    s_add_u32 s31, s31, 24547328
    s_lshl_b32 s40, s23, 2
    s_add_u32 s40, s40, 0
    s_add_u32 s41, s24, 0
    s_cmp_ge_u32 s41, 98
    s_cselect_b32 s40, s41, s40
    s_lshr_b32 s41, s40, 1
    s_lshl_b32 s41, s41, 12
    s_and_b32 s40, s40, 1
    s_lshl_b32 s40, s40, 9
    s_add_u32 s40, s40, s41
    s_add_u32 s47, s40, s31
    s_lshl_b32 s40, s23, 2
    s_add_u32 s40, s40, 1
    s_add_u32 s41, s24, 1
    s_cmp_ge_u32 s41, 98
    s_cselect_b32 s40, s41, s40
    s_lshr_b32 s41, s40, 1
    s_lshl_b32 s41, s41, 12
    s_and_b32 s40, s40, 1
    s_lshl_b32 s40, s40, 9
    s_add_u32 s40, s40, s41
    s_add_u32 s48, s40, s31
    s_lshl_b32 s40, s23, 2
    s_add_u32 s40, s40, 2
    s_add_u32 s41, s24, 2
    s_cmp_ge_u32 s41, 98
    s_cselect_b32 s40, s41, s40
    s_lshr_b32 s41, s40, 1
    s_lshl_b32 s41, s41, 12
    s_and_b32 s40, s40, 1
    s_lshl_b32 s40, s40, 9
    s_add_u32 s40, s40, s41
    s_add_u32 s49, s40, s31
    s_lshl_b32 s40, s23, 2
    s_add_u32 s40, s40, 3
    s_add_u32 s41, s24, 3
    s_cmp_ge_u32 s41, 98
    s_cselect_b32 s40, s41, s40
    s_lshr_b32 s41, s40, 1
    s_lshl_b32 s41, s41, 12
    s_and_b32 s40, s40, 1
    s_lshl_b32 s40, s40, 9
    s_add_u32 s40, s40, s41
    s_add_u32 s66, s40, s31
    s_lshl_b32 s41, s23, 1
    s_add_u32 s40, s41, 56
    s_add_u32 s50, s41, 62
    s_cmp_ge_u32 s23, 13
    s_cselect_b32 s40, s50, s40
    s_add_u32 s41, s24, 4
    s_cmp_ge_u32 s41, 98
    s_cselect_b32 s40, s41, s40
    s_lshr_b32 s41, s40, 1
    s_lshl_b32 s41, s41, 12
    s_and_b32 s40, s40, 1
    s_lshl_b32 s40, s40, 9
    s_add_u32 s40, s40, s41
    s_add_u32 s67, s40, s31
    s_lshl_b32 s41, s23, 1
    s_add_u32 s40, s41, 57
    s_add_u32 s50, s41, 63
    s_cmp_ge_u32 s23, 13
    s_cselect_b32 s40, s50, s40
    s_add_u32 s41, s24, 5
    s_cmp_ge_u32 s41, 98
    s_cselect_b32 s40, s41, s40
    s_lshr_b32 s41, s40, 1
    s_lshl_b32 s41, s41, 12
    s_and_b32 s40, s40, 1
    s_lshl_b32 s40, s40, 9
    s_add_u32 s40, s40, s41
    s_add_u32 s68, s40, s31
    s_add_u32 s40, s23, 82
    s_add_u32 s50, s23, 84
    s_cmp_ge_u32 s23, 6
    s_cselect_b32 s40, s50, s40
    s_add_u32 s41, s24, 6
    s_cmp_ge_u32 s41, 98
    s_cselect_b32 s40, s41, s40
    s_lshr_b32 s41, s40, 1
    s_lshl_b32 s41, s41, 12
    s_and_b32 s40, s40, 1
    s_lshl_b32 s40, s40, 9
    s_add_u32 s40, s40, s41
    s_add_u32 s69, s40, s31
    v_lshlrev_b32 v7, 4, v1
    v_lshl_add_u32 v7, v2, 12, v7
    s_lshl_b32 s42, s22, 13
    s_lshl_b32 s37, s20, 9
    s_add_u32 s42, s42, s37
    s_add_u32 s42, s42, 17338368
    s_lshl_b32 s37, s20, 8
    v_lshlrev_b32 v8, 2, v0
    v_add_u32 v8, s37, v8
    s_lshl_b32 s43, s24, 7
    s_add_u32 s43, s43, 6635520
    s_waitcnt vmcnt(0)
    s_waitcnt vmcnt(0)
    s_barrier
    s_lshl_b32 s61, s70, 8
    s_add_u32 s61, s61, 34381824
    s_cmp_lg_u32 s20, 0
    s_cbranch_scc1 L60_ol
    s_mov_b64 exec, 1
    v_mov_b32 v254, 1
    v_mov_b32 v255, 0
    buffer_atomic_add v254, v255, s[4:7], s61 offen sc1
    s_mov_b64 exec, -1
L60_ol:
    s_cmp_eq_u32 s20, 0
    s_cbranch_scc1 L61_ct
    s_getpc_b64 s[58:59]
L62_cp:
    s_sub_u32 s60, s20, 1
    s_lshl_b32 s60, s60, 13
    v_lshlrev_b32 v222, 7, v0
    v_add_u32 v222, s60, v222
    s_mov_b32 s60, L_exit-L62_cp
    v_min_u32 v222, s60, v222
    v_mov_b32 v223, s59
    v_add_co_u32 v222, vcc, s58, v222
    s_nop 1
    v_addc_co_u32 v223, vcc, 0, v223, vcc
    global_load_dword v220, v[222:223], off
L61_ct:
    s_cmp_eq_u32 s20, 0
    s_cbranch_scc1 L66_pb
    s_add_u32 m0, s36, 0
    s_add_u32 s38, s30, 0
    buffer_load_dwordx4 v11, s[4:7], s38 offen sc1 lds
    s_add_u32 m0, s36, 1024
    s_add_u32 s38, s30, 40960
    buffer_load_dwordx4 v11, s[4:7], s38 offen sc1 lds
    s_add_u32 m0, s36, 2048
    s_add_u32 s38, s30, 81920
    buffer_load_dwordx4 v11, s[4:7], s38 offen sc1 lds
    s_add_u32 m0, s36, 3072
    s_add_u32 s38, s30, 122880
    buffer_load_dwordx4 v11, s[4:7], s38 offen sc1 lds
    s_add_u32 m0, s36, 16384
    s_add_u32 s38, s30, 4096
    buffer_load_dwordx4 v11, s[4:7], s38 offen sc1 lds
    s_add_u32 m0, s36, 17408
    s_add_u32 s38, s30, 45056
    buffer_load_dwordx4 v11, s[4:7], s38 offen sc1 lds
    s_add_u32 m0, s36, 18432
    s_add_u32 s38, s30, 86016
    buffer_load_dwordx4 v11, s[4:7], s38 offen sc1 lds
    s_add_u32 m0, s36, 19456
    s_add_u32 s38, s30, 126976
    buffer_load_dwordx4 v11, s[4:7], s38 offen sc1 lds
L66_pb:
    s_lshl_b32 s61, s73, 8
    s_add_u32 s61, s61, 34381824
    s_cmp_lg_u32 s20, 0
    s_cbranch_scc1 L65_ws
    v_mov_b32 v255, 0
    s_mov_b32 s62, 0
L63_w:
    buffer_load_dword v254, v255, s[4:7], s61 offen sc1
    s_waitcnt vmcnt(0)
    v_cmp_gt_u32 vcc, 16, v254
    s_add_u32 s62, s62, 1
    s_nop 1
    s_cmp_eq_u64 vcc, 0
    s_cbranch_scc1 L64_wd
    s_cmp_lt_u32 s62, 65536
    s_cbranch_scc1 L63_w
L64_wd:
L65_ws:
    s_barrier
    s_cmp_lg_u32 s20, 0
    s_cbranch_scc1 L67_pb
    s_add_u32 m0, s36, 0
    s_add_u32 s38, s30, 0
    s_nop 0
    buffer_load_dwordx4 v11, s[4:7], s38 offen sc1 lds
    s_add_u32 m0, s36, 1024
    s_add_u32 s38, s30, 40960
    s_nop 0
    buffer_load_dwordx4 v11, s[4:7], s38 offen sc1 lds
    s_add_u32 m0, s36, 2048
    s_add_u32 s38, s30, 81920
    s_nop 0
    buffer_load_dwordx4 v11, s[4:7], s38 offen sc1 lds
    s_add_u32 m0, s36, 3072
    s_add_u32 s38, s30, 122880
    s_nop 0
    buffer_load_dwordx4 v11, s[4:7], s38 offen sc1 lds
    s_add_u32 m0, s36, 16384
    s_add_u32 s38, s30, 4096
    s_nop 0
    buffer_load_dwordx4 v11, s[4:7], s38 offen sc1 lds
    s_add_u32 m0, s36, 17408
    s_add_u32 s38, s30, 45056
    s_nop 0
    buffer_load_dwordx4 v11, s[4:7], s38 offen sc1 lds
    s_add_u32 m0, s36, 18432
    s_add_u32 s38, s30, 86016
    s_nop 0
    buffer_load_dwordx4 v11, s[4:7], s38 offen sc1 lds
    s_add_u32 m0, s36, 19456
    s_add_u32 s38, s30, 126976
    s_nop 0
    buffer_load_dwordx4 v11, s[4:7], s38 offen sc1 lds
L67_pb:
    s_add_u32 s39, s28, 0
    buffer_load_dwordx4 a[0:3], v10, s[4:7], s39 offen offset:0 sc1
    s_add_u32 s39, s28, 0
    buffer_load_dwordx4 a[4:7], v10, s[4:7], s39 offen offset:512 sc1
    s_add_u32 s39, s28, 0
    buffer_load_dwordx4 a[8:11], v10, s[4:7], s39 offen offset:1024 sc1
    s_add_u32 s39, s28, 0
    buffer_load_dwordx4 a[12:15], v10, s[4:7], s39 offen offset:1536 sc1
    buffer_load_dwordx4 v[48:51], v7, s[4:7], s42 offen sc1
    buffer_load_dwordx4 v[52:55], v7, s[4:7], s42 offen offset:2048 sc1
    s_add_u32 s39, s28, 0
    buffer_load_dwordx4 a[16:19], v10, s[4:7], s39 offen offset:2048 sc1
    s_add_u32 s39, s28, 0
    buffer_load_dwordx4 a[20:23], v10, s[4:7], s39 offen offset:2560 sc1
    s_add_u32 s39, s28, 0
    buffer_load_dwordx4 a[24:27], v10, s[4:7], s39 offen offset:3072 sc1
    s_add_u32 s39, s28, 0
    buffer_load_dwordx4 a[28:31], v10, s[4:7], s39 offen offset:3584 sc1
    buffer_load_dword v59, v8, s[4:7], s43 offen sc1
    s_add_u32 s43, s43, 13824
    buffer_load_dword v60, v8, s[4:7], s43 offen sc1
    s_add_u32 s43, s43, 13824
    buffer_load_dword v61, v8, s[4:7], s43 offen sc1
    s_add_u32 s43, s43, 13824
    buffer_load_dword v62, v8, s[4:7], s43 offen sc1
    s_add_u32 s43, s43, 13824
    buffer_load_dword v63, v8, s[4:7], s43 offen sc1
    s_waitcnt vmcnt(19)
    s_barrier
    ds_read_b128 v[32:35], v11 offset:0
    ds_read_b128 v[36:39], v11 offset:1024
    ds_read_b128 v[40:43], v11 offset:2048
    s_waitcnt vmcnt(14) lgkmcnt(2)
    v_mfma_f32_32x32x16_bf16 v[64:79], v[32:35], a[0:3], 0
    ds_read_b128 v[44:47], v11 offset:3072
    s_add_u32 m0, s36, 32768
    s_add_u32 s38, s30, 8192
    buffer_load_dwordx4 v11, s[4:7], s38 offen sc1 lds
    s_waitcnt lgkmcnt(2)
    v_mfma_f32_32x32x16_bf16 v[80:95], v[36:39], a[0:3], 0
    ds_read_b128 v[32:35], v11 offset:4096
    s_waitcnt lgkmcnt(2)
    v_mfma_f32_32x32x16_bf16 v[96:111], v[40:43], a[0:3], 0
    ds_read_b128 v[36:39], v11 offset:5120
    s_add_u32 m0, s36, 33792
    s_add_u32 s38, s30, 49152
    buffer_load_dwordx4 v11, s[4:7], s38 offen sc1 lds
    s_waitcnt lgkmcnt(2)
    v_mfma_f32_32x32x16_bf16 v[112:127], v[44:47], a[0:3], 0
    ds_read_b128 v[40:43], v11 offset:6144
    s_waitcnt vmcnt(15) lgkmcnt(2)
    v_mfma_f32_32x32x16_bf16 v[64:79], v[32:35], a[4:7], v[64:79]
    ds_read_b128 v[44:47], v11 offset:7168
    s_add_u32 m0, s36, 34816
    s_add_u32 s38, s30, 90112
    buffer_load_dwordx4 v11, s[4:7], s38 offen sc1 lds
    s_waitcnt lgkmcnt(2)
    v_mfma_f32_32x32x16_bf16 v[80:95], v[36:39], a[4:7], v[80:95]
    ds_read_b128 v[32:35], v11 offset:8192
    s_waitcnt lgkmcnt(2)
    v_mfma_f32_32x32x16_bf16 v[96:111], v[40:43], a[4:7], v[96:111]
    ds_read_b128 v[36:39], v11 offset:9216
    s_add_u32 m0, s36, 35840
    s_add_u32 s38, s30, 131072
    buffer_load_dwordx4 v11, s[4:7], s38 offen sc1 lds
    s_waitcnt lgkmcnt(2)
    v_mfma_f32_32x32x16_bf16 v[112:127], v[44:47], a[4:7], v[112:127]
    ds_read_b128 v[40:43], v11 offset:10240
    s_waitcnt vmcnt(16) lgkmcnt(2)
    v_mfma_f32_32x32x16_bf16 v[64:79], v[32:35], a[8:11], v[64:79]
    ds_read_b128 v[44:47], v11 offset:11264
    s_add_u32 s39, s28, 4096
    buffer_load_dwordx4 a[32:35], v10, s[4:7], s39 offen offset:0 sc1
    s_waitcnt lgkmcnt(2)
    v_mfma_f32_32x32x16_bf16 v[80:95], v[36:39], a[8:11], v[80:95]
    ds_read_b128 v[32:35], v11 offset:12288
    s_waitcnt lgkmcnt(2)
    v_mfma_f32_32x32x16_bf16 v[96:111], v[40:43], a[8:11], v[96:111]
    ds_read_b128 v[36:39], v11 offset:13312
    s_add_u32 s39, s28, 4096
    buffer_load_dwordx4 a[36:39], v10, s[4:7], s39 offen offset:512 sc1
    s_waitcnt lgkmcnt(2)
    v_mfma_f32_32x32x16_bf16 v[112:127], v[44:47], a[8:11], v[112:127]
    ds_read_b128 v[40:43], v11 offset:14336
    s_waitcnt vmcnt(17) lgkmcnt(2)
    v_mfma_f32_32x32x16_bf16 v[64:79], v[32:35], a[12:15], v[64:79]
    ds_read_b128 v[44:47], v11 offset:15360
    s_add_u32 s39, s28, 4096
    buffer_load_dwordx4 a[40:43], v10, s[4:7], s39 offen offset:1024 sc1
    s_waitcnt lgkmcnt(2)
    v_mfma_f32_32x32x16_bf16 v[80:95], v[36:39], a[12:15], v[80:95]
    s_waitcnt vmcnt(10)
    v_add_f32 v59, v59, v60
    s_waitcnt vmcnt(8)
    v_add_f32 v61, v61, v62
    s_waitcnt vmcnt(7)
    v_add_f32 v59, v59, v63
    v_add_f32 v59, v59, v61
    v_add_u32 v8, 65536, v8
    ds_write_b32 v8, v59
    s_waitcnt lgkmcnt(0)
    s_barrier
    ds_read_b128 v[32:35], v11 offset:16384
    v_mfma_f32_32x32x16_bf16 v[96:111], v[40:43], a[12:15], v[96:111]
    ds_read_b128 v[36:39], v11 offset:17408
    s_add_u32 s39, s28, 4096
    buffer_load_dwordx4 a[44:47], v10, s[4:7], s39 offen offset:1536 sc1
    v_mfma_f32_32x32x16_bf16 v[112:127], v[44:47], a[12:15], v[112:127]
    ds_read_b128 v[40:43], v11 offset:18432
    s_waitcnt lgkmcnt(2)
    v_mfma_f32_32x32x16_bf16 v[64:79], v[32:35], a[16:19], v[64:79]
    ds_read_b128 v[44:47], v11 offset:19456
    s_add_u32 m0, s36, 49152
    s_add_u32 s38, s30, 12288
    buffer_load_dwordx4 v11, s[4:7], s38 offen sc1 lds
    v_add_f32 v48, v48, v50
    v_add_f32 v49, v49, v51
    v_add_f32 v52, v52, v54
    s_waitcnt lgkmcnt(2)
    v_mfma_f32_32x32x16_bf16 v[80:95], v[36:39], a[16:19], v[80:95]
    ds_read_b128 v[32:35], v11 offset:20480
    v_add_f32 v53, v53, v55
    v_add_f32 v48, v48, v52
    v_add_f32 v49, v49, v53
    v_mov_b32 v50, v48
    v_mov_b32 v51, v49
    s_waitcnt lgkmcnt(2)
    v_mfma_f32_32x32x16_bf16 v[96:111], v[40:43], a[16:19], v[96:111]
    ds_read_b128 v[36:39], v11 offset:21504
    s_add_u32 m0, s36, 50176
    s_add_u32 s38, s30, 53248
    buffer_load_dwordx4 v11, s[4:7], s38 offen sc1 lds
    v_permlane32_swap_b32 v48, v50
    v_permlane32_swap_b32 v49, v51
    v_add_f32 v48, v48, v50
    s_waitcnt lgkmcnt(2)
    v_mfma_f32_32x32x16_bf16 v[112:127], v[44:47], a[16:19], v[112:127]
    ds_read_b128 v[40:43], v11 offset:22528
    v_add_f32 v49, v49, v51
    v_mul_f32 v48, 0x3acccccd, v48
    v_mul_f32 v49, 0x3acccccd, v49
    v_fma_f32 v49, -v48, v48, v49
    v_add_f32 v49, 0x3727c5ac, v49
    s_waitcnt lgkmcnt(2)
    v_mfma_f32_32x32x16_bf16 v[64:79], v[32:35], a[20:23], v[64:79]
    ds_read_b128 v[44:47], v11 offset:23552
    v_sqrt_f32 v57, v49
    v_sub_f32 v56, 0, v48
    v_rcp_f32 v58, v57
    s_waitcnt lgkmcnt(2)
    v_mfma_f32_32x32x16_bf16 v[80:95], v[36:39], a[20:23], v[80:95]
    ds_read_b128 v[32:35], v11 offset:24576
    s_add_u32 m0, s36, 51200
    s_add_u32 s38, s30, 94208
    buffer_load_dwordx4 v11, s[4:7], s38 offen sc1 lds
    v_mul_f32 v58, 0xbfb8aa3b, v58
    s_waitcnt lgkmcnt(2)
    v_mfma_f32_32x32x16_bf16 v[96:111], v[40:43], a[20:23], v[96:111]
    ds_read_b128 v[36:39], v11 offset:25600
    s_waitcnt lgkmcnt(2)
    v_mfma_f32_32x32x16_bf16 v[112:127], v[44:47], a[20:23], v[112:127]
    ds_read_b128 v[40:43], v11 offset:26624
    s_add_u32 m0, s36, 52224
    s_add_u32 s38, s30, 135168
    buffer_load_dwordx4 v11, s[4:7], s38 offen sc1 lds
    s_waitcnt lgkmcnt(2)
    v_mfma_f32_32x32x16_bf16 v[64:79], v[32:35], a[24:27], v[64:79]
    ds_read_b128 v[44:47], v11 offset:27648
    s_waitcnt lgkmcnt(2)
    v_mfma_f32_32x32x16_bf16 v[80:95], v[36:39], a[24:27], v[80:95]
    ds_read_b128 v[32:35], v11 offset:28672
    s_add_u32 s39, s28, 4096
    buffer_load_dwordx4 a[48:51], v10, s[4:7], s39 offen offset:2048 sc1
    s_waitcnt lgkmcnt(2)
    v_mfma_f32_32x32x16_bf16 v[96:111], v[40:43], a[24:27], v[96:111]
    ds_read_b128 v[36:39], v11 offset:29696
    s_waitcnt lgkmcnt(2)
    v_mfma_f32_32x32x16_bf16 v[112:127], v[44:47], a[24:27], v[112:127]
    ds_read_b128 v[40:43], v11 offset:30720
    s_add_u32 s39, s28, 4096
    buffer_load_dwordx4 a[52:55], v10, s[4:7], s39 offen offset:2560 sc1
    s_waitcnt lgkmcnt(2)
    v_mfma_f32_32x32x16_bf16 v[64:79], v[32:35], a[28:31], v[64:79]
    ds_read_b128 v[44:47], v11 offset:31744
    s_waitcnt lgkmcnt(2)
    v_mfma_f32_32x32x16_bf16 v[80:95], v[36:39], a[28:31], v[80:95]
    s_waitcnt vmcnt(10)
    s_barrier
    ds_read_b128 v[32:35], v11 offset:32768
    s_add_u32 s39, s28, 4096
    buffer_load_dwordx4 a[56:59], v10, s[4:7], s39 offen offset:3072 sc1
    s_waitcnt lgkmcnt(2)
    v_mfma_f32_32x32x16_bf16 v[96:111], v[40:43], a[28:31], v[96:111]
    ds_read_b128 v[36:39], v11 offset:33792
    s_waitcnt lgkmcnt(2)
    v_mfma_f32_32x32x16_bf16 v[112:127], v[44:47], a[28:31], v[112:127]
    ds_read_b128 v[40:43], v11 offset:34816
    s_add_u32 s39, s28, 4096
    buffer_load_dwordx4 a[60:63], v10, s[4:7], s39 offen offset:3584 sc1
    s_waitcnt vmcnt(11) lgkmcnt(2)
    v_mfma_f32_32x32x16_bf16 v[64:79], v[32:35], a[32:35], v[64:79]
    ds_read_b128 v[44:47], v11 offset:35840
    s_waitcnt lgkmcnt(2)
    v_mfma_f32_32x32x16_bf16 v[80:95], v[36:39], a[32:35], v[80:95]
    ds_read_b128 v[32:35], v11 offset:36864
    s_add_u32 m0, s36, 0
    s_add_u32 s38, s30, 16384
    buffer_load_dwordx4 v11, s[4:7], s38 offen sc1 lds
    s_waitcnt lgkmcnt(2)
    v_mfma_f32_32x32x16_bf16 v[96:111], v[40:43], a[32:35], v[96:111]
    ds_read_b128 v[36:39], v11 offset:37888
    s_waitcnt lgkmcnt(2)
    v_mfma_f32_32x32x16_bf16 v[112:127], v[44:47], a[32:35], v[112:127]
    ds_read_b128 v[40:43], v11 offset:38912
    s_add_u32 m0, s36, 1024
    s_add_u32 s38, s30, 57344
    buffer_load_dwordx4 v11, s[4:7], s38 offen sc1 lds
    s_waitcnt vmcnt(12) lgkmcnt(2)
    v_mfma_f32_32x32x16_bf16 v[64:79], v[32:35], a[36:39], v[64:79]
    ds_read_b128 v[44:47], v11 offset:39936
    s_waitcnt lgkmcnt(2)
    v_mfma_f32_32x32x16_bf16 v[80:95], v[36:39], a[36:39], v[80:95]
    ds_read_b128 v[32:35], v11 offset:40960
    s_add_u32 m0, s36, 2048
    s_add_u32 s38, s30, 98304
    buffer_load_dwordx4 v11, s[4:7], s38 offen sc1 lds
    s_waitcnt lgkmcnt(2)
    v_mfma_f32_32x32x16_bf16 v[96:111], v[40:43], a[36:39], v[96:111]
    ds_read_b128 v[36:39], v11 offset:41984
    s_waitcnt lgkmcnt(2)
    v_mfma_f32_32x32x16_bf16 v[112:127], v[44:47], a[36:39], v[112:127]
    ds_read_b128 v[40:43], v11 offset:43008
    s_add_u32 m0, s36, 3072
    s_add_u32 s38, s30, 139264
    buffer_load_dwordx4 v11, s[4:7], s38 offen sc1 lds
    s_waitcnt vmcnt(13) lgkmcnt(2)
    v_mfma_f32_32x32x16_bf16 v[64:79], v[32:35], a[40:43], v[64:79]
    ds_read_b128 v[44:47], v11 offset:44032
    s_waitcnt lgkmcnt(2)
    v_mfma_f32_32x32x16_bf16 v[80:95], v[36:39], a[40:43], v[80:95]
    ds_read_b128 v[32:35], v11 offset:45056
    s_waitcnt lgkmcnt(2)
    v_mfma_f32_32x32x16_bf16 v[96:111], v[40:43], a[40:43], v[96:111]
    ds_read_b128 v[36:39], v11 offset:46080
    s_add_u32 s39, s28, 8192
    buffer_load_dwordx4 a[64:67], v10, s[4:7], s39 offen offset:0 sc1
    s_waitcnt lgkmcnt(2)
    v_mfma_f32_32x32x16_bf16 v[112:127], v[44:47], a[40:43], v[112:127]
    ds_read_b128 v[40:43], v11 offset:47104
    s_waitcnt vmcnt(13) lgkmcnt(2)
    v_mfma_f32_32x32x16_bf16 v[64:79], v[32:35], a[44:47], v[64:79]
    ds_read_b128 v[44:47], v11 offset:48128
    s_add_u32 s39, s28, 8192
    buffer_load_dwordx4 a[68:71], v10, s[4:7], s39 offen offset:512 sc1
    s_waitcnt lgkmcnt(2)
    v_mfma_f32_32x32x16_bf16 v[80:95], v[36:39], a[44:47], v[80:95]
    s_waitcnt vmcnt(10)
    s_barrier
    ds_read_b128 v[32:35], v11 offset:49152
    s_waitcnt lgkmcnt(2)
    v_mfma_f32_32x32x16_bf16 v[96:111], v[40:43], a[44:47], v[96:111]
    ds_read_b128 v[36:39], v11 offset:50176
    s_add_u32 s39, s28, 8192
    buffer_load_dwordx4 a[72:75], v10, s[4:7], s39 offen offset:1024 sc1
    s_waitcnt lgkmcnt(2)
    v_mfma_f32_32x32x16_bf16 v[112:127], v[44:47], a[44:47], v[112:127]
    ds_read_b128 v[40:43], v11 offset:51200
    s_waitcnt vmcnt(10) lgkmcnt(2)
    v_mfma_f32_32x32x16_bf16 v[64:79], v[32:35], a[48:51], v[64:79]
    ds_read_b128 v[44:47], v11 offset:52224
    s_add_u32 s39, s28, 8192
    buffer_load_dwordx4 a[76:79], v10, s[4:7], s39 offen offset:1536 sc1
    s_waitcnt lgkmcnt(2)
    v_mfma_f32_32x32x16_bf16 v[80:95], v[36:39], a[48:51], v[80:95]
    ds_read_b128 v[32:35], v11 offset:53248
    s_waitcnt lgkmcnt(2)
    v_mfma_f32_32x32x16_bf16 v[96:111], v[40:43], a[48:51], v[96:111]
    ds_read_b128 v[36:39], v11 offset:54272
    s_add_u32 m0, s36, 16384
    s_add_u32 s38, s30, 20480
    buffer_load_dwordx4 v11, s[4:7], s38 offen sc1 lds
    s_waitcnt lgkmcnt(2)
    v_mfma_f32_32x32x16_bf16 v[112:127], v[44:47], a[48:51], v[112:127]
    ds_read_b128 v[40:43], v11 offset:55296
    s_waitcnt vmcnt(11) lgkmcnt(2)
    v_mfma_f32_32x32x16_bf16 v[64:79], v[32:35], a[52:55], v[64:79]
    ds_read_b128 v[44:47], v11 offset:56320
    s_add_u32 m0, s36, 17408
    s_add_u32 s38, s30, 61440
    buffer_load_dwordx4 v11, s[4:7], s38 offen sc1 lds
    s_waitcnt lgkmcnt(2)
    v_mfma_f32_32x32x16_bf16 v[80:95], v[36:39], a[52:55], v[80:95]
    ds_read_b128 v[32:35], v11 offset:57344
    s_waitcnt lgkmcnt(2)
    v_mfma_f32_32x32x16_bf16 v[96:111], v[40:43], a[52:55], v[96:111]
    ds_read_b128 v[36:39], v11 offset:58368
    s_add_u32 m0, s36, 18432
    s_add_u32 s38, s30, 102400
    buffer_load_dwordx4 v11, s[4:7], s38 offen sc1 lds
    s_waitcnt lgkmcnt(2)
    v_mfma_f32_32x32x16_bf16 v[112:127], v[44:47], a[52:55], v[112:127]
    ds_read_b128 v[40:43], v11 offset:59392
    s_waitcnt vmcnt(12) lgkmcnt(2)
    v_mfma_f32_32x32x16_bf16 v[64:79], v[32:35], a[56:59], v[64:79]
    ds_read_b128 v[44:47], v11 offset:60416
    s_add_u32 m0, s36, 19456
    s_add_u32 s38, s30, 143360
    buffer_load_dwordx4 v11, s[4:7], s38 offen sc1 lds
    s_waitcnt lgkmcnt(2)
    v_mfma_f32_32x32x16_bf16 v[80:95], v[36:39], a[56:59], v[80:95]
    ds_read_b128 v[32:35], v11 offset:61440
    s_waitcnt lgkmcnt(2)
    v_mfma_f32_32x32x16_bf16 v[96:111], v[40:43], a[56:59], v[96:111]
    ds_read_b128 v[36:39], v11 offset:62464
    s_add_u32 s39, s28, 8192
    buffer_load_dwordx4 a[80:83], v10, s[4:7], s39 offen offset:2048 sc1
    s_waitcnt lgkmcnt(2)
    v_mfma_f32_32x32x16_bf16 v[112:127], v[44:47], a[56:59], v[112:127]
    ds_read_b128 v[40:43], v11 offset:63488
    s_waitcnt vmcnt(13) lgkmcnt(2)
    v_mfma_f32_32x32x16_bf16 v[64:79], v[32:35], a[60:63], v[64:79]
    ds_read_b128 v[44:47], v11 offset:64512
    s_add_u32 s39, s28, 8192
    buffer_load_dwordx4 a[84:87], v10, s[4:7], s39 offen offset:2560 sc1
    s_waitcnt lgkmcnt(2)
    v_mfma_f32_32x32x16_bf16 v[80:95], v[36:39], a[60:63], v[80:95]
    s_waitcnt vmcnt(10)
    s_barrier
    ds_read_b128 v[32:35], v11 offset:0
    s_waitcnt lgkmcnt(2)
    v_mfma_f32_32x32x16_bf16 v[96:111], v[40:43], a[60:63], v[96:111]
    ds_read_b128 v[36:39], v11 offset:1024
    s_waitcnt lgkmcnt(2)
    v_mfma_f32_32x32x16_bf16 v[112:127], v[44:47], a[60:63], v[112:127]
    ds_read_b128 v[40:43], v11 offset:2048
    s_add_u32 s39, s28, 8192
    buffer_load_dwordx4 a[88:91], v10, s[4:7], s39 offen offset:3072 sc1
    s_waitcnt vmcnt(10) lgkmcnt(2)
    v_mfma_f32_32x32x16_bf16 v[64:79], v[32:35], a[64:67], v[64:79]
    ds_read_b128 v[44:47], v11 offset:3072
    s_waitcnt lgkmcnt(2)
    v_mfma_f32_32x32x16_bf16 v[80:95], v[36:39], a[64:67], v[80:95]
    ds_read_b128 v[32:35], v11 offset:4096
    s_add_u32 s39, s28, 8192
    buffer_load_dwordx4 a[92:95], v10, s[4:7], s39 offen offset:3584 sc1
    s_waitcnt lgkmcnt(2)
    v_mfma_f32_32x32x16_bf16 v[96:111], v[40:43], a[64:67], v[96:111]
    ds_read_b128 v[36:39], v11 offset:5120
    s_waitcnt lgkmcnt(2)
    v_mfma_f32_32x32x16_bf16 v[112:127], v[44:47], a[64:67], v[112:127]
    ds_read_b128 v[40:43], v11 offset:6144
    s_add_u32 m0, s36, 32768
    s_add_u32 s38, s30, 24576
    buffer_load_dwordx4 v11, s[4:7], s38 offen sc1 lds
    s_waitcnt vmcnt(11) lgkmcnt(2)
    v_mfma_f32_32x32x16_bf16 v[64:79], v[32:35], a[68:71], v[64:79]
    ds_read_b128 v[44:47], v11 offset:7168
    s_waitcnt lgkmcnt(2)
    v_mfma_f32_32x32x16_bf16 v[80:95], v[36:39], a[68:71], v[80:95]
    ds_read_b128 v[32:35], v11 offset:8192
    s_add_u32 m0, s36, 33792
    s_add_u32 s38, s30, 65536
    buffer_load_dwordx4 v11, s[4:7], s38 offen sc1 lds
    s_waitcnt lgkmcnt(2)
    v_mfma_f32_32x32x16_bf16 v[96:111], v[40:43], a[68:71], v[96:111]
    ds_read_b128 v[36:39], v11 offset:9216
    s_waitcnt lgkmcnt(2)
    v_mfma_f32_32x32x16_bf16 v[112:127], v[44:47], a[68:71], v[112:127]
    ds_read_b128 v[40:43], v11 offset:10240
    s_add_u32 m0, s36, 34816
    s_add_u32 s38, s30, 106496
    buffer_load_dwordx4 v11, s[4:7], s38 offen sc1 lds
    s_waitcnt vmcnt(12) lgkmcnt(2)
    v_mfma_f32_32x32x16_bf16 v[64:79], v[32:35], a[72:75], v[64:79]
    ds_read_b128 v[44:47], v11 offset:11264
    s_waitcnt lgkmcnt(2)
    v_mfma_f32_32x32x16_bf16 v[80:95], v[36:39], a[72:75], v[80:95]
    ds_read_b128 v[32:35], v11 offset:12288
    s_add_u32 m0, s36, 35840
    s_add_u32 s38, s30, 147456
    buffer_load_dwordx4 v11, s[4:7], s38 offen sc1 lds
    s_waitcnt lgkmcnt(2)
    v_mfma_f32_32x32x16_bf16 v[96:111], v[40:43], a[72:75], v[96:111]
    ds_read_b128 v[36:39], v11 offset:13312
    s_waitcnt lgkmcnt(2)
    v_mfma_f32_32x32x16_bf16 v[112:127], v[44:47], a[72:75], v[112:127]
    ds_read_b128 v[40:43], v11 offset:14336
    s_add_u32 s39, s28, 12288
    buffer_load_dwordx4 a[96:99], v10, s[4:7], s39 offen offset:0 sc1
    s_waitcnt vmcnt(13) lgkmcnt(2)
    v_mfma_f32_32x32x16_bf16 v[64:79], v[32:35], a[76:79], v[64:79]
    ds_read_b128 v[44:47], v11 offset:15360
    s_waitcnt lgkmcnt(2)
    v_mfma_f32_32x32x16_bf16 v[80:95], v[36:39], a[76:79], v[80:95]
    s_waitcnt vmcnt(9)
    s_barrier
    ds_read_b128 v[32:35], v11 offset:16384
    s_add_u32 s39, s28, 12288
    buffer_load_dwordx4 a[100:103], v10, s[4:7], s39 offen offset:512 sc1
    s_waitcnt lgkmcnt(2)
    v_mfma_f32_32x32x16_bf16 v[96:111], v[40:43], a[76:79], v[96:111]
    ds_read_b128 v[36:39], v11 offset:17408
    s_waitcnt lgkmcnt(2)
    v_mfma_f32_32x32x16_bf16 v[112:127], v[44:47], a[76:79], v[112:127]
    ds_read_b128 v[40:43], v11 offset:18432
    s_add_u32 s39, s28, 12288
    buffer_load_dwordx4 a[104:107], v10, s[4:7], s39 offen offset:1024 sc1
    s_waitcnt vmcnt(10) lgkmcnt(2)
    v_mfma_f32_32x32x16_bf16 v[64:79], v[32:35], a[80:83], v[64:79]
    ds_read_b128 v[44:47], v11 offset:19456
    s_waitcnt lgkmcnt(2)
    v_mfma_f32_32x32x16_bf16 v[80:95], v[36:39], a[80:83], v[80:95]
    ds_read_b128 v[32:35], v11 offset:20480
    s_add_u32 s39, s28, 12288
    buffer_load_dwordx4 a[108:111], v10, s[4:7], s39 offen offset:1536 sc1
    s_waitcnt lgkmcnt(2)
    v_mfma_f32_32x32x16_bf16 v[96:111], v[40:43], a[80:83], v[96:111]
    ds_read_b128 v[36:39], v11 offset:21504
    s_waitcnt lgkmcnt(2)
    v_mfma_f32_32x32x16_bf16 v[112:127], v[44:47], a[80:83], v[112:127]
    ds_read_b128 v[40:43], v11 offset:22528
    s_waitcnt vmcnt(10) lgkmcnt(2)
    v_mfma_f32_32x32x16_bf16 v[64:79], v[32:35], a[84:87], v[64:79]
    ds_read_b128 v[44:47], v11 offset:23552
    s_add_u32 m0, s36, 49152
    s_add_u32 s38, s30, 28672
    buffer_load_dwordx4 v11, s[4:7], s38 offen sc1 lds
    s_waitcnt lgkmcnt(2)
    v_mfma_f32_32x32x16_bf16 v[80:95], v[36:39], a[84:87], v[80:95]
    ds_read_b128 v[32:35], v11 offset:24576
    s_waitcnt lgkmcnt(2)
    v_mfma_f32_32x32x16_bf16 v[96:111], v[40:43], a[84:87], v[96:111]
    ds_read_b128 v[36:39], v11 offset:25600
    s_add_u32 m0, s36, 50176
    s_add_u32 s38, s30, 69632
    buffer_load_dwordx4 v11, s[4:7], s38 offen sc1 lds
    s_waitcnt lgkmcnt(2)
    v_mfma_f32_32x32x16_bf16 v[112:127], v[44:47], a[84:87], v[112:127]
    ds_read_b128 v[40:43], v11 offset:26624
    s_waitcnt vmcnt(11) lgkmcnt(2)
    v_mfma_f32_32x32x16_bf16 v[64:79], v[32:35], a[88:91], v[64:79]
    ds_read_b128 v[44:47], v11 offset:27648
    s_add_u32 m0, s36, 51200
    s_add_u32 s38, s30, 110592
    buffer_load_dwordx4 v11, s[4:7], s38 offen sc1 lds
    s_waitcnt lgkmcnt(2)
    v_mfma_f32_32x32x16_bf16 v[80:95], v[36:39], a[88:91], v[80:95]
    ds_read_b128 v[32:35], v11 offset:28672
    s_waitcnt lgkmcnt(2)
    v_mfma_f32_32x32x16_bf16 v[96:111], v[40:43], a[88:91], v[96:111]
    ds_read_b128 v[36:39], v11 offset:29696
    s_add_u32 m0, s36, 52224
    s_add_u32 s38, s30, 151552
    buffer_load_dwordx4 v11, s[4:7], s38 offen sc1 lds
    s_waitcnt lgkmcnt(2)
    v_mfma_f32_32x32x16_bf16 v[112:127], v[44:47], a[88:91], v[112:127]
    ds_read_b128 v[40:43], v11 offset:30720
    s_waitcnt vmcnt(12) lgkmcnt(2)
    v_mfma_f32_32x32x16_bf16 v[64:79], v[32:35], a[92:95], v[64:79]
    ds_read_b128 v[44:47], v11 offset:31744
    s_add_u32 s39, s28, 12288
    buffer_load_dwordx4 a[112:115], v10, s[4:7], s39 offen offset:2048 sc1
    s_waitcnt lgkmcnt(2)
    v_mfma_f32_32x32x16_bf16 v[80:95], v[36:39], a[92:95], v[80:95]
    s_waitcnt vmcnt(9)
    s_barrier
    ds_read_b128 v[32:35], v11 offset:32768
    s_waitcnt lgkmcnt(2)
    v_mfma_f32_32x32x16_bf16 v[96:111], v[40:43], a[92:95], v[96:111]
    ds_read_b128 v[36:39], v11 offset:33792
    s_add_u32 s39, s28, 12288
    buffer_load_dwordx4 a[116:119], v10, s[4:7], s39 offen offset:2560 sc1
    s_waitcnt lgkmcnt(2)
    v_mfma_f32_32x32x16_bf16 v[112:127], v[44:47], a[92:95], v[112:127]
    ds_read_b128 v[40:43], v11 offset:34816
    s_waitcnt vmcnt(9) lgkmcnt(2)
    v_mfma_f32_32x32x16_bf16 v[64:79], v[32:35], a[96:99], v[64:79]
    ds_read_b128 v[44:47], v11 offset:35840
    s_add_u32 s39, s28, 12288
    buffer_load_dwordx4 a[120:123], v10, s[4:7], s39 offen offset:3072 sc1
    s_waitcnt lgkmcnt(2)
    v_mfma_f32_32x32x16_bf16 v[80:95], v[36:39], a[96:99], v[80:95]
    ds_read_b128 v[32:35], v11 offset:36864
    s_waitcnt lgkmcnt(2)
    v_mfma_f32_32x32x16_bf16 v[96:111], v[40:43], a[96:99], v[96:111]
    ds_read_b128 v[36:39], v11 offset:37888
    s_add_u32 s39, s28, 12288
    buffer_load_dwordx4 a[124:127], v10, s[4:7], s39 offen offset:3584 sc1
    s_waitcnt lgkmcnt(2)
    v_mfma_f32_32x32x16_bf16 v[112:127], v[44:47], a[96:99], v[112:127]
    ds_read_b128 v[40:43], v11 offset:38912
    s_waitcnt vmcnt(10) lgkmcnt(2)
    v_mfma_f32_32x32x16_bf16 v[64:79], v[32:35], a[100:103], v[64:79]
    ds_read_b128 v[44:47], v11 offset:39936
    s_add_u32 m0, s36, 0
    s_add_u32 s38, s30, 32768
    buffer_load_dwordx4 v11, s[4:7], s38 offen sc1 lds
    s_waitcnt lgkmcnt(2)
    v_mfma_f32_32x32x16_bf16 v[80:95], v[36:39], a[100:103], v[80:95]
    ds_read_b128 v[32:35], v11 offset:40960
    s_waitcnt lgkmcnt(2)
    v_mfma_f32_32x32x16_bf16 v[96:111], v[40:43], a[100:103], v[96:111]
    ds_read_b128 v[36:39], v11 offset:41984
    s_add_u32 m0, s36, 1024
    s_add_u32 s38, s30, 73728
    buffer_load_dwordx4 v11, s[4:7], s38 offen sc1 lds
    s_waitcnt lgkmcnt(2)
    v_mfma_f32_32x32x16_bf16 v[112:127], v[44:47], a[100:103], v[112:127]
    ds_read_b128 v[40:43], v11 offset:43008
    s_waitcnt vmcnt(11) lgkmcnt(2)
    v_mfma_f32_32x32x16_bf16 v[64:79], v[32:35], a[104:107], v[64:79]
    ds_read_b128 v[44:47], v11 offset:44032
    s_waitcnt lgkmcnt(2)
    v_mfma_f32_32x32x16_bf16 v[80:95], v[36:39], a[104:107], v[80:95]
    ds_read_b128 v[32:35], v11 offset:45056
    s_add_u32 m0, s36, 2048
    s_add_u32 s38, s30, 114688
    buffer_load_dwordx4 v11, s[4:7], s38 offen sc1 lds
    s_waitcnt lgkmcnt(2)
    v_mfma_f32_32x32x16_bf16 v[96:111], v[40:43], a[104:107], v[96:111]
    ds_read_b128 v[36:39], v11 offset:46080
    s_waitcnt lgkmcnt(2)
    v_mfma_f32_32x32x16_bf16 v[112:127], v[44:47], a[104:107], v[112:127]
    ds_read_b128 v[40:43], v11 offset:47104
    s_add_u32 m0, s36, 3072
    s_add_u32 s38, s30, 155648
    buffer_load_dwordx4 v11, s[4:7], s38 offen sc1 lds
    s_waitcnt vmcnt(12) lgkmcnt(2)
    v_mfma_f32_32x32x16_bf16 v[64:79], v[32:35], a[108:111], v[64:79]
    ds_read_b128 v[44:47], v11 offset:48128
    s_waitcnt lgkmcnt(2)
    v_mfma_f32_32x32x16_bf16 v[80:95], v[36:39], a[108:111], v[80:95]
    s_waitcnt vmcnt(8)
    s_barrier
    ds_read_b128 v[32:35], v11 offset:49152
    s_add_u32 s39, s28, 16384
    buffer_load_dwordx4 a[128:131], v10, s[4:7], s39 offen offset:0 sc1
    s_waitcnt lgkmcnt(2)
    v_mfma_f32_32x32x16_bf16 v[96:111], v[40:43], a[108:111], v[96:111]
    ds_read_b128 v[36:39], v11 offset:50176
    s_waitcnt lgkmcnt(2)
    v_mfma_f32_32x32x16_bf16 v[112:127], v[44:47], a[108:111], v[112:127]
    ds_read_b128 v[40:43], v11 offset:51200
    s_add_u32 s39, s28, 16384
    buffer_load_dwordx4 a[132:135], v10, s[4:7], s39 offen offset:512 sc1
    s_waitcnt vmcnt(9) lgkmcnt(2)
    v_mfma_f32_32x32x16_bf16 v[64:79], v[32:35], a[112:115], v[64:79]
    ds_read_b128 v[44:47], v11 offset:52224
    s_waitcnt lgkmcnt(2)
    v_mfma_f32_32x32x16_bf16 v[80:95], v[36:39], a[112:115], v[80:95]
    ds_read_b128 v[32:35], v11 offset:53248
    s_add_u32 s39, s28, 16384
    buffer_load_dwordx4 a[136:139], v10, s[4:7], s39 offen offset:1024 sc1
    s_waitcnt lgkmcnt(2)
    v_mfma_f32_32x32x16_bf16 v[96:111], v[40:43], a[112:115], v[96:111]
    ds_read_b128 v[36:39], v11 offset:54272
    s_waitcnt lgkmcnt(2)
    v_mfma_f32_32x32x16_bf16 v[112:127], v[44:47], a[112:115], v[112:127]
    ds_read_b128 v[40:43], v11 offset:55296
    s_add_u32 s39, s28, 16384
    buffer_load_dwordx4 a[140:143], v10, s[4:7], s39 offen offset:1536 sc1
    s_waitcnt vmcnt(10) lgkmcnt(2)
    v_mfma_f32_32x32x16_bf16 v[64:79], v[32:35], a[116:119], v[64:79]
    ds_read_b128 v[44:47], v11 offset:56320
    s_waitcnt lgkmcnt(2)
    v_mfma_f32_32x32x16_bf16 v[80:95], v[36:39], a[116:119], v[80:95]
    ds_read_b128 v[32:35], v11 offset:57344
    s_add_u32 m0, s36, 16384
    s_add_u32 s38, s30, 36864
    buffer_load_dwordx4 v11, s[4:7], s38 offen sc1 lds
    s_waitcnt lgkmcnt(2)
    v_mfma_f32_32x32x16_bf16 v[96:111], v[40:43], a[116:119], v[96:111]
    ds_read_b128 v[36:39], v11 offset:58368
    s_waitcnt lgkmcnt(2)
    v_mfma_f32_32x32x16_bf16 v[112:127], v[44:47], a[116:119], v[112:127]
    ds_read_b128 v[40:43], v11 offset:59392
    s_add_u32 m0, s36, 17408
    s_add_u32 s38, s30, 77824
    buffer_load_dwordx4 v11, s[4:7], s38 offen sc1 lds
    s_waitcnt vmcnt(11) lgkmcnt(2)
    v_mfma_f32_32x32x16_bf16 v[64:79], v[32:35], a[120:123], v[64:79]
    ds_read_b128 v[44:47], v11 offset:60416
    s_waitcnt lgkmcnt(2)
    v_mfma_f32_32x32x16_bf16 v[80:95], v[36:39], a[120:123], v[80:95]
    ds_read_b128 v[32:35], v11 offset:61440
    s_add_u32 m0, s36, 18432
    s_add_u32 s38, s30, 118784
    buffer_load_dwordx4 v11, s[4:7], s38 offen sc1 lds
    s_waitcnt lgkmcnt(2)
    v_mfma_f32_32x32x16_bf16 v[96:111], v[40:43], a[120:123], v[96:111]
    ds_read_b128 v[36:39], v11 offset:62464
    s_waitcnt lgkmcnt(2)
    v_mfma_f32_32x32x16_bf16 v[112:127], v[44:47], a[120:123], v[112:127]
    ds_read_b128 v[40:43], v11 offset:63488
    s_add_u32 m0, s36, 19456
    s_add_u32 s38, s30, 159744
    buffer_load_dwordx4 v11, s[4:7], s38 offen sc1 lds
    s_waitcnt vmcnt(12) lgkmcnt(2)
    v_mfma_f32_32x32x16_bf16 v[64:79], v[32:35], a[124:127], v[64:79]
    ds_read_b128 v[44:47], v11 offset:64512
    s_waitcnt lgkmcnt(2)
    v_mfma_f32_32x32x16_bf16 v[80:95], v[36:39], a[124:127], v[80:95]
    s_waitcnt vmcnt(8)
    s_barrier
    ds_read_b128 v[32:35], v11 offset:0
    s_waitcnt lgkmcnt(2)
    v_mfma_f32_32x32x16_bf16 v[96:111], v[40:43], a[124:127], v[96:111]
    ds_read_b128 v[36:39], v11 offset:1024
    s_add_u32 s39, s28, 16384
    buffer_load_dwordx4 a[144:147], v10, s[4:7], s39 offen offset:2048 sc1
    s_waitcnt lgkmcnt(2)
    v_mfma_f32_32x32x16_bf16 v[112:127], v[44:47], a[124:127], v[112:127]
    ds_read_b128 v[40:43], v11 offset:2048
    s_waitcnt vmcnt(8) lgkmcnt(2)
    v_mfma_f32_32x32x16_bf16 v[64:79], v[32:35], a[128:131], v[64:79]
    ds_read_b128 v[44:47], v11 offset:3072
    s_add_u32 s39, s28, 16384
    buffer_load_dwordx4 a[148:151], v10, s[4:7], s39 offen offset:2560 sc1
    s_waitcnt lgkmcnt(2)
    v_mfma_f32_32x32x16_bf16 v[80:95], v[36:39], a[128:131], v[80:95]
    ds_read_b128 v[32:35], v11 offset:4096
    s_waitcnt lgkmcnt(2)
    v_mfma_f32_32x32x16_bf16 v[96:111], v[40:43], a[128:131], v[96:111]
    ds_read_b128 v[36:39], v11 offset:5120
    s_add_u32 s39, s28, 16384
    buffer_load_dwordx4 a[152:155], v10, s[4:7], s39 offen offset:3072 sc1
    s_waitcnt lgkmcnt(2)
    v_mfma_f32_32x32x16_bf16 v[112:127], v[44:47], a[128:131], v[112:127]
    ds_read_b128 v[40:43], v11 offset:6144
    s_waitcnt vmcnt(9) lgkmcnt(2)
    v_mfma_f32_32x32x16_bf16 v[64:79], v[32:35], a[132:135], v[64:79]
    ds_read_b128 v[44:47], v11 offset:7168
    s_add_u32 s39, s28, 16384
    buffer_load_dwordx4 a[156:159], v10, s[4:7], s39 offen offset:3584 sc1
    s_waitcnt lgkmcnt(2)
    v_mfma_f32_32x32x16_bf16 v[80:95], v[36:39], a[132:135], v[80:95]
    ds_read_b128 v[32:35], v11 offset:8192
    s_waitcnt lgkmcnt(2)
    v_mfma_f32_32x32x16_bf16 v[96:111], v[40:43], a[132:135], v[96:111]
    ds_read_b128 v[36:39], v11 offset:9216
    s_add_u32 m0, s34, 32768
    s_add_u32 s38, s30, 163840
    buffer_load_dwordx4 v11, s[4:7], s38 offen sc1 lds
    s_waitcnt lgkmcnt(2)
    v_mfma_f32_32x32x16_bf16 v[112:127], v[44:47], a[132:135], v[112:127]
    ds_read_b128 v[40:43], v11 offset:10240
    s_waitcnt vmcnt(10) lgkmcnt(2)
    v_mfma_f32_32x32x16_bf16 v[64:79], v[32:35], a[136:139], v[64:79]
    ds_read_b128 v[44:47], v11 offset:11264
    s_add_u32 m0, s34, 33792
    s_add_u32 s38, s30, 204800
    buffer_load_dwordx4 v11, s[4:7], s38 offen sc1 lds
    s_waitcnt lgkmcnt(2)
    v_mfma_f32_32x32x16_bf16 v[80:95], v[36:39], a[136:139], v[80:95]
    ds_read_b128 v[32:35], v11 offset:12288
    s_waitcnt lgkmcnt(2)
    v_mfma_f32_32x32x16_bf16 v[96:111], v[40:43], a[136:139], v[96:111]
    ds_read_b128 v[36:39], v11 offset:13312
    s_add_u32 m0, s34, 40960
    s_add_u32 s38, s30, 167936
    buffer_load_dwordx4 v11, s[4:7], s38 offen sc1 lds
    s_waitcnt lgkmcnt(2)
    v_mfma_f32_32x32x16_bf16 v[112:127], v[44:47], a[136:139], v[112:127]
    ds_read_b128 v[40:43], v11 offset:14336
    s_waitcnt vmcnt(11) lgkmcnt(2)
    v_mfma_f32_32x32x16_bf16 v[64:79], v[32:35], a[140:143], v[64:79]
    ds_read_b128 v[44:47], v11 offset:15360
    s_add_u32 m0, s34, 41984
    s_add_u32 s38, s30, 208896
    buffer_load_dwordx4 v11, s[4:7], s38 offen sc1 lds
    s_waitcnt lgkmcnt(2)
    v_mfma_f32_32x32x16_bf16 v[80:95], v[36:39], a[140:143], v[80:95]
    s_waitcnt vmcnt(8)
    s_barrier
    ds_read_b128 v[32:35], v11 offset:16384
    s_waitcnt lgkmcnt(2)
    v_mfma_f32_32x32x16_bf16 v[96:111], v[40:43], a[140:143], v[96:111]
    ds_read_b128 v[36:39], v11 offset:17408
    s_add_u32 m0, s34, 49152
    s_add_u32 s38, s30, 172032
    buffer_load_dwordx4 v11, s[4:7], s38 offen sc1 lds
    s_waitcnt lgkmcnt(2)
    v_mfma_f32_32x32x16_bf16 v[112:127], v[44:47], a[140:143], v[112:127]
    ds_read_b128 v[40:43], v11 offset:18432
    s_waitcnt vmcnt(8) lgkmcnt(2)
    v_mfma_f32_32x32x16_bf16 v[64:79], v[32:35], a[144:147], v[64:79]
    ds_read_b128 v[44:47], v11 offset:19456
    s_add_u32 m0, s34, 50176
    s_add_u32 s38, s30, 212992
    buffer_load_dwordx4 v11, s[4:7], s38 offen sc1 lds
    s_waitcnt lgkmcnt(2)
    v_mfma_f32_32x32x16_bf16 v[80:95], v[36:39], a[144:147], v[80:95]
    ds_read_b128 v[32:35], v11 offset:20480
    s_waitcnt lgkmcnt(2)
    v_mfma_f32_32x32x16_bf16 v[96:111], v[40:43], a[144:147], v[96:111]
    ds_read_b128 v[36:39], v11 offset:21504
    s_waitcnt lgkmcnt(2)
    v_mfma_f32_32x32x16_bf16 v[112:127], v[44:47], a[144:147], v[112:127]
    ds_read_b128 v[40:43], v11 offset:22528
    s_add_u32 m0, s34, 57344
    s_add_u32 s38, s30, 176128
    buffer_load_dwordx4 v11, s[4:7], s38 offen sc1 lds
    s_waitcnt vmcnt(9) lgkmcnt(2)
    v_mfma_f32_32x32x16_bf16 v[64:79], v[32:35], a[148:151], v[64:79]
    ds_read_b128 v[44:47], v11 offset:23552
    s_waitcnt lgkmcnt(2)
    v_mfma_f32_32x32x16_bf16 v[80:95], v[36:39], a[148:151], v[80:95]
    ds_read_b128 v[32:35], v11 offset:24576
    s_add_u32 m0, s34, 58368
    s_add_u32 s38, s30, 217088
    buffer_load_dwordx4 v11, s[4:7], s38 offen sc1 lds
    s_waitcnt lgkmcnt(2)
    v_mfma_f32_32x32x16_bf16 v[96:111], v[40:43], a[148:151], v[96:111]
    ds_read_b128 v[36:39], v11 offset:25600
    s_waitcnt lgkmcnt(2)
    v_mfma_f32_32x32x16_bf16 v[112:127], v[44:47], a[148:151], v[112:127]
    ds_read_b128 v[40:43], v11 offset:26624
    s_waitcnt vmcnt(9) lgkmcnt(2)
    v_mfma_f32_32x32x16_bf16 v[64:79], v[32:35], a[152:155], v[64:79]
    ds_read_b128 v[44:47], v11 offset:27648
    s_waitcnt lgkmcnt(2)
    v_mfma_f32_32x32x16_bf16 v[80:95], v[36:39], a[152:155], v[80:95]
    ds_read_b128 v[32:35], v11 offset:28672
    s_waitcnt lgkmcnt(2)
    v_mfma_f32_32x32x16_bf16 v[96:111], v[40:43], a[152:155], v[96:111]
    ds_read_b128 v[36:39], v11 offset:29696
    s_waitcnt lgkmcnt(2)
    v_mfma_f32_32x32x16_bf16 v[112:127], v[44:47], a[152:155], v[112:127]
    ds_read_b128 v[40:43], v11 offset:30720
    s_waitcnt vmcnt(8) lgkmcnt(2)
    v_mfma_f32_32x32x16_bf16 v[64:79], v[32:35], a[156:159], v[64:79]
    ds_read_b128 v[44:47], v11 offset:31744
    s_waitcnt lgkmcnt(2)
    v_mfma_f32_32x32x16_bf16 v[80:95], v[36:39], a[156:159], v[80:95]
    s_waitcnt vmcnt(4)
    s_barrier
    ds_read_b128 v[32:35], v11 offset:32768
    s_add_u32 m0, s34, 0
    s_add_u32 s38, s30, 180224
    buffer_load_dwordx4 v11, s[4:7], s38 offen sc1 lds
    s_waitcnt lgkmcnt(2)
    v_mfma_f32_32x32x16_bf16 v[96:111], v[40:43], a[156:159], v[96:111]
    ds_read_b128 v[36:39], v11 offset:33792
    s_add_u32 m0, s34, 1024
    s_add_u32 s38, s30, 221184
    buffer_load_dwordx4 v11, s[4:7], s38 offen sc1 lds
    s_waitcnt lgkmcnt(2)
    v_mfma_f32_32x32x16_bf16 v[112:127], v[44:47], a[156:159], v[112:127]
    ds_read_b128 v[40:43], v11 offset:34816
    s_waitcnt lgkmcnt(2)
    v_mfma_f32_32x32x16_bf16 v[128:143], v[32:35], a[0:3], 0
    ds_read_b128 v[44:47], v11 offset:35840
    s_add_u32 m0, s34, 8192
    s_add_u32 s38, s30, 184320
    buffer_load_dwordx4 v11, s[4:7], s38 offen sc1 lds
    ds_read_b128 v[200:203], v13 offset:0
    ds_read_b128 v[204:207], v13 offset:32
    ds_read_b128 v[208:211], v13 offset:64
    s_waitcnt lgkmcnt(5)
    v_mfma_f32_32x32x16_bf16 v[144:159], v[36:39], a[0:3], 0
    ds_read_b128 v[32:35], v11 offset:36864
    ds_read_b128 v[212:215], v13 offset:96
    s_waitcnt lgkmcnt(4)
    v_fma_f32 v64, v56, v200, v64
    v_fma_f32 v65, v56, v201, v65
    v_fma_f32 v66, v56, v202, v66
    v_fma_f32 v67, v56, v203, v67
    v_mfma_f32_32x32x16_bf16 v[128:143], v[40:43], a[4:7], v[128:143]
    ds_read_b128 v[36:39], v11 offset:37888
    s_waitcnt lgkmcnt(4)
    v_fma_f32 v68, v56, v204, v68
    v_fma_f32 v69, v56, v205, v69
    v_fma_f32 v70, v56, v206, v70
    v_fma_f32 v71, v56, v207, v71
    v_mul_f32 v64, v58, v64
    v_mfma_f32_32x32x16_bf16 v[144:159], v[44:47], a[4:7], v[144:159]
    ds_read_b128 v[40:43], v11 offset:38912
    s_add_u32 m0, s34, 9216
    s_add_u32 s38, s30, 225280
    buffer_load_dwordx4 v11, s[4:7], s38 offen sc1 lds
    v_mul_f32 v65, v58, v65
    v_mul_f32 v66, v58, v66
    v_mul_f32 v67, v58, v67
    s_waitcnt lgkmcnt(3)
    v_mfma_f32_32x32x16_bf16 v[128:143], v[32:35], a[8:11], v[128:143]
    ds_read_b128 v[44:47], v11 offset:39936
    v_mul_f32 v68, v58, v68
    v_mul_f32 v69, v58, v69
    v_mul_f32 v70, v58, v70
    v_mul_f32 v71, v58, v71
    s_waitcnt lgkmcnt(2)
    v_mfma_f32_32x32x16_bf16 v[144:159], v[36:39], a[8:11], v[144:159]
    ds_read_b128 v[32:35], v11 offset:40960
    v_exp_f32 v64, v64
    v_fma_f32 v72, v56, v208, v72
    v_exp_f32 v65, v65
    s_waitcnt lgkmcnt(2)
    v_mfma_f32_32x32x16_bf16 v[128:143], v[40:43], a[12:15], v[128:143]
    ds_read_b128 v[36:39], v11 offset:41984
    v_fma_f32 v73, v56, v209, v73
    v_exp_f32 v66, v66
    v_fma_f32 v74, v56, v210, v74
    s_waitcnt lgkmcnt(2)
    v_mfma_f32_32x32x16_bf16 v[144:159], v[44:47], a[12:15], v[144:159]
    ds_read_b128 v[40:43], v11 offset:43008
    v_exp_f32 v67, v67
    v_fma_f32 v75, v56, v211, v75
    v_exp_f32 v68, v68
    s_waitcnt lgkmcnt(2)
    v_mfma_f32_32x32x16_bf16 v[128:143], v[32:35], a[16:19], v[128:143]
    ds_read_b128 v[44:47], v11 offset:44032
    v_fma_f32 v76, v56, v212, v76
    v_exp_f32 v69, v69
    v_fma_f32 v77, v56, v213, v77
    s_waitcnt lgkmcnt(2)
    v_mfma_f32_32x32x16_bf16 v[144:159], v[36:39], a[16:19], v[144:159]
    ds_read_b128 v[32:35], v11 offset:45056
    v_exp_f32 v70, v70
    v_fma_f32 v78, v56, v214, v78
    v_exp_f32 v71, v71
    s_waitcnt lgkmcnt(2)
    v_mfma_f32_32x32x16_bf16 v[128:143], v[40:43], a[20:23], v[128:143]
    ds_read_b128 v[36:39], v11 offset:46080
    v_fma_f32 v79, v56, v215, v79
    v_fma_f32 v64, v64, v57, v57
    v_fma_f32 v65, v65, v57, v57
    v_rcp_f32 v64, v64
    s_waitcnt lgkmcnt(2)
    v_mfma_f32_32x32x16_bf16 v[144:159], v[44:47], a[20:23], v[144:159]
    ds_read_b128 v[40:43], v11 offset:47104
    v_fma_f32 v66, v66, v57, v57
    v_rcp_f32 v65, v65
    v_fma_f32 v67, v67, v57, v57
    s_waitcnt lgkmcnt(2)
    v_mfma_f32_32x32x16_bf16 v[128:143], v[32:35], a[24:27], v[128:143]
    ds_read_b128 v[44:47], v11 offset:48128
    v_rcp_f32 v66, v66
    v_fma_f32 v68, v68, v57, v57
    v_rcp_f32 v67, v67
    s_waitcnt lgkmcnt(2)
    v_mfma_f32_32x32x16_bf16 v[144:159], v[36:39], a[24:27], v[144:159]
    s_waitcnt vmcnt(4)
    s_barrier
    ds_read_b128 v[32:35], v11 offset:49152
    s_add_u32 m0, s34, 16384
    s_add_u32 s38, s30, 188416
    buffer_load_dwordx4 v11, s[4:7], s38 offen sc1 lds
    v_fma_f32 v69, v69, v57, v57
    v_rcp_f32 v68, v68
    s_waitcnt lgkmcnt(2)
    v_mfma_f32_32x32x16_bf16 v[128:143], v[40:43], a[28:31], v[128:143]
    ds_read_b128 v[36:39], v11 offset:50176
    s_add_u32 m0, s34, 17408
    s_add_u32 s38, s30, 229376
    buffer_load_dwordx4 v11, s[4:7], s38 offen sc1 lds
    v_fma_f32 v70, v70, v57, v57
    v_rcp_f32 v69, v69
    s_waitcnt lgkmcnt(2)
    v_mfma_f32_32x32x16_bf16 v[144:159], v[44:47], a[28:31], v[144:159]
    ds_read_b128 v[40:43], v11 offset:51200
    v_fma_f32 v71, v71, v57, v57
    v_rcp_f32 v70, v70
    v_rcp_f32 v71, v71
    s_waitcnt lgkmcnt(2)
    v_mfma_f32_32x32x16_bf16 v[128:143], v[32:35], a[32:35], v[128:143]
    ds_read_b128 v[44:47], v11 offset:52224
    s_add_u32 m0, s34, 24576
    s_add_u32 s38, s30, 192512
    buffer_load_dwordx4 v11, s[4:7], s38 offen sc1 lds
    v_mul_f32 v72, v72, v64
    v_mul_f32 v73, v73, v65
    v_mul_f32 v74, v74, v66
    s_waitcnt lgkmcnt(2)
    v_mfma_f32_32x32x16_bf16 v[144:159], v[36:39], a[32:35], v[144:159]
    ds_read_b128 v[32:35], v11 offset:53248
    v_mul_f32 v75, v75, v67
    v_mul_f32 v76, v76, v68
    v_mul_f32 v77, v77, v69
    v_mul_f32 v78, v78, v70
    v_mul_f32 v79, v79, v71
    s_waitcnt lgkmcnt(2)
    v_mfma_f32_32x32x16_bf16 v[128:143], v[40:43], a[36:39], v[128:143]
    ds_read_b128 v[36:39], v11 offset:54272
    v_cvt_pk_bf16_f32 v216, v72, v73
    v_cvt_pk_bf16_f32 v217, v74, v75
    v_cvt_pk_bf16_f32 v218, v76, v77
    v_cvt_pk_bf16_f32 v219, v78, v79
    buffer_store_dwordx4 v[216:219], v12, s[4:7], s47 offen sc1
    s_waitcnt lgkmcnt(2)
    v_mfma_f32_32x32x16_bf16 v[144:159], v[44:47], a[36:39], v[144:159]
    ds_read_b128 v[40:43], v11 offset:55296
    ds_read_b128 v[200:203], v13 offset:128
    ds_read_b128 v[204:207], v13 offset:160
    ds_read_b128 v[208:211], v13 offset:192
    ds_read_b128 v[212:215], v13 offset:224
    s_waitcnt lgkmcnt(3)
    v_fma_f32 v80, v56, v200, v80
    v_mfma_f32_32x32x16_bf16 v[128:143], v[32:35], a[40:43], v[128:143]
    ds_read_b128 v[44:47], v11 offset:56320
    v_fma_f32 v81, v56, v201, v81
    v_fma_f32 v82, v56, v202, v82
    v_fma_f32 v83, v56, v203, v83
    s_waitcnt lgkmcnt(3)
    v_fma_f32 v84, v56, v204, v84
    v_fma_f32 v85, v56, v205, v85
    v_mfma_f32_32x32x16_bf16 v[144:159], v[36:39], a[40:43], v[144:159]
    ds_read_b128 v[32:35], v11 offset:57344
    s_add_u32 m0, s34, 25600
    s_add_u32 s38, s30, 233472
    buffer_load_dwordx4 v11, s[4:7], s38 offen sc1 lds
    v_fma_f32 v86, v56, v206, v86
    v_fma_f32 v87, v56, v207, v87
    v_mul_f32 v80, v58, v80
    v_mfma_f32_32x32x16_bf16 v[128:143], v[40:43], a[44:47], v[128:143]
    ds_read_b128 v[36:39], v11 offset:58368
    v_mul_f32 v81, v58, v81
    v_mul_f32 v82, v58, v82
    v_mul_f32 v83, v58, v83
    v_mul_f32 v84, v58, v84
    v_mul_f32 v85, v58, v85
    s_waitcnt lgkmcnt(2)
    v_mfma_f32_32x32x16_bf16 v[144:159], v[44:47], a[44:47], v[144:159]
    ds_read_b128 v[40:43], v11 offset:59392
    v_mul_f32 v86, v58, v86
    v_mul_f32 v87, v58, v87
    v_exp_f32 v80, v80
    v_fma_f32 v88, v56, v208, v88
    s_waitcnt lgkmcnt(2)
    v_mfma_f32_32x32x16_bf16 v[128:143], v[32:35], a[48:51], v[128:143]
    ds_read_b128 v[44:47], v11 offset:60416
    v_exp_f32 v81, v81
    v_fma_f32 v89, v56, v209, v89
    v_exp_f32 v82, v82
    s_waitcnt lgkmcnt(2)
    v_mfma_f32_32x32x16_bf16 v[144:159], v[36:39], a[48:51], v[144:159]
    ds_read_b128 v[32:35], v11 offset:61440
    v_fma_f32 v90, v56, v210, v90
    v_exp_f32 v83, v83
    v_fma_f32 v91, v56, v211, v91
    s_waitcnt lgkmcnt(2)
    v_mfma_f32_32x32x16_bf16 v[128:143], v[40:43], a[52:55], v[128:143]
    ds_read_b128 v[36:39], v11 offset:62464
    v_exp_f32 v84, v84
    v_fma_f32 v92, v56, v212, v92
    v_exp_f32 v85, v85
    s_waitcnt lgkmcnt(2)
    v_mfma_f32_32x32x16_bf16 v[144:159], v[44:47], a[52:55], v[144:159]
    ds_read_b128 v[40:43], v11 offset:63488
    v_fma_f32 v93, v56, v213, v93
    v_exp_f32 v86, v86
    v_fma_f32 v94, v56, v214, v94
    s_waitcnt lgkmcnt(2)
    v_mfma_f32_32x32x16_bf16 v[128:143], v[32:35], a[56:59], v[128:143]
    ds_read_b128 v[44:47], v11 offset:64512
    v_exp_f32 v87, v87
    v_fma_f32 v95, v56, v215, v95
    v_fma_f32 v80, v80, v57, v57
    v_fma_f32 v81, v81, v57, v57
    s_waitcnt lgkmcnt(2)
    v_mfma_f32_32x32x16_bf16 v[144:159], v[36:39], a[56:59], v[144:159]
    s_waitcnt vmcnt(5)
    s_barrier
    ds_read_b128 v[32:35], v11 offset:0
    s_add_u32 m0, s34, 32768
    s_add_u32 s38, s30, 196608
    buffer_load_dwordx4 v11, s[4:7], s38 offen sc1 lds
    v_rcp_f32 v80, v80
    v_fma_f32 v82, v82, v57, v57
    s_waitcnt lgkmcnt(2)
    v_mfma_f32_32x32x16_bf16 v[128:143], v[40:43], a[60:63], v[128:143]
    ds_read_b128 v[36:39], v11 offset:1024
    s_add_u32 m0, s34, 33792
    s_add_u32 s38, s30, 237568
    buffer_load_dwordx4 v11, s[4:7], s38 offen sc1 lds
    v_rcp_f32 v81, v81
    v_fma_f32 v83, v83, v57, v57
    s_waitcnt lgkmcnt(2)
    v_mfma_f32_32x32x16_bf16 v[144:159], v[44:47], a[60:63], v[144:159]
    ds_read_b128 v[40:43], v11 offset:2048
    v_rcp_f32 v82, v82
    v_fma_f32 v84, v84, v57, v57
    v_rcp_f32 v83, v83
    s_waitcnt lgkmcnt(2)
    v_mfma_f32_32x32x16_bf16 v[128:143], v[32:35], a[64:67], v[128:143]
    ds_read_b128 v[44:47], v11 offset:3072
    s_add_u32 m0, s34, 40960
    s_add_u32 s38, s30, 200704
    buffer_load_dwordx4 v11, s[4:7], s38 offen sc1 lds
    v_fma_f32 v85, v85, v57, v57
    v_rcp_f32 v84, v84
    s_waitcnt lgkmcnt(2)
    v_mfma_f32_32x32x16_bf16 v[144:159], v[36:39], a[64:67], v[144:159]
    ds_read_b128 v[32:35], v11 offset:4096
    v_fma_f32 v86, v86, v57, v57
    v_rcp_f32 v85, v85
    v_fma_f32 v87, v87, v57, v57
    s_waitcnt lgkmcnt(2)
    v_mfma_f32_32x32x16_bf16 v[128:143], v[40:43], a[68:71], v[128:143]
    ds_read_b128 v[36:39], v11 offset:5120
    v_rcp_f32 v86, v86
    v_rcp_f32 v87, v87
    v_mul_f32 v88, v88, v80
    s_waitcnt lgkmcnt(2)
    v_mfma_f32_32x32x16_bf16 v[144:159], v[44:47], a[68:71], v[144:159]
    ds_read_b128 v[40:43], v11 offset:6144
    s_add_u32 m0, s34, 41984
    s_add_u32 s38, s30, 241664
    buffer_load_dwordx4 v11, s[4:7], s38 offen sc1 lds
    v_mul_f32 v89, v89, v81
    v_mul_f32 v90, v90, v82
    v_mul_f32 v91, v91, v83
    s_waitcnt lgkmcnt(2)
    v_mfma_f32_32x32x16_bf16 v[128:143], v[32:35], a[72:75], v[128:143]
    ds_read_b128 v[44:47], v11 offset:7168
    v_mul_f32 v92, v92, v84
    v_mul_f32 v93, v93, v85
    v_mul_f32 v94, v94, v86
    v_mul_f32 v95, v95, v87
    v_cvt_pk_bf16_f32 v220, v88, v89
    s_waitcnt lgkmcnt(2)
    v_mfma_f32_32x32x16_bf16 v[144:159], v[36:39], a[72:75], v[144:159]
    ds_read_b128 v[32:35], v11 offset:8192
    v_cvt_pk_bf16_f32 v221, v90, v91
    v_cvt_pk_bf16_f32 v222, v92, v93
    v_cvt_pk_bf16_f32 v223, v94, v95
    buffer_store_dwordx4 v[220:223], v12, s[4:7], s48 offen sc1
    ds_read_b128 v[200:203], v13 offset:256
    s_waitcnt lgkmcnt(3)
    v_mfma_f32_32x32x16_bf16 v[128:143], v[40:43], a[76:79], v[128:143]
    ds_read_b128 v[36:39], v11 offset:9216
    ds_read_b128 v[204:207], v13 offset:288
    ds_read_b128 v[208:211], v13 offset:320
    ds_read_b128 v[212:215], v13 offset:352
    s_waitcnt lgkmcnt(4)
    v_fma_f32 v96, v56, v200, v96
    v_fma_f32 v97, v56, v201, v97
    v_mfma_f32_32x32x16_bf16 v[144:159], v[44:47], a[76:79], v[144:159]
    ds_read_b128 v[40:43], v11 offset:10240
    v_fma_f32 v98, v56, v202, v98
    v_fma_f32 v99, v56, v203, v99
    s_waitcnt lgkmcnt(3)
    v_fma_f32 v100, v56, v204, v100
    v_fma_f32 v101, v56, v205, v101
    v_fma_f32 v102, v56, v206, v102
    v_mfma_f32_32x32x16_bf16 v[128:143], v[32:35], a[80:83], v[128:143]
    ds_read_b128 v[44:47], v11 offset:11264
    v_fma_f32 v103, v56, v207, v103
    v_mul_f32 v96, v58, v96
    v_mul_f32 v97, v58, v97
    v_mul_f32 v98, v58, v98
    v_mul_f32 v99, v58, v99
    v_mfma_f32_32x32x16_bf16 v[144:159], v[36:39], a[80:83], v[144:159]
    ds_read_b128 v[32:35], v11 offset:12288
    v_mul_f32 v100, v58, v100
    v_mul_f32 v101, v58, v101
    v_mul_f32 v102, v58, v102
    v_mul_f32 v103, v58, v103
    s_waitcnt lgkmcnt(2)
    v_mfma_f32_32x32x16_bf16 v[128:143], v[40:43], a[84:87], v[128:143]
    ds_read_b128 v[36:39], v11 offset:13312
    v_exp_f32 v96, v96
    v_fma_f32 v104, v56, v208, v104
    v_exp_f32 v97, v97
    s_waitcnt lgkmcnt(2)
    v_mfma_f32_32x32x16_bf16 v[144:159], v[44:47], a[84:87], v[144:159]
    ds_read_b128 v[40:43], v11 offset:14336
    v_fma_f32 v105, v56, v209, v105
    v_exp_f32 v98, v98
    v_fma_f32 v106, v56, v210, v106
    s_waitcnt lgkmcnt(2)
    v_mfma_f32_32x32x16_bf16 v[128:143], v[32:35], a[88:91], v[128:143]
    ds_read_b128 v[44:47], v11 offset:15360
    v_exp_f32 v99, v99
    v_fma_f32 v107, v56, v211, v107
    v_exp_f32 v100, v100
    s_waitcnt lgkmcnt(2)
    v_mfma_f32_32x32x16_bf16 v[144:159], v[36:39], a[88:91], v[144:159]
    s_waitcnt vmcnt(5)
    s_barrier
    ds_read_b128 v[32:35], v11 offset:16384
    s_add_u32 m0, s33, 49152
    s_add_u32 s38, s30, 245760
    buffer_load_dwordx4 v11, s[4:7], s38 offen sc1 lds
    v_fma_f32 v108, v56, v212, v108
    v_exp_f32 v101, v101
    s_waitcnt lgkmcnt(2)
    v_mfma_f32_32x32x16_bf16 v[128:143], v[40:43], a[92:95], v[128:143]
    ds_read_b128 v[36:39], v11 offset:17408
    s_add_u32 m0, s33, 53248
    s_add_u32 s38, s30, 249856
    buffer_load_dwordx4 v11, s[4:7], s38 offen sc1 lds
    v_fma_f32 v109, v56, v213, v109
    v_exp_f32 v102, v102
    s_waitcnt lgkmcnt(2)
    v_mfma_f32_32x32x16_bf16 v[144:159], v[44:47], a[92:95], v[144:159]
    ds_read_b128 v[40:43], v11 offset:18432
    v_fma_f32 v110, v56, v214, v110
    v_exp_f32 v103, v103
    v_fma_f32 v111, v56, v215, v111
    v_fma_f32 v96, v96, v57, v57
    s_waitcnt lgkmcnt(2)
    v_mfma_f32_32x32x16_bf16 v[128:143], v[32:35], a[96:99], v[128:143]
    ds_read_b128 v[44:47], v11 offset:19456
    v_fma_f32 v97, v97, v57, v57
    v_rcp_f32 v96, v96
    v_fma_f32 v98, v98, v57, v57
    s_waitcnt lgkmcnt(2)
    v_mfma_f32_32x32x16_bf16 v[144:159], v[36:39], a[96:99], v[144:159]
    ds_read_b128 v[32:35], v11 offset:20480
    v_rcp_f32 v97, v97
    v_fma_f32 v99, v99, v57, v57
    v_rcp_f32 v98, v98
    s_waitcnt lgkmcnt(2)
    v_mfma_f32_32x32x16_bf16 v[128:143], v[40:43], a[100:103], v[128:143]
    ds_read_b128 v[36:39], v11 offset:21504
    v_fma_f32 v100, v100, v57, v57
    v_rcp_f32 v99, v99
    v_fma_f32 v101, v101, v57, v57
    s_waitcnt lgkmcnt(2)
    v_mfma_f32_32x32x16_bf16 v[144:159], v[44:47], a[100:103], v[144:159]
    ds_read_b128 v[40:43], v11 offset:22528
    v_rcp_f32 v100, v100
    v_fma_f32 v102, v102, v57, v57
    v_rcp_f32 v101, v101
    s_waitcnt lgkmcnt(2)
    v_mfma_f32_32x32x16_bf16 v[128:143], v[32:35], a[104:107], v[128:143]
    ds_read_b128 v[44:47], v11 offset:23552
    v_fma_f32 v103, v103, v57, v57
    v_rcp_f32 v102, v102
    v_rcp_f32 v103, v103
    s_waitcnt lgkmcnt(2)
    v_mfma_f32_32x32x16_bf16 v[144:159], v[36:39], a[104:107], v[144:159]
    ds_read_b128 v[32:35], v11 offset:24576
    v_mul_f32 v104, v104, v96
    v_mul_f32 v105, v105, v97
    v_mul_f32 v106, v106, v98
    v_mul_f32 v107, v107, v99
    v_mul_f32 v108, v108, v100
    s_waitcnt lgkmcnt(2)
    v_mfma_f32_32x32x16_bf16 v[128:143], v[40:43], a[108:111], v[128:143]
    ds_read_b128 v[36:39], v11 offset:25600
    v_mul_f32 v109, v109, v101
    v_mul_f32 v110, v110, v102
    v_mul_f32 v111, v111, v103
    v_cvt_pk_bf16_f32 v216, v104, v105
    v_cvt_pk_bf16_f32 v217, v106, v107
    s_waitcnt lgkmcnt(2)
    v_mfma_f32_32x32x16_bf16 v[144:159], v[44:47], a[108:111], v[144:159]
    ds_read_b128 v[40:43], v11 offset:26624
    v_cvt_pk_bf16_f32 v218, v108, v109
    v_cvt_pk_bf16_f32 v219, v110, v111
    buffer_store_dwordx4 v[216:219], v12, s[4:7], s49 offen sc1
    ds_read_b128 v[200:203], v13 offset:384
    ds_read_b128 v[204:207], v13 offset:416
    s_waitcnt lgkmcnt(4)
    v_mfma_f32_32x32x16_bf16 v[128:143], v[32:35], a[112:115], v[128:143]
    ds_read_b128 v[44:47], v11 offset:27648
    ds_read_b128 v[208:211], v13 offset:448
    ds_read_b128 v[212:215], v13 offset:480
    s_waitcnt lgkmcnt(4)
    v_fma_f32 v112, v56, v200, v112
    v_fma_f32 v113, v56, v201, v113
    v_fma_f32 v114, v56, v202, v114
    v_mfma_f32_32x32x16_bf16 v[144:159], v[36:39], a[112:115], v[144:159]
    ds_read_b128 v[32:35], v11 offset:28672
    v_fma_f32 v115, v56, v203, v115
    s_waitcnt lgkmcnt(4)
    v_fma_f32 v116, v56, v204, v116
    v_fma_f32 v117, v56, v205, v117
    v_fma_f32 v118, v56, v206, v118
    v_fma_f32 v119, v56, v207, v119
    v_mfma_f32_32x32x16_bf16 v[128:143], v[40:43], a[116:119], v[128:143]
    ds_read_b128 v[36:39], v11 offset:29696
    v_mul_f32 v112, v58, v112
    v_mul_f32 v113, v58, v113
    v_mul_f32 v114, v58, v114
    v_mul_f32 v115, v58, v115
    v_mul_f32 v116, v58, v116
    s_waitcnt lgkmcnt(4)
    v_mfma_f32_32x32x16_bf16 v[144:159], v[44:47], a[116:119], v[144:159]
    ds_read_b128 v[40:43], v11 offset:30720
    v_mul_f32 v117, v58, v117
    v_mul_f32 v118, v58, v118
    v_mul_f32 v119, v58, v119
    v_exp_f32 v112, v112
    s_waitcnt lgkmcnt(2)
    v_mfma_f32_32x32x16_bf16 v[128:143], v[32:35], a[120:123], v[128:143]
    ds_read_b128 v[44:47], v11 offset:31744
    v_fma_f32 v120, v56, v208, v120
    v_exp_f32 v113, v113
    v_fma_f32 v121, v56, v209, v121
    s_waitcnt lgkmcnt(2)
    v_mfma_f32_32x32x16_bf16 v[144:159], v[36:39], a[120:123], v[144:159]
    s_waitcnt vmcnt(4)
    s_barrier
    ds_read_b128 v[32:35], v11 offset:32768
    s_add_u32 m0, s33, 0
    s_add_u32 s38, s30, 253952
    buffer_load_dwordx4 v11, s[4:7], s38 offen sc1 lds
    v_exp_f32 v114, v114
    v_fma_f32 v122, v56, v210, v122
    s_waitcnt lgkmcnt(2)
    v_mfma_f32_32x32x16_bf16 v[128:143], v[40:43], a[124:127], v[128:143]
    ds_read_b128 v[36:39], v11 offset:33792
    s_add_u32 m0, s33, 4096
    s_add_u32 s38, s30, 258048
    buffer_load_dwordx4 v11, s[4:7], s38 offen sc1 lds
    v_exp_f32 v115, v115
    v_fma_f32 v123, v56, v211, v123
    s_waitcnt lgkmcnt(2)
    v_mfma_f32_32x32x16_bf16 v[144:159], v[44:47], a[124:127], v[144:159]
    ds_read_b128 v[40:43], v11 offset:34816
    v_exp_f32 v116, v116
    v_fma_f32 v124, v56, v212, v124
    v_exp_f32 v117, v117
    s_waitcnt lgkmcnt(2)
    v_mfma_f32_32x32x16_bf16 v[128:143], v[32:35], a[128:131], v[128:143]
    ds_read_b128 v[44:47], v11 offset:35840
    v_fma_f32 v125, v56, v213, v125
    v_exp_f32 v118, v118
    v_fma_f32 v126, v56, v214, v126
    s_waitcnt lgkmcnt(2)
    v_mfma_f32_32x32x16_bf16 v[144:159], v[36:39], a[128:131], v[144:159]
    ds_read_b128 v[32:35], v11 offset:36864
    v_exp_f32 v119, v119
    v_fma_f32 v127, v56, v215, v127
    v_fma_f32 v112, v112, v57, v57
    v_fma_f32 v113, v113, v57, v57
    s_waitcnt lgkmcnt(2)
    v_mfma_f32_32x32x16_bf16 v[128:143], v[40:43], a[132:135], v[128:143]
    ds_read_b128 v[36:39], v11 offset:37888
    v_rcp_f32 v112, v112
    v_fma_f32 v114, v114, v57, v57
    v_rcp_f32 v113, v113
    s_waitcnt lgkmcnt(2)
    v_mfma_f32_32x32x16_bf16 v[144:159], v[44:47], a[132:135], v[144:159]
    ds_read_b128 v[40:43], v11 offset:38912
    v_fma_f32 v115, v115, v57, v57
    v_rcp_f32 v114, v114
    v_fma_f32 v116, v116, v57, v57
    s_waitcnt lgkmcnt(2)
    v_mfma_f32_32x32x16_bf16 v[128:143], v[32:35], a[136:139], v[128:143]
    ds_read_b128 v[44:47], v11 offset:39936
    v_rcp_f32 v115, v115
    v_fma_f32 v117, v117, v57, v57
    v_rcp_f32 v116, v116
    s_waitcnt lgkmcnt(2)
    v_mfma_f32_32x32x16_bf16 v[144:159], v[36:39], a[136:139], v[144:159]
    ds_read_b128 v[32:35], v11 offset:40960
    v_fma_f32 v118, v118, v57, v57
    v_rcp_f32 v117, v117
    v_fma_f32 v119, v119, v57, v57
    s_waitcnt lgkmcnt(2)
    v_mfma_f32_32x32x16_bf16 v[128:143], v[40:43], a[140:143], v[128:143]
    ds_read_b128 v[36:39], v11 offset:41984
    v_rcp_f32 v118, v118
    v_rcp_f32 v119, v119
    v_mul_f32 v120, v120, v112
    s_waitcnt lgkmcnt(2)
    v_mfma_f32_32x32x16_bf16 v[144:159], v[44:47], a[140:143], v[144:159]
    ds_read_b128 v[40:43], v11 offset:43008
    v_mul_f32 v121, v121, v113
    v_mul_f32 v122, v122, v114
    v_mul_f32 v123, v123, v115
    v_mul_f32 v124, v124, v116
    v_mul_f32 v125, v125, v117
    s_waitcnt lgkmcnt(2)
    v_mfma_f32_32x32x16_bf16 v[128:143], v[32:35], a[144:147], v[128:143]
    ds_read_b128 v[44:47], v11 offset:44032
    v_mul_f32 v126, v126, v118
    v_mul_f32 v127, v127, v119
    v_cvt_pk_bf16_f32 v220, v120, v121
    v_cvt_pk_bf16_f32 v221, v122, v123
    v_cvt_pk_bf16_f32 v222, v124, v125
    s_waitcnt lgkmcnt(2)
    v_mfma_f32_32x32x16_bf16 v[144:159], v[36:39], a[144:147], v[144:159]
    ds_read_b128 v[32:35], v11 offset:45056
    v_cvt_pk_bf16_f32 v223, v126, v127
    buffer_store_dwordx4 v[220:223], v12, s[4:7], s66 offen sc1
    s_waitcnt lgkmcnt(2)
    v_mfma_f32_32x32x16_bf16 v[128:143], v[40:43], a[148:151], v[128:143]
    ds_read_b128 v[36:39], v11 offset:46080
    s_waitcnt lgkmcnt(2)
    v_mfma_f32_32x32x16_bf16 v[144:159], v[44:47], a[148:151], v[144:159]
    ds_read_b128 v[40:43], v11 offset:47104
    s_waitcnt lgkmcnt(2)
    v_mfma_f32_32x32x16_bf16 v[128:143], v[32:35], a[152:155], v[128:143]
    ds_read_b128 v[44:47], v11 offset:48128
    s_waitcnt lgkmcnt(2)
    v_mfma_f32_32x32x16_bf16 v[144:159], v[36:39], a[152:155], v[144:159]
    s_waitcnt vmcnt(4)
    s_barrier
    ds_read_b128 v[32:35], v11 offset:49152
    s_add_u32 m0, s33, 16384
    s_add_u32 s38, s30, 262144
    buffer_load_dwordx4 v11, s[4:7], s38 offen sc1 lds
    s_waitcnt lgkmcnt(2)
    v_mfma_f32_32x32x16_bf16 v[128:143], v[40:43], a[156:159], v[128:143]
    ds_read_b128 v[36:39], v11 offset:50176
    s_add_u32 m0, s33, 20480
    s_add_u32 s38, s30, 266240
    buffer_load_dwordx4 v11, s[4:7], s38 offen sc1 lds
    s_waitcnt lgkmcnt(2)
    v_mfma_f32_32x32x16_bf16 v[144:159], v[44:47], a[156:159], v[144:159]
    ds_read_b128 v[40:43], v11 offset:51200
    s_waitcnt lgkmcnt(2)
    v_mfma_f32_32x32x16_bf16 v[64:79], v[32:35], a[0:3], 0
    ds_read_b128 v[44:47], v11 offset:52224
    ds_read_b128 v[200:203], v13 offset:512
    ds_read_b128 v[204:207], v13 offset:544
    ds_read_b128 v[208:211], v13 offset:576
    ds_read_b128 v[212:215], v13 offset:608
    s_waitcnt lgkmcnt(3)
    v_fma_f32 v128, v56, v200, v128
    v_mfma_f32_32x32x16_bf16 v[64:79], v[36:39], a[4:7], v[64:79]
    ds_read_b128 v[32:35], v11 offset:53248
    v_fma_f32 v129, v56, v201, v129
    v_fma_f32 v130, v56, v202, v130
    v_fma_f32 v131, v56, v203, v131
    s_waitcnt lgkmcnt(3)
    v_fma_f32 v132, v56, v204, v132
    v_fma_f32 v133, v56, v205, v133
    v_mfma_f32_32x32x16_bf16 v[64:79], v[40:43], a[8:11], v[64:79]
    ds_read_b128 v[36:39], v11 offset:54272
    v_fma_f32 v134, v56, v206, v134
    v_fma_f32 v135, v56, v207, v135
    v_mul_f32 v128, v58, v128
    v_mul_f32 v129, v58, v129
    v_mul_f32 v130, v58, v130
    v_mfma_f32_32x32x16_bf16 v[64:79], v[44:47], a[12:15], v[64:79]
    ds_read_b128 v[40:43], v11 offset:55296
    v_mul_f32 v131, v58, v131
    v_mul_f32 v132, v58, v132
    v_mul_f32 v133, v58, v133
    v_mul_f32 v134, v58, v134
    v_mul_f32 v135, v58, v135
    s_waitcnt lgkmcnt(2)
    v_mfma_f32_32x32x16_bf16 v[64:79], v[32:35], a[16:19], v[64:79]
    ds_read_b128 v[44:47], v11 offset:56320
    v_exp_f32 v128, v128
    v_fma_f32 v136, v56, v208, v136
    v_exp_f32 v129, v129
    s_waitcnt lgkmcnt(2)
    v_mfma_f32_32x32x16_bf16 v[64:79], v[36:39], a[20:23], v[64:79]
    s_waitcnt vmcnt(3)
    s_barrier
    ds_read_b128 v[32:35], v11 offset:0
    s_add_u32 m0, s33, 32768
    s_add_u32 s38, s30, 270336
    buffer_load_dwordx4 v11, s[4:7], s38 offen sc1 lds
    v_fma_f32 v137, v56, v209, v137
    v_exp_f32 v130, v130
    s_waitcnt lgkmcnt(2)
    v_mfma_f32_32x32x16_bf16 v[64:79], v[40:43], a[24:27], v[64:79]
    ds_read_b128 v[36:39], v11 offset:1024
    s_add_u32 m0, s33, 36864
    s_add_u32 s38, s30, 274432
    buffer_load_dwordx4 v11, s[4:7], s38 offen sc1 lds
    v_fma_f32 v138, v56, v210, v138
    v_exp_f32 v131, v131
    s_waitcnt lgkmcnt(2)
    v_mfma_f32_32x32x16_bf16 v[64:79], v[44:47], a[28:31], v[64:79]
    ds_read_b128 v[40:43], v11 offset:2048
    v_fma_f32 v139, v56, v211, v139
    v_exp_f32 v132, v132
    v_fma_f32 v140, v56, v212, v140
    s_waitcnt lgkmcnt(2)
    v_mfma_f32_32x32x16_bf16 v[64:79], v[32:35], a[32:35], v[64:79]
    ds_read_b128 v[44:47], v11 offset:3072
    v_exp_f32 v133, v133
    v_fma_f32 v141, v56, v213, v141
    v_exp_f32 v134, v134
    s_waitcnt lgkmcnt(2)
    v_mfma_f32_32x32x16_bf16 v[64:79], v[36:39], a[36:39], v[64:79]
    ds_read_b128 v[32:35], v11 offset:4096
    v_fma_f32 v142, v56, v214, v142
    v_exp_f32 v135, v135
    v_fma_f32 v143, v56, v215, v143
    v_fma_f32 v128, v128, v57, v57
    s_waitcnt lgkmcnt(2)
    v_mfma_f32_32x32x16_bf16 v[64:79], v[40:43], a[40:43], v[64:79]
    ds_read_b128 v[36:39], v11 offset:5120
    v_fma_f32 v129, v129, v57, v57
    v_rcp_f32 v128, v128
    v_fma_f32 v130, v130, v57, v57
    s_waitcnt lgkmcnt(2)
    v_mfma_f32_32x32x16_bf16 v[64:79], v[44:47], a[44:47], v[64:79]
    ds_read_b128 v[40:43], v11 offset:6144
    v_rcp_f32 v129, v129
    v_fma_f32 v131, v131, v57, v57
    v_rcp_f32 v130, v130
    s_waitcnt lgkmcnt(2)
    v_mfma_f32_32x32x16_bf16 v[64:79], v[32:35], a[48:51], v[64:79]
    ds_read_b128 v[44:47], v11 offset:7168
    v_fma_f32 v132, v132, v57, v57
    v_rcp_f32 v131, v131
    v_fma_f32 v133, v133, v57, v57
    s_waitcnt lgkmcnt(2)
    v_mfma_f32_32x32x16_bf16 v[64:79], v[36:39], a[52:55], v[64:79]
    s_waitcnt vmcnt(4)
    s_waitcnt vmcnt(2)
    s_barrier
    s_cmp_eq_u32 s20, 0
    s_cbranch_scc1 L68_ct
    s_getpc_b64 s[58:59]
L69_cp:
    s_sub_u32 s60, s20, 1
    s_lshl_b32 s60, s60, 13
    v_lshlrev_b32 v254, 7, v0
    v_add_u32 v254, s60, v254
    s_mov_b32 s60, L_exit-L69_cp
    v_min_u32 v254, s60, v254
    v_mov_b32 v255, s59
    v_add_co_u32 v254, vcc, s58, v254
    s_nop 1
    v_addc_co_u32 v255, vcc, 0, v255, vcc
    global_load_dword v60, v[254:255], off
L68_ct:
    s_lshl_b32 s61, s73, 8
    s_add_u32 s61, s61, 34416640
    s_cmp_lg_u32 s20, 0
    s_cbranch_scc1 L70_ol
    s_mov_b64 exec, 1
    v_mov_b32 v254, 1
    v_mov_b32 v255, 0
    buffer_atomic_add v254, v255, s[4:7], s61 offen sc1
    s_mov_b64 exec, -1
L70_ol:
    ds_read_b128 v[32:35], v11 offset:16384
    s_add_u32 m0, s33, 49152
    s_add_u32 s38, s30, 278528
    buffer_load_dwordx4 v11, s[4:7], s38 offen sc1 lds
    v_rcp_f32 v132, v132
    v_fma_f32 v134, v134, v57, v57
    s_waitcnt lgkmcnt(2)
    v_mfma_f32_32x32x16_bf16 v[64:79], v[40:43], a[56:59], v[64:79]
    ds_read_b128 v[36:39], v11 offset:17408
    s_add_u32 m0, s33, 53248
    s_add_u32 s38, s30, 282624
    buffer_load_dwordx4 v11, s[4:7], s38 offen sc1 lds
    v_rcp_f32 v133, v133
    v_fma_f32 v135, v135, v57, v57
    s_waitcnt lgkmcnt(2)
    v_mfma_f32_32x32x16_bf16 v[64:79], v[44:47], a[60:63], v[64:79]
    ds_read_b128 v[40:43], v11 offset:18432
    v_rcp_f32 v134, v134
    v_rcp_f32 v135, v135
    v_mul_f32 v136, v136, v128
    s_waitcnt lgkmcnt(2)
    v_mfma_f32_32x32x16_bf16 v[64:79], v[32:35], a[64:67], v[64:79]
    ds_read_b128 v[44:47], v11 offset:19456
    v_mul_f32 v137, v137, v129
    v_mul_f32 v138, v138, v130
    v_mul_f32 v139, v139, v131
    v_mul_f32 v140, v140, v132
    v_mul_f32 v141, v141, v133
    s_waitcnt lgkmcnt(2)
    v_mfma_f32_32x32x16_bf16 v[64:79], v[36:39], a[68:71], v[64:79]
    ds_read_b128 v[32:35], v11 offset:20480
    v_mul_f32 v142, v142, v134
    v_mul_f32 v143, v143, v135
    v_cvt_pk_bf16_f32 v216, v136, v137
    v_cvt_pk_bf16_f32 v217, v138, v139
    v_cvt_pk_bf16_f32 v218, v140, v141
    s_waitcnt lgkmcnt(2)
    v_mfma_f32_32x32x16_bf16 v[64:79], v[40:43], a[72:75], v[64:79]
    ds_read_b128 v[36:39], v11 offset:21504
    v_cvt_pk_bf16_f32 v219, v142, v143
    buffer_store_dwordx4 v[216:219], v12, s[4:7], s67 offen sc1
    ds_read_b128 v[200:203], v13 offset:640
    ds_read_b128 v[204:207], v13 offset:672
    ds_read_b128 v[208:211], v13 offset:704
    s_waitcnt lgkmcnt(5)
    v_mfma_f32_32x32x16_bf16 v[64:79], v[44:47], a[76:79], v[64:79]
    ds_read_b128 v[40:43], v11 offset:22528
    ds_read_b128 v[212:215], v13 offset:736
    s_waitcnt lgkmcnt(4)
    v_fma_f32 v144, v56, v200, v144
    v_fma_f32 v145, v56, v201, v145
    v_fma_f32 v146, v56, v202, v146
    v_fma_f32 v147, v56, v203, v147
    v_mfma_f32_32x32x16_bf16 v[64:79], v[32:35], a[80:83], v[64:79]
    ds_read_b128 v[44:47], v11 offset:23552
    s_waitcnt lgkmcnt(4)
    v_fma_f32 v148, v56, v204, v148
    v_fma_f32 v149, v56, v205, v149
    v_fma_f32 v150, v56, v206, v150
    v_fma_f32 v151, v56, v207, v151
    v_mul_f32 v144, v58, v144
    v_mfma_f32_32x32x16_bf16 v[64:79], v[36:39], a[84:87], v[64:79]
    s_waitcnt vmcnt(3)
    s_barrier
    ds_read_b128 v[32:35], v11 offset:32768
    v_mul_f32 v145, v58, v145
    v_mul_f32 v146, v58, v146
    v_mul_f32 v147, v58, v147
    v_mul_f32 v148, v58, v148
    v_mul_f32 v149, v58, v149
    s_waitcnt lgkmcnt(3)
    v_mfma_f32_32x32x16_bf16 v[64:79], v[40:43], a[88:91], v[64:79]
    ds_read_b128 v[36:39], v11 offset:33792
    v_mul_f32 v150, v58, v150
    v_mul_f32 v151, v58, v151
    v_exp_f32 v144, v144
    v_fma_f32 v152, v56, v208, v152
    s_waitcnt lgkmcnt(2)
    v_mfma_f32_32x32x16_bf16 v[64:79], v[44:47], a[92:95], v[64:79]
    ds_read_b128 v[40:43], v11 offset:34816
    v_exp_f32 v145, v145
    v_fma_f32 v153, v56, v209, v153
    v_exp_f32 v146, v146
    s_waitcnt lgkmcnt(2)
    v_mfma_f32_32x32x16_bf16 v[64:79], v[32:35], a[96:99], v[64:79]
    ds_read_b128 v[44:47], v11 offset:35840
    v_fma_f32 v154, v56, v210, v154
    v_exp_f32 v147, v147
    v_fma_f32 v155, v56, v211, v155
    s_waitcnt lgkmcnt(2)
    v_mfma_f32_32x32x16_bf16 v[64:79], v[36:39], a[100:103], v[64:79]
    ds_read_b128 v[32:35], v11 offset:36864
    v_exp_f32 v148, v148
    v_fma_f32 v156, v56, v212, v156
    v_exp_f32 v149, v149
    s_waitcnt lgkmcnt(2)
    v_mfma_f32_32x32x16_bf16 v[64:79], v[40:43], a[104:107], v[64:79]
    ds_read_b128 v[36:39], v11 offset:37888
    v_fma_f32 v157, v56, v213, v157
    v_exp_f32 v150, v150
    v_fma_f32 v158, v56, v214, v158
    s_waitcnt lgkmcnt(2)
    v_mfma_f32_32x32x16_bf16 v[64:79], v[44:47], a[108:111], v[64:79]
    ds_read_b128 v[40:43], v11 offset:38912
    v_exp_f32 v151, v151
    v_fma_f32 v159, v56, v215, v159
    v_fma_f32 v144, v144, v57, v57
    v_fma_f32 v145, v145, v57, v57
    s_waitcnt lgkmcnt(2)
    v_mfma_f32_32x32x16_bf16 v[64:79], v[32:35], a[112:115], v[64:79]
    ds_read_b128 v[44:47], v11 offset:39936
    v_rcp_f32 v144, v144
    v_fma_f32 v146, v146, v57, v57
    v_rcp_f32 v145, v145
    s_waitcnt lgkmcnt(2)
    v_mfma_f32_32x32x16_bf16 v[64:79], v[36:39], a[116:119], v[64:79]
    s_waitcnt vmcnt(1)
    s_barrier
    ds_read_b128 v[32:35], v11 offset:49152
    v_fma_f32 v147, v147, v57, v57
    v_rcp_f32 v146, v146
    v_fma_f32 v148, v148, v57, v57
    s_waitcnt lgkmcnt(2)
    v_mfma_f32_32x32x16_bf16 v[64:79], v[40:43], a[120:123], v[64:79]
    ds_read_b128 v[36:39], v11 offset:50176
    v_rcp_f32 v147, v147
    v_fma_f32 v149, v149, v57, v57
    v_rcp_f32 v148, v148
    s_waitcnt lgkmcnt(2)
    v_mfma_f32_32x32x16_bf16 v[64:79], v[44:47], a[124:127], v[64:79]
    ds_read_b128 v[40:43], v11 offset:51200
    v_fma_f32 v150, v150, v57, v57
    v_rcp_f32 v149, v149
    v_fma_f32 v151, v151, v57, v57
    s_waitcnt lgkmcnt(2)
    v_mfma_f32_32x32x16_bf16 v[64:79], v[32:35], a[128:131], v[64:79]
    ds_read_b128 v[44:47], v11 offset:52224
    v_rcp_f32 v150, v150
    v_rcp_f32 v151, v151
    v_mul_f32 v152, v152, v144
    s_waitcnt lgkmcnt(2)
    v_mfma_f32_32x32x16_bf16 v[64:79], v[36:39], a[132:135], v[64:79]
    ds_read_b128 v[32:35], v11 offset:53248
    v_mul_f32 v153, v153, v145
    v_mul_f32 v154, v154, v146
    v_mul_f32 v155, v155, v147
    v_mul_f32 v156, v156, v148
    v_mul_f32 v157, v157, v149
    s_waitcnt lgkmcnt(2)
    v_mfma_f32_32x32x16_bf16 v[64:79], v[40:43], a[136:139], v[64:79]
    ds_read_b128 v[36:39], v11 offset:54272
    v_mul_f32 v158, v158, v150
    v_mul_f32 v159, v159, v151
    v_cvt_pk_bf16_f32 v220, v152, v153
    v_cvt_pk_bf16_f32 v221, v154, v155
    v_cvt_pk_bf16_f32 v222, v156, v157
    s_waitcnt lgkmcnt(2)
    v_mfma_f32_32x32x16_bf16 v[64:79], v[44:47], a[140:143], v[64:79]
    ds_read_b128 v[40:43], v11 offset:55296
    v_cvt_pk_bf16_f32 v223, v158, v159
    buffer_store_dwordx4 v[220:223], v12, s[4:7], s68 offen sc1
    s_waitcnt lgkmcnt(2)
    v_mfma_f32_32x32x16_bf16 v[64:79], v[32:35], a[144:147], v[64:79]
    ds_read_b128 v[44:47], v11 offset:56320
    s_waitcnt lgkmcnt(2)
    v_mfma_f32_32x32x16_bf16 v[64:79], v[36:39], a[148:151], v[64:79]
    s_waitcnt lgkmcnt(1)
    v_mfma_f32_32x32x16_bf16 v[64:79], v[40:43], a[152:155], v[64:79]
    s_waitcnt lgkmcnt(0)
    v_mfma_f32_32x32x16_bf16 v[64:79], v[44:47], a[156:159], v[64:79]
    ds_read_b128 v[200:203], v13 offset:768
    ds_read_b128 v[204:207], v13 offset:800
    ds_read_b128 v[208:211], v13 offset:832
    ds_read_b128 v[212:215], v13 offset:864
    s_waitcnt lgkmcnt(3)
    s_nop 6
    v_fma_f32 v64, v56, v200, v64
    v_fma_f32 v65, v56, v201, v65
    v_fma_f32 v66, v56, v202, v66
    v_fma_f32 v67, v56, v203, v67
    s_waitcnt lgkmcnt(2)
    v_fma_f32 v68, v56, v204, v68
    v_fma_f32 v69, v56, v205, v69
    v_fma_f32 v70, v56, v206, v70
    v_fma_f32 v71, v56, v207, v71
    v_mul_f32 v64, v58, v64
    v_mul_f32 v65, v58, v65
    v_mul_f32 v66, v58, v66
    v_mul_f32 v67, v58, v67
    v_mul_f32 v68, v58, v68
    v_mul_f32 v69, v58, v69
    v_mul_f32 v70, v58, v70
    v_mul_f32 v71, v58, v71
    v_exp_f32 v64, v64
    s_waitcnt lgkmcnt(1)
    v_fma_f32 v72, v56, v208, v72
    v_exp_f32 v65, v65
    v_fma_f32 v73, v56, v209, v73
    v_exp_f32 v66, v66
    v_fma_f32 v74, v56, v210, v74
    v_exp_f32 v67, v67
    v_fma_f32 v75, v56, v211, v75
    v_exp_f32 v68, v68
    s_waitcnt lgkmcnt(0)
    v_fma_f32 v76, v56, v212, v76
    v_exp_f32 v69, v69
    v_fma_f32 v77, v56, v213, v77
    v_exp_f32 v70, v70
    v_fma_f32 v78, v56, v214, v78
    v_exp_f32 v71, v71
    v_fma_f32 v79, v56, v215, v79
    v_fma_f32 v64, v64, v57, v57
    v_fma_f32 v65, v65, v57, v57
    v_rcp_f32 v64, v64
    v_fma_f32 v66, v66, v57, v57
    v_rcp_f32 v65, v65
    v_fma_f32 v67, v67, v57, v57
    v_rcp_f32 v66, v66
    v_fma_f32 v68, v68, v57, v57
    v_rcp_f32 v67, v67
    v_fma_f32 v69, v69, v57, v57
    v_rcp_f32 v68, v68
    v_fma_f32 v70, v70, v57, v57
    v_rcp_f32 v69, v69
    v_fma_f32 v71, v71, v57, v57
    v_rcp_f32 v70, v70
    v_rcp_f32 v71, v71
    v_mul_f32 v72, v72, v64
    v_mul_f32 v73, v73, v65
    v_mul_f32 v74, v74, v66
    v_mul_f32 v75, v75, v67
    s_waitcnt vmcnt(0)
    s_barrier
    s_lshl_b32 s61, s73, 8
    s_add_u32 s61, s61, 34431744
    s_cmp_lg_u32 s20, 0
    s_cbranch_scc1 L71_ol
    s_mov_b64 exec, 1
    v_mov_b32 v254, 1
    v_mov_b32 v255, 0
    buffer_atomic_add v254, v255, s[4:7], s61 offen sc1
    s_mov_b64 exec, -1
L71_ol:
    s_lshl_b32 s57, s70, 8
    s_add_u32 s57, s57, 34416640
    v_mov_b32 v236, 0
    buffer_load_dword v237, v236, s[4:7], s57 offen sc1
    v_mul_f32 v76, v76, v68
    v_mul_f32 v77, v77, v69
    v_mul_f32 v78, v78, v70
    v_mul_f32 v79, v79, v71
    v_cvt_pk_bf16_f32 v216, v72, v73
    v_cvt_pk_bf16_f32 v217, v74, v75
    v_cvt_pk_bf16_f32 v218, v76, v77
    v_cvt_pk_bf16_f32 v219, v78, v79
    buffer_store_dwordx4 v[216:219], v12, s[4:7], s69 offen sc1
    s_mov_b32 s22, s70
    s_mov_b32 s23, s71
    s_mov_b32 s24, s72
    v_and_b32 v1, 15, v0
    v_lshrrev_b32 v2, 4, v0
    s_lshl_b32 s30, s22, 1
    s_add_u32 s30, s30, s23
    s_mul_i32 s30, s30, 221184
    s_add_u32 s30, s30, 24547328
    s_mul_i32 s31, s20, 7
    s_mul_i32 s29, s20, 3
    s_add_u32 s29, s29, 21
    s_lshl_b32 s41, s20, 2
    s_add_u32 s41, s41, 30
    s_cmp_eq_u32 s20, 3
    s_cselect_b32 s28, 1, 0
    s_sub_u32 s41, s41, s28
    s_lshl_b32 s31, s31, 12
    s_add_u32 s31, s31, s30
    s_lshl_b32 s29, s29, 12
    s_add_u32 s29, s29, s30
    s_lshl_b32 s41, s41, 12
    s_add_u32 s41, s41, s30
    s_add_u32 s28, s20, 0
    s_and_b32 s28, s28, 3
    s_lshl_b32 s28, s28, 10
    s_add_u32 s32, s31, s28
    s_add_u32 s36, s29, s28
    s_add_u32 s52, s41, s28
    s_add_u32 s28, s20, 1
    s_and_b32 s28, s28, 3
    s_lshl_b32 s28, s28, 10
    s_add_u32 s33, s31, s28
    s_add_u32 s37, s29, s28
    s_add_u32 s53, s41, s28
    s_add_u32 s28, s20, 2
    s_and_b32 s28, s28, 3
    s_lshl_b32 s28, s28, 10
    s_add_u32 s34, s31, s28
    s_add_u32 s38, s29, s28
    s_add_u32 s54, s41, s28
    s_add_u32 s28, s20, 3
    s_and_b32 s28, s28, 3
    s_lshl_b32 s28, s28, 10
    s_add_u32 s35, s31, s28
    s_add_u32 s39, s29, s28
    s_add_u32 s55, s41, s28
    s_lshl_b32 s43, s23, 2
    s_add_u32 s43, s43, s20
    s_mov_b32 s62, 0
    s_waitcnt vmcnt(1)
    v_cmp_gt_u32 vcc, 16, v237
    s_nop 1
    s_cmp_eq_u64 vcc, 0
    s_cbranch_scc1 L73_apd
    s_lshl_b32 s57, s70, 8
    s_add_u32 s57, s57, 34416640
L72_ap:
    buffer_load_dword v237, v236, s[4:7], s57 offen sc1
    s_waitcnt vmcnt(0)
    v_cmp_gt_u32 vcc, 16, v237
    s_add_u32 s62, s62, 1
    s_nop 1
    s_cmp_eq_u64 vcc, 0
    s_cbranch_scc1 L73_apd
    s_cmp_lt_u32 s62, 65536
    s_cbranch_scc1 L72_ap
L73_apd:
    s_add_u32 s40, s32, 0
    buffer_load_dwordx4 a[120:123], v11, s[4:7], s40 offen sc1
    s_add_u32 s40, s33, 0
    buffer_load_dwordx4 a[124:127], v11, s[4:7], s40 offen sc1
    s_add_u32 s40, s34, 0
    buffer_load_dwordx4 a[128:131], v11, s[4:7], s40 offen sc1
    s_add_u32 s40, s35, 0
    buffer_load_dwordx4 a[132:135], v11, s[4:7], s40 offen sc1
    s_add_u32 s40, s32, 4096
    buffer_load_dwordx4 a[136:139], v11, s[4:7], s40 offen sc1
    s_add_u32 s40, s33, 4096
    buffer_load_dwordx4 a[140:143], v11, s[4:7], s40 offen sc1
    s_add_u32 s40, s34, 4096
    buffer_load_dwordx4 a[144:147], v11, s[4:7], s40 offen sc1
    s_add_u32 s40, s35, 4096
    buffer_load_dwordx4 a[148:151], v11, s[4:7], s40 offen sc1
    s_add_u32 s40, s32, 8192
    buffer_load_dwordx4 v[144:147], v11, s[4:7], s40 offen sc1
    s_add_u32 s40, s33, 8192
    buffer_load_dwordx4 v[148:151], v11, s[4:7], s40 offen sc1
    s_add_u32 s40, s34, 8192
    buffer_load_dwordx4 v[152:155], v11, s[4:7], s40 offen sc1
    s_add_u32 s40, s35, 8192
    buffer_load_dwordx4 v[156:159], v11, s[4:7], s40 offen sc1
    s_waitcnt vmcnt(12)
    s_barrier
    s_lshl_b32 s61, s73, 8
    s_add_u32 s61, s61, 34390016
    s_cmp_lg_u32 s20, 0
    s_cbranch_scc1 L74_ol
    s_mov_b64 exec, 1
    v_mov_b32 v254, 1
    v_mov_b32 v255, 0
    buffer_atomic_add v254, v255, s[4:7], s61 offen sc1
    s_mov_b64 exec, -1
L74_ol:
    v_mul_u32_u24 v5, 163840, v1
    v_lshl_add_u32 v12, v2, 3, v5
    v_add_u32 v13, s100, v11
    s_waitcnt vmcnt(11)
    v_mfma_f32_16x16x32_bf16 v[64:67], a[160:163], a[120:123], 0
    s_add_u32 s40, s32, 12288
    buffer_load_dwordx4 v[200:203], v11, s[4:7], s40 offen sc1
    s_waitcnt vmcnt(11)
    v_mfma_f32_16x16x32_bf16 v[84:87], a[160:163], a[124:127], 0
    s_add_u32 s40, s33, 12288
    buffer_load_dwordx4 v[204:207], v11, s[4:7], s40 offen sc1
    s_waitcnt vmcnt(11)
    v_mfma_f32_16x16x32_bf16 v[104:107], a[160:163], a[128:131], 0
    s_add_u32 s40, s34, 12288
    buffer_load_dwordx4 v[208:211], v11, s[4:7], s40 offen sc1
    s_waitcnt vmcnt(11)
    v_mfma_f32_16x16x32_bf16 v[124:127], a[160:163], a[132:135], 0
    s_add_u32 s40, s35, 12288
    buffer_load_dwordx4 v[212:215], v11, s[4:7], s40 offen sc1
    v_mfma_f32_16x16x32_bf16 v[68:71], a[164:167], a[120:123], 0
    s_add_u32 s45, s101, 63488
    buffer_load_dwordx4 a[0:3], v11, s[4:7], s45 offen sc1
    v_mfma_f32_16x16x32_bf16 v[88:91], a[164:167], a[124:127], 0
    s_add_u32 s45, s101, 64512
    buffer_load_dwordx4 a[4:7], v11, s[4:7], s45 offen sc1
    v_mfma_f32_16x16x32_bf16 v[108:111], a[164:167], a[128:131], 0
    s_add_u32 s45, s101, 65536
    buffer_load_dwordx4 a[8:11], v11, s[4:7], s45 offen sc1
    v_mfma_f32_16x16x32_bf16 v[128:131], a[164:167], a[132:135], 0
    s_add_u32 s45, s101, 66560
    buffer_load_dwordx4 a[12:15], v11, s[4:7], s45 offen sc1
    v_mfma_f32_16x16x32_bf16 v[72:75], a[168:171], a[120:123], 0
    s_add_u32 s45, s101, 67584
    buffer_load_dwordx4 a[16:19], v11, s[4:7], s45 offen sc1
    v_mfma_f32_16x16x32_bf16 v[92:95], a[168:171], a[124:127], 0
    s_add_u32 s45, s101, 68608
    buffer_load_dwordx4 a[20:23], v11, s[4:7], s45 offen sc1
    v_mfma_f32_16x16x32_bf16 v[112:115], a[168:171], a[128:131], 0
    v_mfma_f32_16x16x32_bf16 v[132:135], a[168:171], a[132:135], 0
    v_mfma_f32_16x16x32_bf16 v[76:79], a[172:175], a[120:123], 0
    v_mfma_f32_16x16x32_bf16 v[96:99], a[172:175], a[124:127], 0
    v_mfma_f32_16x16x32_bf16 v[116:119], a[172:175], a[128:131], 0
    v_mfma_f32_16x16x32_bf16 v[136:139], a[172:175], a[132:135], 0
    v_mfma_f32_16x16x32_bf16 v[80:83], a[176:179], a[120:123], 0
    v_mfma_f32_16x16x32_bf16 v[100:103], a[176:179], a[124:127], 0
    v_mfma_f32_16x16x32_bf16 v[120:123], a[176:179], a[128:131], 0
    v_mfma_f32_16x16x32_bf16 v[140:143], a[176:179], a[132:135], 0
    s_lshl_b32 s57, s70, 8
    s_add_u32 s57, s57, 34431744
    v_mov_b32 v236, 0
    buffer_load_dword v237, v236, s[4:7], s57 offen sc1
    s_waitcnt vmcnt(18)
    v_mfma_f32_16x16x32_bf16 v[64:67], a[180:183], a[136:139], v[64:67]
    s_waitcnt vmcnt(17)
    v_mfma_f32_16x16x32_bf16 v[84:87], a[180:183], a[140:143], v[84:87]
    s_add_u32 s40, s32, 16384
    buffer_load_dwordx4 v[216:219], v11, s[4:7], s40 offen sc1
    s_waitcnt vmcnt(17)
    v_mfma_f32_16x16x32_bf16 v[104:107], a[180:183], a[144:147], v[104:107]
    s_waitcnt vmcnt(16)
    v_mfma_f32_16x16x32_bf16 v[124:127], a[180:183], a[148:151], v[124:127]
    s_add_u32 s40, s33, 16384
    buffer_load_dwordx4 v[220:223], v11, s[4:7], s40 offen sc1
    v_mfma_f32_16x16x32_bf16 v[68:71], a[184:187], a[136:139], v[68:71]
    v_mfma_f32_16x16x32_bf16 v[88:91], a[184:187], a[140:143], v[88:91]
    s_add_u32 s40, s34, 16384
    buffer_load_dwordx4 a[152:155], v11, s[4:7], s40 offen sc1
    v_mfma_f32_16x16x32_bf16 v[108:111], a[184:187], a[144:147], v[108:111]
    v_mfma_f32_16x16x32_bf16 v[128:131], a[184:187], a[148:151], v[128:131]
    s_add_u32 s40, s35, 16384
    buffer_load_dwordx4 a[156:159], v11, s[4:7], s40 offen sc1
    v_mfma_f32_16x16x32_bf16 v[72:75], a[188:191], a[136:139], v[72:75]
    v_mfma_f32_16x16x32_bf16 v[92:95], a[188:191], a[140:143], v[92:95]
    s_add_u32 s45, s101, 69632
    buffer_load_dwordx4 a[24:27], v11, s[4:7], s45 offen sc1
    v_mfma_f32_16x16x32_bf16 v[112:115], a[188:191], a[144:147], v[112:115]
    v_mfma_f32_16x16x32_bf16 v[132:135], a[188:191], a[148:151], v[132:135]
    s_add_u32 s45, s101, 70656
    buffer_load_dwordx4 a[28:31], v11, s[4:7], s45 offen sc1
    v_mfma_f32_16x16x32_bf16 v[76:79], a[192:195], a[136:139], v[76:79]
    v_mfma_f32_16x16x32_bf16 v[96:99], a[192:195], a[140:143], v[96:99]
    v_mfma_f32_16x16x32_bf16 v[116:119], a[192:195], a[144:147], v[116:119]
    v_mfma_f32_16x16x32_bf16 v[136:139], a[192:195], a[148:151], v[136:139]
    v_mfma_f32_16x16x32_bf16 v[80:83], a[196:199], a[136:139], v[80:83]
    v_mfma_f32_16x16x32_bf16 v[100:103], a[196:199], a[140:143], v[100:103]
    v_mfma_f32_16x16x32_bf16 v[120:123], a[196:199], a[144:147], v[120:123]
    v_mfma_f32_16x16x32_bf16 v[140:143], a[196:199], a[148:151], v[140:143]
    s_mov_b32 s62, 0
    s_waitcnt vmcnt(6)
    v_cmp_gt_u32 vcc, 16, v237
    s_nop 1
    s_cmp_eq_u64 vcc, 0
    s_cbranch_scc1 L77_apd
    s_lshl_b32 s57, s70, 8
    s_add_u32 s57, s57, 34431744
L76_ap:
    buffer_load_dword v237, v236, s[4:7], s57 offen sc1
    s_waitcnt vmcnt(0)
    v_cmp_gt_u32 vcc, 16, v237
    s_add_u32 s62, s62, 1
    s_nop 1
    s_cmp_eq_u64 vcc, 0
    s_cbranch_scc1 L77_apd
    s_cmp_lt_u32 s62, 65536
    s_cbranch_scc1 L76_ap
L77_apd:
    v_mfma_f32_16x16x32_bf16 v[64:67], a[200:203], v[144:147], v[64:67]
    v_mfma_f32_16x16x32_bf16 v[84:87], a[200:203], v[148:151], v[84:87]
    v_mfma_f32_16x16x32_bf16 v[104:107], a[200:203], v[152:155], v[104:107]
    v_mfma_f32_16x16x32_bf16 v[124:127], a[200:203], v[156:159], v[124:127]
    s_add_u32 s40, s32, 20480
    buffer_load_dwordx4 a[120:123], v11, s[4:7], s40 offen sc1
    v_mfma_f32_16x16x32_bf16 v[68:71], a[204:207], v[144:147], v[68:71]
    v_mfma_f32_16x16x32_bf16 v[88:91], a[204:207], v[148:151], v[88:91]
    v_mfma_f32_16x16x32_bf16 v[108:111], a[204:207], v[152:155], v[108:111]
    v_mfma_f32_16x16x32_bf16 v[128:131], a[204:207], v[156:159], v[128:131]
    s_add_u32 s40, s33, 20480
    buffer_load_dwordx4 a[124:127], v11, s[4:7], s40 offen sc1
    v_mfma_f32_16x16x32_bf16 v[72:75], a[208:211], v[144:147], v[72:75]
    v_mfma_f32_16x16x32_bf16 v[92:95], a[208:211], v[148:151], v[92:95]
    v_mfma_f32_16x16x32_bf16 v[112:115], a[208:211], v[152:155], v[112:115]
    v_mfma_f32_16x16x32_bf16 v[132:135], a[208:211], v[156:159], v[132:135]
    s_add_u32 s40, s34, 20480
    buffer_load_dwordx4 a[128:131], v11, s[4:7], s40 offen sc1
    v_mfma_f32_16x16x32_bf16 v[76:79], a[212:215], v[144:147], v[76:79]
    v_mfma_f32_16x16x32_bf16 v[96:99], a[212:215], v[148:151], v[96:99]
    v_mfma_f32_16x16x32_bf16 v[116:119], a[212:215], v[152:155], v[116:119]
    v_mfma_f32_16x16x32_bf16 v[136:139], a[212:215], v[156:159], v[136:139]
    s_add_u32 s40, s35, 20480
    buffer_load_dwordx4 a[132:135], v11, s[4:7], s40 offen sc1
    v_mfma_f32_16x16x32_bf16 v[80:83], a[216:219], v[144:147], v[80:83]
    v_mfma_f32_16x16x32_bf16 v[100:103], a[216:219], v[148:151], v[100:103]
    v_mfma_f32_16x16x32_bf16 v[120:123], a[216:219], v[152:155], v[120:123]
    v_mfma_f32_16x16x32_bf16 v[140:143], a[216:219], v[156:159], v[140:143]
    v_mfma_f32_16x16x32_bf16 v[64:67], a[220:223], v[200:203], v[64:67]
    v_mfma_f32_16x16x32_bf16 v[84:87], a[220:223], v[204:207], v[84:87]
    s_add_u32 s40, s32, 24576
    buffer_load_dwordx4 a[136:139], v11, s[4:7], s40 offen sc1
    v_mfma_f32_16x16x32_bf16 v[104:107], a[220:223], v[208:211], v[104:107]
    v_mfma_f32_16x16x32_bf16 v[124:127], a[220:223], v[212:215], v[124:127]
    s_add_u32 s40, s33, 24576
    buffer_load_dwordx4 a[140:143], v11, s[4:7], s40 offen sc1
    v_mfma_f32_16x16x32_bf16 v[68:71], a[224:227], v[200:203], v[68:71]
    v_mfma_f32_16x16x32_bf16 v[88:91], a[224:227], v[204:207], v[88:91]
    s_add_u32 s40, s34, 24576
    buffer_load_dwordx4 a[144:147], v11, s[4:7], s40 offen sc1
    v_mfma_f32_16x16x32_bf16 v[108:111], a[224:227], v[208:211], v[108:111]
    v_mfma_f32_16x16x32_bf16 v[128:131], a[224:227], v[212:215], v[128:131]
    s_add_u32 s40, s35, 24576
    buffer_load_dwordx4 a[148:151], v11, s[4:7], s40 offen sc1
    v_mfma_f32_16x16x32_bf16 v[72:75], a[228:231], v[200:203], v[72:75]
    v_mfma_f32_16x16x32_bf16 v[92:95], a[228:231], v[204:207], v[92:95]
    s_add_u32 s40, s36, 28672
    buffer_load_dwordx4 v[144:147], v11, s[4:7], s40 offen sc1
    v_mfma_f32_16x16x32_bf16 v[112:115], a[228:231], v[208:211], v[112:115]
    v_mfma_f32_16x16x32_bf16 v[132:135], a[228:231], v[212:215], v[132:135]
    s_add_u32 s40, s37, 28672
    buffer_load_dwordx4 v[148:151], v11, s[4:7], s40 offen sc1
    v_mfma_f32_16x16x32_bf16 v[76:79], a[232:235], v[200:203], v[76:79]
    v_mfma_f32_16x16x32_bf16 v[96:99], a[232:235], v[204:207], v[96:99]
    s_add_u32 s40, s38, 28672
    buffer_load_dwordx4 v[152:155], v11, s[4:7], s40 offen sc1
    v_mfma_f32_16x16x32_bf16 v[116:119], a[232:235], v[208:211], v[116:119]
    v_mfma_f32_16x16x32_bf16 v[136:139], a[232:235], v[212:215], v[136:139]
    s_add_u32 s40, s39, 28672
    buffer_load_dwordx4 v[156:159], v11, s[4:7], s40 offen sc1
    v_mfma_f32_16x16x32_bf16 v[80:83], a[236:239], v[200:203], v[80:83]
    v_mfma_f32_16x16x32_bf16 v[100:103], a[236:239], v[204:207], v[100:103]
    v_mfma_f32_16x16x32_bf16 v[120:123], a[236:239], v[208:211], v[120:123]
    v_mfma_f32_16x16x32_bf16 v[140:143], a[236:239], v[212:215], v[140:143]
    s_lshl_b32 s57, s70, 8
    s_add_u32 s57, s57, 34390016
    v_mov_b32 v236, 0
    buffer_load_dword v237, v236, s[4:7], s57 offen sc1
    s_waitcnt vmcnt(18)
    v_mfma_f32_16x16x32_bf16 v[64:67], a[240:243], v[216:219], v[64:67]
    s_waitcnt vmcnt(17)
    v_mfma_f32_16x16x32_bf16 v[84:87], a[240:243], v[220:223], v[84:87]
    s_waitcnt vmcnt(16)
    v_mfma_f32_16x16x32_bf16 v[104:107], a[240:243], a[152:155], v[104:107]
    s_waitcnt vmcnt(15)
    v_mfma_f32_16x16x32_bf16 v[124:127], a[240:243], a[156:159], v[124:127]
    s_add_u32 s40, s36, 32768
    buffer_load_dwordx4 v[200:203], v11, s[4:7], s40 offen sc1
    v_mfma_f32_16x16x32_bf16 v[68:71], a[244:247], v[216:219], v[68:71]
    v_mfma_f32_16x16x32_bf16 v[88:91], a[244:247], v[220:223], v[88:91]
    v_mfma_f32_16x16x32_bf16 v[108:111], a[244:247], a[152:155], v[108:111]
    v_mfma_f32_16x16x32_bf16 v[128:131], a[244:247], a[156:159], v[128:131]
    s_add_u32 s40, s37, 32768
    buffer_load_dwordx4 v[204:207], v11, s[4:7], s40 offen sc1
    v_mfma_f32_16x16x32_bf16 v[72:75], a[248:251], v[216:219], v[72:75]
    v_mfma_f32_16x16x32_bf16 v[92:95], a[248:251], v[220:223], v[92:95]
    v_mfma_f32_16x16x32_bf16 v[112:115], a[248:251], a[152:155], v[112:115]
    v_mfma_f32_16x16x32_bf16 v[132:135], a[248:251], a[156:159], v[132:135]
    s_add_u32 s40, s38, 32768
    buffer_load_dwordx4 v[208:211], v11, s[4:7], s40 offen sc1
    v_mfma_f32_16x16x32_bf16 v[76:79], a[252:255], v[216:219], v[76:79]
    v_mfma_f32_16x16x32_bf16 v[96:99], a[252:255], v[220:223], v[96:99]
    v_mfma_f32_16x16x32_bf16 v[116:119], a[252:255], a[152:155], v[116:119]
    v_mfma_f32_16x16x32_bf16 v[136:139], a[252:255], a[156:159], v[136:139]
    s_add_u32 s40, s39, 32768
    buffer_load_dwordx4 v[212:215], v11, s[4:7], s40 offen sc1
    v_mfma_f32_16x16x32_bf16 v[80:83], v[160:163], v[216:219], v[80:83]
    v_mfma_f32_16x16x32_bf16 v[100:103], v[160:163], v[220:223], v[100:103]
    v_mfma_f32_16x16x32_bf16 v[120:123], v[160:163], a[152:155], v[120:123]
    v_mfma_f32_16x16x32_bf16 v[140:143], v[160:163], a[156:159], v[140:143]
    s_mov_b32 s62, 0
    s_waitcnt vmcnt(4)
    v_cmp_gt_u32 vcc, 16, v237
    s_nop 1
    s_cmp_eq_u64 vcc, 0
    s_cbranch_scc1 L79_apd
    s_lshl_b32 s57, s70, 8
    s_add_u32 s57, s57, 34390016
L78_ap:
    buffer_load_dword v237, v236, s[4:7], s57 offen sc1
    s_waitcnt vmcnt(0)
    v_cmp_gt_u32 vcc, 16, v237
    s_add_u32 s62, s62, 1
    s_nop 1
    s_cmp_eq_u64 vcc, 0
    s_cbranch_scc1 L79_apd
    s_cmp_lt_u32 s62, 65536
    s_cbranch_scc1 L78_ap
L79_apd:
    v_mfma_f32_16x16x32_bf16 v[64:67], v[164:167], a[120:123], v[64:67]
    v_mfma_f32_16x16x32_bf16 v[84:87], v[164:167], a[124:127], v[84:87]
    v_mfma_f32_16x16x32_bf16 v[104:107], v[164:167], a[128:131], v[104:107]
    v_mfma_f32_16x16x32_bf16 v[124:127], v[164:167], a[132:135], v[124:127]
    s_add_u32 s40, s36, 36864
    buffer_load_dwordx4 v[216:219], v11, s[4:7], s40 offen sc1
    v_mfma_f32_16x16x32_bf16 v[68:71], v[168:171], a[120:123], v[68:71]
    v_mfma_f32_16x16x32_bf16 v[88:91], v[168:171], a[124:127], v[88:91]
    v_mfma_f32_16x16x32_bf16 v[108:111], v[168:171], a[128:131], v[108:111]
    v_mfma_f32_16x16x32_bf16 v[128:131], v[168:171], a[132:135], v[128:131]
    s_add_u32 s40, s37, 36864
    buffer_load_dwordx4 v[220:223], v11, s[4:7], s40 offen sc1
    v_mfma_f32_16x16x32_bf16 v[72:75], v[172:175], a[120:123], v[72:75]
    v_mfma_f32_16x16x32_bf16 v[92:95], v[172:175], a[124:127], v[92:95]
    v_mfma_f32_16x16x32_bf16 v[112:115], v[172:175], a[128:131], v[112:115]
    v_mfma_f32_16x16x32_bf16 v[132:135], v[172:175], a[132:135], v[132:135]
    s_add_u32 s40, s38, 36864
    buffer_load_dwordx4 a[152:155], v11, s[4:7], s40 offen sc1
    v_mfma_f32_16x16x32_bf16 v[76:79], v[176:179], a[120:123], v[76:79]
    v_mfma_f32_16x16x32_bf16 v[96:99], v[176:179], a[124:127], v[96:99]
    v_mfma_f32_16x16x32_bf16 v[116:119], v[176:179], a[128:131], v[116:119]
    v_mfma_f32_16x16x32_bf16 v[136:139], v[176:179], a[132:135], v[136:139]
    s_add_u32 s40, s39, 36864
    buffer_load_dwordx4 a[156:159], v11, s[4:7], s40 offen sc1
    v_mfma_f32_16x16x32_bf16 v[80:83], v[180:183], a[120:123], v[80:83]
    v_mfma_f32_16x16x32_bf16 v[100:103], v[180:183], a[124:127], v[100:103]
    v_mfma_f32_16x16x32_bf16 v[120:123], v[180:183], a[128:131], v[120:123]
    v_mfma_f32_16x16x32_bf16 v[140:143], v[180:183], a[132:135], v[140:143]
    v_mfma_f32_16x16x32_bf16 v[64:67], v[184:187], a[136:139], v[64:67]
    v_mfma_f32_16x16x32_bf16 v[84:87], v[184:187], a[140:143], v[84:87]
    v_mfma_f32_16x16x32_bf16 v[104:107], v[184:187], a[144:147], v[104:107]
    v_mfma_f32_16x16x32_bf16 v[124:127], v[184:187], a[148:151], v[124:127]
    s_add_u32 s40, s52, 40960
    buffer_load_dwordx4 a[120:123], v11, s[4:7], s40 offen sc1
    v_mfma_f32_16x16x32_bf16 v[68:71], v[188:191], a[136:139], v[68:71]
    v_mfma_f32_16x16x32_bf16 v[88:91], v[188:191], a[140:143], v[88:91]
    v_mfma_f32_16x16x32_bf16 v[108:111], v[188:191], a[144:147], v[108:111]
    v_mfma_f32_16x16x32_bf16 v[128:131], v[188:191], a[148:151], v[128:131]
    s_add_u32 s40, s53, 40960
    buffer_load_dwordx4 a[124:127], v11, s[4:7], s40 offen sc1
    v_mfma_f32_16x16x32_bf16 v[72:75], v[192:195], a[136:139], v[72:75]
    v_mfma_f32_16x16x32_bf16 v[92:95], v[192:195], a[140:143], v[92:95]
    v_mfma_f32_16x16x32_bf16 v[112:115], v[192:195], a[144:147], v[112:115]
    v_mfma_f32_16x16x32_bf16 v[132:135], v[192:195], a[148:151], v[132:135]
    s_add_u32 s40, s54, 40960
    buffer_load_dwordx4 a[128:131], v11, s[4:7], s40 offen sc1
    v_mfma_f32_16x16x32_bf16 v[76:79], v[196:199], a[136:139], v[76:79]
    v_mfma_f32_16x16x32_bf16 v[96:99], v[196:199], a[140:143], v[96:99]
    v_mfma_f32_16x16x32_bf16 v[116:119], v[196:199], a[144:147], v[116:119]
    v_mfma_f32_16x16x32_bf16 v[136:139], v[196:199], a[148:151], v[136:139]
    s_add_u32 s40, s55, 40960
    buffer_load_dwordx4 a[132:135], v11, s[4:7], s40 offen sc1
    v_mfma_f32_16x16x32_bf16 v[80:83], v[224:227], a[136:139], v[80:83]
    v_mfma_f32_16x16x32_bf16 v[100:103], v[224:227], a[140:143], v[100:103]
    v_mfma_f32_16x16x32_bf16 v[120:123], v[224:227], a[144:147], v[120:123]
    v_mfma_f32_16x16x32_bf16 v[140:143], v[224:227], a[148:151], v[140:143]
    v_mfma_f32_16x16x32_bf16 v[64:67], v[228:231], v[144:147], v[64:67]
    ds_read_b128 a[32:35], v13 offset:0
    v_mfma_f32_16x16x32_bf16 v[84:87], v[228:231], v[148:151], v[84:87]
    v_mfma_f32_16x16x32_bf16 v[104:107], v[228:231], v[152:155], v[104:107]
    v_mfma_f32_16x16x32_bf16 v[124:127], v[228:231], v[156:159], v[124:127]
    s_add_u32 s40, s52, 45056
    buffer_load_dwordx4 a[136:139], v11, s[4:7], s40 offen sc1
    ds_read_b128 a[36:39], v13 offset:1024
    v_mfma_f32_16x16x32_bf16 v[68:71], v[232:235], v[144:147], v[68:71]
    v_mfma_f32_16x16x32_bf16 v[88:91], v[232:235], v[148:151], v[88:91]
    v_mfma_f32_16x16x32_bf16 v[108:111], v[232:235], v[152:155], v[108:111]
    ds_read_b128 a[40:43], v13 offset:2048
    v_mfma_f32_16x16x32_bf16 v[128:131], v[232:235], v[156:159], v[128:131]
    s_add_u32 s40, s53, 45056
    buffer_load_dwordx4 a[140:143], v11, s[4:7], s40 offen sc1
    v_mfma_f32_16x16x32_bf16 v[72:75], v[16:19], v[144:147], v[72:75]
    v_mfma_f32_16x16x32_bf16 v[92:95], v[16:19], v[148:151], v[92:95]
    ds_read_b128 a[44:47], v13 offset:3072
    v_mfma_f32_16x16x32_bf16 v[112:115], v[16:19], v[152:155], v[112:115]
    v_mfma_f32_16x16x32_bf16 v[132:135], v[16:19], v[156:159], v[132:135]
    s_add_u32 s40, s54, 45056
    buffer_load_dwordx4 a[144:147], v11, s[4:7], s40 offen sc1
    v_mfma_f32_16x16x32_bf16 v[76:79], v[20:23], v[144:147], v[76:79]
    ds_read_b128 a[48:51], v13 offset:4096
    v_mfma_f32_16x16x32_bf16 v[96:99], v[20:23], v[148:151], v[96:99]
    v_mfma_f32_16x16x32_bf16 v[116:119], v[20:23], v[152:155], v[116:119]
    v_mfma_f32_16x16x32_bf16 v[136:139], v[20:23], v[156:159], v[136:139]
    s_add_u32 s40, s55, 45056
    buffer_load_dwordx4 a[148:151], v11, s[4:7], s40 offen sc1
    v_mfma_f32_16x16x32_bf16 v[80:83], v[24:27], v[144:147], v[80:83]
    v_mfma_f32_16x16x32_bf16 v[100:103], v[24:27], v[148:151], v[100:103]
    v_mfma_f32_16x16x32_bf16 v[120:123], v[24:27], v[152:155], v[120:123]
    v_mfma_f32_16x16x32_bf16 v[140:143], v[24:27], v[156:159], v[140:143]
    s_waitcnt vmcnt(15) lgkmcnt(4)
    v_mfma_f32_16x16x32_bf16 v[64:67], a[32:35], v[200:203], v[64:67]
    ds_read_b128 a[52:55], v13 offset:5120
    s_waitcnt vmcnt(14)
    v_mfma_f32_16x16x32_bf16 v[84:87], a[32:35], v[204:207], v[84:87]
    s_waitcnt vmcnt(13)
    v_mfma_f32_16x16x32_bf16 v[104:107], a[32:35], v[208:211], v[104:107]
    s_waitcnt vmcnt(12)
    v_mfma_f32_16x16x32_bf16 v[124:127], a[32:35], v[212:215], v[124:127]
    s_add_u32 s40, s52, 49152
    buffer_load_dwordx4 v[144:147], v11, s[4:7], s40 offen sc1
    ds_read_b128 a[56:59], v13 offset:6144
    s_waitcnt lgkmcnt(5)
    v_mfma_f32_16x16x32_bf16 v[68:71], a[36:39], v[200:203], v[68:71]
    v_mfma_f32_16x16x32_bf16 v[88:91], a[36:39], v[204:207], v[88:91]
    v_mfma_f32_16x16x32_bf16 v[108:111], a[36:39], v[208:211], v[108:111]
    ds_read_b128 a[60:63], v13 offset:7168
    v_mfma_f32_16x16x32_bf16 v[128:131], a[36:39], v[212:215], v[128:131]
    s_add_u32 s40, s53, 49152
    buffer_load_dwordx4 v[148:151], v11, s[4:7], s40 offen sc1
    s_waitcnt lgkmcnt(5)
    v_mfma_f32_16x16x32_bf16 v[72:75], a[40:43], v[200:203], v[72:75]
    v_mfma_f32_16x16x32_bf16 v[92:95], a[40:43], v[204:207], v[92:95]
    ds_read_b128 a[64:67], v13 offset:8192
    v_mfma_f32_16x16x32_bf16 v[112:115], a[40:43], v[208:211], v[112:115]
    v_mfma_f32_16x16x32_bf16 v[132:135], a[40:43], v[212:215], v[132:135]
    s_add_u32 s40, s54, 49152
    buffer_load_dwordx4 v[152:155], v11, s[4:7], s40 offen sc1
    s_waitcnt lgkmcnt(5)
    v_mfma_f32_16x16x32_bf16 v[76:79], a[44:47], v[200:203], v[76:79]
    ds_read_b128 a[68:71], v13 offset:9216
    v_mfma_f32_16x16x32_bf16 v[96:99], a[44:47], v[204:207], v[96:99]
    v_mfma_f32_16x16x32_bf16 v[116:119], a[44:47], v[208:211], v[116:119]
    v_mfma_f32_16x16x32_bf16 v[136:139], a[44:47], v[212:215], v[136:139]
    s_add_u32 s40, s55, 49152
    buffer_load_dwordx4 v[156:159], v11, s[4:7], s40 offen sc1
    s_waitcnt lgkmcnt(5)
    v_mfma_f32_16x16x32_bf16 v[80:83], a[48:51], v[200:203], v[80:83]
    v_mfma_f32_16x16x32_bf16 v[100:103], a[48:51], v[204:207], v[100:103]
    v_mfma_f32_16x16x32_bf16 v[120:123], a[48:51], v[208:211], v[120:123]
    v_mfma_f32_16x16x32_bf16 v[140:143], a[48:51], v[212:215], v[140:143]
    s_waitcnt vmcnt(15) lgkmcnt(4)
    v_mfma_f32_16x16x32_bf16 v[64:67], a[52:55], v[216:219], v[64:67]
    ds_read_b128 a[32:35], v13 offset:10240
    s_waitcnt vmcnt(14)
    v_mfma_f32_16x16x32_bf16 v[84:87], a[52:55], v[220:223], v[84:87]
    s_waitcnt vmcnt(13)
    v_mfma_f32_16x16x32_bf16 v[104:107], a[52:55], a[152:155], v[104:107]
    s_waitcnt vmcnt(12)
    v_mfma_f32_16x16x32_bf16 v[124:127], a[52:55], a[156:159], v[124:127]
    s_add_u32 s40, s52, 53248
    buffer_load_dwordx4 v[200:203], v11, s[4:7], s40 offen sc1
    ds_read_b128 a[36:39], v13 offset:11264
    s_waitcnt lgkmcnt(5)
    v_mfma_f32_16x16x32_bf16 v[68:71], a[56:59], v[216:219], v[68:71]
    v_mfma_f32_16x16x32_bf16 v[88:91], a[56:59], v[220:223], v[88:91]
    v_mfma_f32_16x16x32_bf16 v[108:111], a[56:59], a[152:155], v[108:111]
    ds_read_b128 a[40:43], v13 offset:12288
    v_mfma_f32_16x16x32_bf16 v[128:131], a[56:59], a[156:159], v[128:131]
    s_add_u32 s40, s53, 53248
    buffer_load_dwordx4 v[204:207], v11, s[4:7], s40 offen sc1
    s_waitcnt lgkmcnt(5)
    v_mfma_f32_16x16x32_bf16 v[72:75], a[60:63], v[216:219], v[72:75]
    v_mfma_f32_16x16x32_bf16 v[92:95], a[60:63], v[220:223], v[92:95]
    ds_read_b128 a[44:47], v13 offset:13312
    v_mfma_f32_16x16x32_bf16 v[112:115], a[60:63], a[152:155], v[112:115]
    v_mfma_f32_16x16x32_bf16 v[132:135], a[60:63], a[156:159], v[132:135]
    s_add_u32 s40, s54, 53248
    buffer_load_dwordx4 v[208:211], v11, s[4:7], s40 offen sc1
    s_waitcnt lgkmcnt(5)
    v_mfma_f32_16x16x32_bf16 v[76:79], a[64:67], v[216:219], v[76:79]
    ds_read_b128 a[48:51], v13 offset:14336
    v_mfma_f32_16x16x32_bf16 v[96:99], a[64:67], v[220:223], v[96:99]
    v_mfma_f32_16x16x32_bf16 v[116:119], a[64:67], a[152:155], v[116:119]
    v_mfma_f32_16x16x32_bf16 v[136:139], a[64:67], a[156:159], v[136:139]
    s_add_u32 s40, s55, 53248
    buffer_load_dwordx4 v[212:215], v11, s[4:7], s40 offen sc1
    s_waitcnt lgkmcnt(5)
    v_mfma_f32_16x16x32_bf16 v[80:83], a[68:71], v[216:219], v[80:83]
    v_mfma_f32_16x16x32_bf16 v[100:103], a[68:71], v[220:223], v[100:103]
    v_mfma_f32_16x16x32_bf16 v[120:123], a[68:71], a[152:155], v[120:123]
    v_mfma_f32_16x16x32_bf16 v[140:143], a[68:71], a[156:159], v[140:143]
    s_waitcnt vmcnt(15) lgkmcnt(4)
    v_mfma_f32_16x16x32_bf16 v[64:67], a[32:35], a[120:123], v[64:67]
    ds_read_b128 a[52:55], v13 offset:15360
    s_waitcnt vmcnt(14)
    v_mfma_f32_16x16x32_bf16 v[84:87], a[32:35], a[124:127], v[84:87]
    s_waitcnt vmcnt(13)
    v_mfma_f32_16x16x32_bf16 v[104:107], a[32:35], a[128:131], v[104:107]
    s_waitcnt vmcnt(12)
    v_mfma_f32_16x16x32_bf16 v[124:127], a[32:35], a[132:135], v[124:127]
    ds_read_b128 a[56:59], v13 offset:16384
    s_waitcnt lgkmcnt(5)
    v_mfma_f32_16x16x32_bf16 v[68:71], a[36:39], a[120:123], v[68:71]
    v_mfma_f32_16x16x32_bf16 v[88:91], a[36:39], a[124:127], v[88:91]
    v_mfma_f32_16x16x32_bf16 v[108:111], a[36:39], a[128:131], v[108:111]
    ds_read_b128 a[60:63], v13 offset:17408
    v_mfma_f32_16x16x32_bf16 v[128:131], a[36:39], a[132:135], v[128:131]
    s_waitcnt lgkmcnt(5)
    v_mfma_f32_16x16x32_bf16 v[72:75], a[40:43], a[120:123], v[72:75]
    v_mfma_f32_16x16x32_bf16 v[92:95], a[40:43], a[124:127], v[92:95]
    ds_read_b128 a[64:67], v13 offset:18432
    v_mfma_f32_16x16x32_bf16 v[112:115], a[40:43], a[128:131], v[112:115]
    v_mfma_f32_16x16x32_bf16 v[132:135], a[40:43], a[132:135], v[132:135]
    s_waitcnt lgkmcnt(5)
    v_mfma_f32_16x16x32_bf16 v[76:79], a[44:47], a[120:123], v[76:79]
    ds_read_b128 a[68:71], v13 offset:19456
    v_mfma_f32_16x16x32_bf16 v[96:99], a[44:47], a[124:127], v[96:99]
    v_mfma_f32_16x16x32_bf16 v[116:119], a[44:47], a[128:131], v[116:119]
    v_mfma_f32_16x16x32_bf16 v[136:139], a[44:47], a[132:135], v[136:139]
    s_waitcnt lgkmcnt(5)
    v_mfma_f32_16x16x32_bf16 v[80:83], a[48:51], a[120:123], v[80:83]
    v_mfma_f32_16x16x32_bf16 v[100:103], a[48:51], a[124:127], v[100:103]
    v_mfma_f32_16x16x32_bf16 v[120:123], a[48:51], a[128:131], v[120:123]
    v_mfma_f32_16x16x32_bf16 v[140:143], a[48:51], a[132:135], v[140:143]
    s_waitcnt vmcnt(11) lgkmcnt(4)
    v_mfma_f32_16x16x32_bf16 v[64:67], a[52:55], a[136:139], v[64:67]
    ds_read_b128 a[32:35], v13 offset:20480
    s_waitcnt vmcnt(10)
    v_mfma_f32_16x16x32_bf16 v[84:87], a[52:55], a[140:143], v[84:87]
    s_waitcnt vmcnt(9)
    v_mfma_f32_16x16x32_bf16 v[104:107], a[52:55], a[144:147], v[104:107]
    s_waitcnt vmcnt(8)
    v_mfma_f32_16x16x32_bf16 v[124:127], a[52:55], a[148:151], v[124:127]
    ds_read_b128 a[36:39], v13 offset:21504
    s_waitcnt lgkmcnt(5)
    v_mfma_f32_16x16x32_bf16 v[68:71], a[56:59], a[136:139], v[68:71]
    v_mfma_f32_16x16x32_bf16 v[88:91], a[56:59], a[140:143], v[88:91]
    v_mfma_f32_16x16x32_bf16 v[108:111], a[56:59], a[144:147], v[108:111]
    v_mfma_f32_16x16x32_bf16 v[128:131], a[56:59], a[148:151], v[128:131]
    s_waitcnt lgkmcnt(4)
    v_mfma_f32_16x16x32_bf16 v[72:75], a[60:63], a[136:139], v[72:75]
    v_mfma_f32_16x16x32_bf16 v[92:95], a[60:63], a[140:143], v[92:95]
    v_mfma_f32_16x16x32_bf16 v[112:115], a[60:63], a[144:147], v[112:115]
    v_mfma_f32_16x16x32_bf16 v[132:135], a[60:63], a[148:151], v[132:135]
    s_waitcnt lgkmcnt(3)
    v_mfma_f32_16x16x32_bf16 v[76:79], a[64:67], a[136:139], v[76:79]
    v_mfma_f32_16x16x32_bf16 v[96:99], a[64:67], a[140:143], v[96:99]
    v_mfma_f32_16x16x32_bf16 v[116:119], a[64:67], a[144:147], v[116:119]
    v_mfma_f32_16x16x32_bf16 v[136:139], a[64:67], a[148:151], v[136:139]
    s_waitcnt lgkmcnt(2)
    v_mfma_f32_16x16x32_bf16 v[80:83], a[68:71], a[136:139], v[80:83]
    v_mfma_f32_16x16x32_bf16 v[100:103], a[68:71], a[140:143], v[100:103]
    v_mfma_f32_16x16x32_bf16 v[120:123], a[68:71], a[144:147], v[120:123]
    v_mfma_f32_16x16x32_bf16 v[140:143], a[68:71], a[148:151], v[140:143]
    s_waitcnt vmcnt(7) lgkmcnt(1)
    v_mfma_f32_16x16x32_bf16 v[64:67], a[32:35], v[144:147], v[64:67]
    s_waitcnt vmcnt(6)
    v_mfma_f32_16x16x32_bf16 v[84:87], a[32:35], v[148:151], v[84:87]
    s_waitcnt vmcnt(5)
    v_mfma_f32_16x16x32_bf16 v[104:107], a[32:35], v[152:155], v[104:107]
    s_waitcnt vmcnt(4)
    v_mfma_f32_16x16x32_bf16 v[124:127], a[32:35], v[156:159], v[124:127]
    s_waitcnt lgkmcnt(0)
    v_mfma_f32_16x16x32_bf16 v[68:71], a[36:39], v[144:147], v[68:71]
    v_mfma_f32_16x16x32_bf16 v[88:91], a[36:39], v[148:151], v[88:91]
    v_mfma_f32_16x16x32_bf16 v[108:111], a[36:39], v[152:155], v[108:111]
    v_mfma_f32_16x16x32_bf16 v[128:131], a[36:39], v[156:159], v[128:131]
    v_mfma_f32_16x16x32_bf16 v[72:75], a[0:3], v[144:147], v[72:75]
    v_mfma_f32_16x16x32_bf16 v[92:95], a[0:3], v[148:151], v[92:95]
    v_mfma_f32_16x16x32_bf16 v[112:115], a[0:3], v[152:155], v[112:115]
    v_mfma_f32_16x16x32_bf16 v[132:135], a[0:3], v[156:159], v[132:135]
    v_mfma_f32_16x16x32_bf16 v[76:79], a[4:7], v[144:147], v[76:79]
    v_mfma_f32_16x16x32_bf16 v[96:99], a[4:7], v[148:151], v[96:99]
    v_mfma_f32_16x16x32_bf16 v[116:119], a[4:7], v[152:155], v[116:119]
    v_mfma_f32_16x16x32_bf16 v[136:139], a[4:7], v[156:159], v[136:139]
    v_mfma_f32_16x16x32_bf16 v[80:83], a[8:11], v[144:147], v[80:83]
    v_mfma_f32_16x16x32_bf16 v[100:103], a[8:11], v[148:151], v[100:103]
    v_mfma_f32_16x16x32_bf16 v[120:123], a[8:11], v[152:155], v[120:123]
    v_mfma_f32_16x16x32_bf16 v[140:143], a[8:11], v[156:159], v[140:143]
    s_cmp_ge_u32 s20, 2
    s_cbranch_scc1 L75_b2skip
    s_waitcnt vmcnt(3)
    v_mfma_f32_16x16x32_bf16 v[64:67], a[12:15], v[200:203], v[64:67]
    s_waitcnt vmcnt(2)
    v_mfma_f32_16x16x32_bf16 v[84:87], a[12:15], v[204:207], v[84:87]
    s_waitcnt vmcnt(1)
    v_mfma_f32_16x16x32_bf16 v[104:107], a[12:15], v[208:211], v[104:107]
    s_waitcnt vmcnt(0)
    v_mfma_f32_16x16x32_bf16 v[124:127], a[12:15], v[212:215], v[124:127]
    v_mfma_f32_16x16x32_bf16 v[68:71], a[16:19], v[200:203], v[68:71]
    v_mfma_f32_16x16x32_bf16 v[88:91], a[16:19], v[204:207], v[88:91]
    v_mfma_f32_16x16x32_bf16 v[108:111], a[16:19], v[208:211], v[108:111]
    v_mfma_f32_16x16x32_bf16 v[128:131], a[16:19], v[212:215], v[128:131]
    v_mfma_f32_16x16x32_bf16 v[72:75], a[20:23], v[200:203], v[72:75]
    v_mfma_f32_16x16x32_bf16 v[92:95], a[20:23], v[204:207], v[92:95]
    v_mfma_f32_16x16x32_bf16 v[112:115], a[20:23], v[208:211], v[112:115]
    v_mfma_f32_16x16x32_bf16 v[132:135], a[20:23], v[212:215], v[132:135]
    v_mfma_f32_16x16x32_bf16 v[76:79], a[24:27], v[200:203], v[76:79]
    v_mfma_f32_16x16x32_bf16 v[96:99], a[24:27], v[204:207], v[96:99]
    v_mfma_f32_16x16x32_bf16 v[116:119], a[24:27], v[208:211], v[116:119]
    v_mfma_f32_16x16x32_bf16 v[136:139], a[24:27], v[212:215], v[136:139]
    v_mfma_f32_16x16x32_bf16 v[80:83], a[28:31], v[200:203], v[80:83]
    v_mfma_f32_16x16x32_bf16 v[100:103], a[28:31], v[204:207], v[100:103]
    v_mfma_f32_16x16x32_bf16 v[120:123], a[28:31], v[208:211], v[120:123]
    v_mfma_f32_16x16x32_bf16 v[140:143], a[28:31], v[212:215], v[140:143]
L75_b2skip:
    s_waitcnt vmcnt(0)
    s_nop 7
    v_lshlrev_b32 v10, 4, v0
    s_add_u32 s31, s20, 1
    s_and_b32 s31, s31, 3
    s_mul_i32 s31, s31, 15360
    s_add_u32 s31, s31, 0
    v_add_u32 v13, s31, v10
    ds_write_b128 v13, v[84:87] offset:0
    ds_write_b128 v13, v[88:91] offset:1024
    ds_write_b128 v13, v[92:95] offset:2048
    ds_write_b128 v13, v[96:99] offset:3072
    ds_write_b128 v13, v[100:103] offset:4096
    s_add_u32 s31, s20, 2
    s_and_b32 s31, s31, 3
    s_mul_i32 s31, s31, 15360
    s_add_u32 s31, s31, 5120
    v_add_u32 v13, s31, v10
    ds_write_b128 v13, v[104:107] offset:0
    ds_write_b128 v13, v[108:111] offset:1024
    ds_write_b128 v13, v[112:115] offset:2048
    ds_write_b128 v13, v[116:119] offset:3072
    ds_write_b128 v13, v[120:123] offset:4096
    s_add_u32 s31, s20, 3
    s_and_b32 s31, s31, 3
    s_mul_i32 s31, s31, 15360
    s_add_u32 s31, s31, 10240
    v_add_u32 v13, s31, v10
    ds_write_b128 v13, v[124:127] offset:0
    ds_write_b128 v13, v[128:131] offset:1024
    ds_write_b128 v13, v[132:135] offset:2048
    ds_write_b128 v13, v[136:139] offset:3072
    ds_write_b128 v13, v[140:143] offset:4096
    s_mul_i32 s31, s20, 15360
    v_add_u32 v13, s31, v10
    s_waitcnt lgkmcnt(0)
    s_barrier
    ds_read_b128 v[84:87], v13 offset:0
    ds_read_b128 v[88:91], v13 offset:5120
    ds_read_b128 v[92:95], v13 offset:10240
    ds_read_b128 v[96:99], v13 offset:1024
    ds_read_b128 v[100:103], v13 offset:6144
    ds_read_b128 v[104:107], v13 offset:11264
    ds_read_b128 v[108:111], v13 offset:2048
    ds_read_b128 v[112:115], v13 offset:7168
    ds_read_b128 v[116:119], v13 offset:12288
    ds_read_b128 v[120:123], v13 offset:3072
    ds_read_b128 v[124:127], v13 offset:8192
    ds_read_b128 v[128:131], v13 offset:13312
    ds_read_b128 v[132:135], v13 offset:4096
    ds_read_b128 v[136:139], v13 offset:9216
    ds_read_b128 v[140:143], v13 offset:14336
    s_waitcnt lgkmcnt(14)
    v_pk_add_f32 v[64:65], v[64:65], v[84:85]
    v_pk_add_f32 v[66:67], v[66:67], v[86:87]
    s_waitcnt lgkmcnt(13)
    v_pk_add_f32 v[64:65], v[64:65], v[88:89]
    v_pk_add_f32 v[66:67], v[66:67], v[90:91]
    s_waitcnt lgkmcnt(12)
    v_pk_add_f32 v[64:65], v[64:65], v[92:93]
    v_pk_add_f32 v[66:67], v[66:67], v[94:95]
    s_waitcnt lgkmcnt(11)
    v_pk_add_f32 v[68:69], v[68:69], v[96:97]
    v_pk_add_f32 v[70:71], v[70:71], v[98:99]
    s_waitcnt lgkmcnt(10)
    v_pk_add_f32 v[68:69], v[68:69], v[100:101]
    v_pk_add_f32 v[70:71], v[70:71], v[102:103]
    s_waitcnt lgkmcnt(9)
    v_pk_add_f32 v[68:69], v[68:69], v[104:105]
    v_pk_add_f32 v[70:71], v[70:71], v[106:107]
    s_waitcnt lgkmcnt(8)
    v_pk_add_f32 v[72:73], v[72:73], v[108:109]
    v_pk_add_f32 v[74:75], v[74:75], v[110:111]
    s_waitcnt lgkmcnt(7)
    v_pk_add_f32 v[72:73], v[72:73], v[112:113]
    v_pk_add_f32 v[74:75], v[74:75], v[114:115]
    s_waitcnt lgkmcnt(6)
    v_pk_add_f32 v[72:73], v[72:73], v[116:117]
    v_pk_add_f32 v[74:75], v[74:75], v[118:119]
    s_waitcnt lgkmcnt(5)
    v_pk_add_f32 v[76:77], v[76:77], v[120:121]
    v_pk_add_f32 v[78:79], v[78:79], v[122:123]
    s_waitcnt lgkmcnt(4)
    v_pk_add_f32 v[76:77], v[76:77], v[124:125]
    v_pk_add_f32 v[78:79], v[78:79], v[126:127]
    s_waitcnt lgkmcnt(3)
    v_pk_add_f32 v[76:77], v[76:77], v[128:129]
    v_pk_add_f32 v[78:79], v[78:79], v[130:131]
    s_waitcnt lgkmcnt(2)
    v_pk_add_f32 v[80:81], v[80:81], v[132:133]
    v_pk_add_f32 v[82:83], v[82:83], v[134:135]
    s_waitcnt lgkmcnt(1)
    v_pk_add_f32 v[80:81], v[80:81], v[136:137]
    v_pk_add_f32 v[82:83], v[82:83], v[138:139]
    s_waitcnt lgkmcnt(0)
    v_pk_add_f32 v[80:81], v[80:81], v[140:141]
    v_pk_add_f32 v[82:83], v[82:83], v[142:143]
    s_lshl_b32 s37, s43, 4
    s_add_u32 s37, s37, s22
    s_mul_i32 s37, s37, 1280
    s_mul_i32 s38, s24, 160
    s_add_u32 s37, s37, s38
    s_mul_i32 s38, s20, 2560
    s_add_u32 s38, s38, 65536
    v_mul_u32_u24 v5, 160, v1
    v_lshl_add_u32 v5, v2, 3, v5
    v_add_u32 v5, s38, v5
    v_add_u32 v3, 0, v0
    v_mul_u32_u24 v4, 205, v3
    v_lshrrev_b32 v4, 11, v4
    v_mul_u32_u24 v8, 10, v4
    v_sub_u32 v8, v3, v8
    v_mul_u32_u24 v9, 160, v4
    v_lshl_add_u32 v9, v8, 4, v9
    v_add_u32 v48, s38, v9
    v_mul_u32_u24 v9, 163840, v4
    v_lshl_add_u32 v52, v8, 4, v9
    v_add_u32 v3, 64, v0
    v_mul_u32_u24 v4, 205, v3
    v_lshrrev_b32 v4, 11, v4
    v_mul_u32_u24 v8, 10, v4
    v_sub_u32 v8, v3, v8
    v_mul_u32_u24 v9, 160, v4
    v_lshl_add_u32 v9, v8, 4, v9
    v_add_u32 v49, s38, v9
    v_mul_u32_u24 v9, 163840, v4
    v_lshl_add_u32 v53, v8, 4, v9
    v_add_u32 v3, 128, v0
    v_mul_u32_u24 v4, 205, v3
    v_lshrrev_b32 v4, 11, v4
    v_mul_u32_u24 v8, 10, v4
    v_sub_u32 v8, v3, v8
    v_mul_u32_u24 v9, 160, v4
    v_lshl_add_u32 v9, v8, 4, v9
    v_add_u32 v50, s38, v9
    v_mul_u32_u24 v9, 163840, v4
    v_lshl_add_u32 v54, v8, 4, v9
    v_lshlrev_b32 v14, 16, v240
    v_and_b32 v15, 0xffff0000, v240
    v_lshlrev_b32 v6, 16, v241
    v_and_b32 v7, 0xffff0000, v241
    v_pk_add_f32 v[64:65], v[64:65], v[14:15]
    v_pk_add_f32 v[66:67], v[66:67], v[6:7]
    v_cvt_pk_bf16_f32 v240, v64, v65
    v_cvt_pk_bf16_f32 v241, v66, v67
    ds_write_b64 v5, v[240:241] offset:0
    v_lshlrev_b32 v14, 16, v242
    v_and_b32 v15, 0xffff0000, v242
    v_lshlrev_b32 v6, 16, v243
    v_and_b32 v7, 0xffff0000, v243
    v_pk_add_f32 v[68:69], v[68:69], v[14:15]
    v_pk_add_f32 v[70:71], v[70:71], v[6:7]
    v_cvt_pk_bf16_f32 v242, v68, v69
    v_cvt_pk_bf16_f32 v243, v70, v71
    ds_write_b64 v5, v[242:243] offset:32
    v_lshlrev_b32 v14, 16, v244
    v_and_b32 v15, 0xffff0000, v244
    v_lshlrev_b32 v6, 16, v245
    v_and_b32 v7, 0xffff0000, v245
    v_pk_add_f32 v[72:73], v[72:73], v[14:15]
    v_pk_add_f32 v[74:75], v[74:75], v[6:7]
    v_cvt_pk_bf16_f32 v244, v72, v73
    v_cvt_pk_bf16_f32 v245, v74, v75
    ds_write_b64 v5, v[244:245] offset:64
    v_lshlrev_b32 v14, 16, v246
    v_and_b32 v15, 0xffff0000, v246
    v_lshlrev_b32 v6, 16, v247
    v_and_b32 v7, 0xffff0000, v247
    v_pk_add_f32 v[76:77], v[76:77], v[14:15]
    v_pk_add_f32 v[78:79], v[78:79], v[6:7]
    v_cvt_pk_bf16_f32 v246, v76, v77
    v_cvt_pk_bf16_f32 v247, v78, v79
    ds_write_b64 v5, v[246:247] offset:96
    v_lshlrev_b32 v14, 16, v248
    v_and_b32 v15, 0xffff0000, v248
    v_lshlrev_b32 v6, 16, v249
    v_and_b32 v7, 0xffff0000, v249
    v_pk_add_f32 v[80:81], v[80:81], v[14:15]
    v_pk_add_f32 v[82:83], v[82:83], v[6:7]
    v_cvt_pk_bf16_f32 v248, v80, v81
    v_cvt_pk_bf16_f32 v249, v82, v83
    ds_write_b64 v5, v[248:249] offset:128
    s_waitcnt lgkmcnt(0)
    ds_read_b128 v[84:87], v48
    ds_read_b128 v[88:91], v49
    ds_read_b128 v[92:95], v50
    s_waitcnt lgkmcnt(2)
    buffer_store_dwordx4 v[84:87], v52, s[92:95], s37 offen
    s_waitcnt lgkmcnt(1)
    buffer_store_dwordx4 v[88:91], v53, s[92:95], s37 offen
    s_waitcnt lgkmcnt(0)
    s_mov_b32 exec_hi, 0
    buffer_store_dwordx4 v[92:95], v54, s[92:95], s37 offen
    s_mov_b64 exec, -1
    s_waitcnt vmcnt(0)
L_exit:
    s_endpgm
.section .rodata,"a"
.p2align 6
.amdhsa_kernel interleave_layers__spectral_fnet__glu_gated_glu__prompt_kernel
  .amdhsa_next_free_vgpr 512
  .amdhsa_next_free_sgpr 102
  .amdhsa_accum_offset 256
  .amdhsa_group_segment_fixed_size 0
  .amdhsa_kernarg_size 96
  .amdhsa_user_sgpr_count 2
  .amdhsa_user_sgpr_kernarg_segment_ptr 1
  .amdhsa_system_sgpr_workgroup_id_x 1
.end_amdhsa_kernel
```
